```python
import torch

def _softmax(x, axis=-1):
    return torch.softmax(x, dim=axis)
def _gelu(x):
    return torch.nn.functional.gelu(x, approximate="tanh")
def _silu(x):
    return torch.nn.functional.silu(x)
def _sigmoid(x):
    return torch.sigmoid(x)
def _layernorm(x, axis=-1, eps=1e-5):
    m = x.mean(dim=axis, keepdim=True)
    v = x.var(dim=axis, keepdim=True, unbiased=False)
    return (x - m) / torch.sqrt(v + eps)
def _scatter_add(tgt, idx, src, axis=0):
    return tgt.clone().index_add_(axis, idx, src)
def _segment_sum(src, seg, n):
    out = torch.zeros((n,) + src.shape[1:], dtype=src.dtype)
    return out.index_add_(0, seg, src)
def _pad(x, pw):
    flat = tuple(v for pair in reversed(pw) for v in pair)
    return torch.nn.functional.pad(x, flat)

kernel_name = 'gated_mix__mha_block_cached__moe_arch_mod__decode'

def setup_inputs():

    _w = (lambda a: (lambda t: t.to(torch.bfloat16) if t.is_floating_point() else t)(torch.as_tensor(a)))
    def _A_setup():
        B, Sq, D = 8, 1, 512
        H, Sk, Dh = 32, 4096, 128
        return {
            "x": _w((lambda *s: torch.randn(*s, dtype=torch.bfloat16) * 0.05)(B, Sq, D)),
            "k_cache": _w((lambda *s: torch.randn(*s, dtype=torch.bfloat16) * 3.2)(B, H, Sk, Dh)),
            "v_cache": _w((lambda *s: torch.randn(*s, dtype=torch.bfloat16) * 1.6)(B, H, Sk, Dh)),
            "wq": _w((lambda *s: torch.randn(*s, dtype=torch.bfloat16) * 3.2)(D, H * Dh) * (D ** -0.5)),
            "wo": _w((lambda *s: torch.randn(*s, dtype=torch.bfloat16) * 1.6)(H * Dh, D) * ((H * Dh) ** -0.5)),
        }
    _A_in = _A_setup()

    def _B_setup():
        B, S, D, F, C = 8, 1, 512, 1792, 1
        return {
            "x": _w((lambda *s: torch.randn(*s, dtype=torch.bfloat16) * 0.05)(B, S, D)),
            "w_r": _w((lambda *s: torch.randn(*s, dtype=torch.bfloat16) * 1.6)(D)),
            "w_gate": _w((lambda *s: torch.randn(*s, dtype=torch.bfloat16) * 0.1)(D, F)),
            "w_up": _w((lambda *s: torch.randn(*s, dtype=torch.bfloat16) * 0.1)(D, F)),
            "w_down": _w((lambda *s: torch.randn(*s, dtype=torch.bfloat16) * 0.1)(F, D)),
        }
    _B_in = _B_setup()

    return {
        "A_x": _A_in["x"],
        "A_k_cache": _A_in["k_cache"],
        "A_v_cache": _A_in["v_cache"],
        "A_wq": _A_in["wq"],
        "A_wo": _A_in["wo"],
        "B_x": _B_in["x"],
        "B_w_r": _B_in["w_r"],
        "B_w_gate": _B_in["w_gate"],
        "B_w_up": _B_in["w_up"],
        "B_w_down": _B_in["w_down"],
        "gate_w": _w((lambda *s: torch.randn(*s, dtype=torch.bfloat16) * 0.05)(512) * 16.0),
    }

def reference(A_x, A_k_cache, A_v_cache, A_wq, A_wo, B_x, B_w_r, B_w_gate, B_w_up, B_w_down, gate_w):
    def _A_ref(x, k_cache, v_cache, wq, wo):
        B, Sq, D = x.shape
        H, Dh = 32, 128
        q = (lambda x, *d: x.permute(*d))((x @ wq).reshape(B, Sq, H, Dh), 0, 2, 1, 3)
        scores = torch.einsum("bhqd,bhkd->bhqk", q, k_cache) * (Dh ** -0.5)
        p = _softmax(scores, axis=-1)
        o = torch.einsum("bhqk,bhkd->bhqd", p, v_cache)
        return (lambda x, *d: x.permute(*d))(o, 0, 2, 1, 3).reshape(B, Sq, H * Dh) @ wo

    def _B_ref(x, w_r, w_gate, w_up, w_down):
        B, S, D = x.shape
        C = 1
        r = x @ w_r
        idx = torch.argsort(-r, axis=-1)[:, :C]
        idx_e = (lambda x, n, axis: torch.repeat_interleave(x, n, dim=axis))(idx.reshape(B, C, 1), D, axis=2)
        x_sel = (lambda x, i, axis: torch.take_along_dim(x, i, dim=axis))(x, idx_e, axis=1)
        g = _silu(x_sel @ w_gate)
        u = x_sel @ w_up
        y = (g * u) @ w_down
        r_sel = _sigmoid((lambda x, i, axis: torch.take_along_dim(x, i, dim=axis))(r, idx, axis=1))
        y = y * r_sel.reshape(B, C, 1)
        b_off = (torch.arange(B) * S).reshape(B, 1)
        flat_idx = (idx + b_off).reshape(B * C)
        zero = (x * 0.0).reshape(B * S, D)
        upd = _scatter_add(zero, flat_idx, y.reshape(B * C, D), axis=0)
        return x + upd.reshape(B, S, D)

    x = A_x
    g = _sigmoid((x * gate_w).sum(-1, keepdims=True))
    a = _A_ref(x, A_k_cache, A_v_cache, A_wq, A_wo)
    b = _B_ref(x, B_w_r, B_w_gate, B_w_up, B_w_down)
    return g * a + (1 - g) * b
```

```asm
; @launch grid=(256,1,1) block=(512,1,1) lds=155648
.amdgcn_target "amdgcn-amd-amdhsa--gfx950"
.text
.globl gated_mix__mha_block_cached__moe_arch_mod__decode_kernel
.p2align 8
.type gated_mix__mha_block_cached__moe_arch_mod__decode_kernel,@function
gated_mix__mha_block_cached__moe_arch_mod__decode_kernel:
    s_cmp_ge_u32 s2, 256
    s_cbranch_scc1 L_done
    s_load_dwordx4 s[52:55], s[0:1], 8
    v_lshrrev_b32 v1, 6, v0
    v_and_b32 v2, 63, v0
    v_readfirstlane_b32 s5, v1
    s_lshl_b32 s6, s2, 20
    s_mov_b32 s49, 0
    s_cmp_ge_u32 s5, 4
    s_cbranch_scc1 L_helper
    s_setprio 3
    v_lshlrev_b32 v1, 10, v1
    v_lshl_add_u32 v1, v2, 4, v1
    s_bitcmp1_b32 s2, 3
    s_cselect_b32 s50, 0x1000, 0
    s_xor_b32 s49, s49, s50
    s_bitcmp1_b32 s2, 6
    s_cselect_b32 s50, 0x2000, 0
    s_xor_b32 s49, s49, s50
    s_bitcmp1_b32 s2, 7
    s_cselect_b32 s50, 0x4000, 0
    s_xor_b32 s49, s49, s50
    s_mov_b32 s7, s49
    s_mov_b32 s10, 0x100000
    s_mov_b32 s11, 0x00020000
    s_mul_i32 s48, s5, 36864
    s_add_u32 s48, s48, 8192
    s_mov_b32 m0, s48
    s_waitcnt lgkmcnt(0)
    s_add_u32 s8, s52, s6
    s_addc_u32 s9, s53, 0
    s_and_b32 s9, s9, 0xffff
    buffer_load_dwordx4 v1, s[8:11], s7 offen offset:0 nt lds
    s_add_u32 m0, s48, 1024
    s_xor_b32 s7, s49, 0x1000
    buffer_load_dwordx4 v1, s[8:11], s7 offen offset:0 nt lds
    s_add_u32 m0, s48, 2048
    s_xor_b32 s7, s49, 0x2000
    buffer_load_dwordx4 v1, s[8:11], s7 offen offset:0 nt lds
    s_add_u32 m0, s48, 3072
    s_xor_b32 s7, s49, 0x3000
    buffer_load_dwordx4 v1, s[8:11], s7 offen offset:0 nt lds
    s_add_u32 m0, s48, 4096
    s_xor_b32 s7, s49, 0x4000
    buffer_load_dwordx4 v1, s[8:11], s7 offen offset:0 nt lds
    s_add_u32 m0, s48, 5120
    s_xor_b32 s7, s49, 0x5000
    s_add_u32 s12, s54, s6
    s_addc_u32 s13, s55, 0
    s_and_b32 s13, s13, 0xffff
    s_mov_b32 s14, 0x100000
    s_mov_b32 s15, 0x00020000
    s_mov_b32 s44, 0xcccccccc
    s_mov_b32 s45, 0xcccccccc
    s_mov_b32 s46, 0xaaaaaaaa
    s_mov_b32 s47, 0xaaaaaaaa
    v_and_b32 v3, 15, v2
    v_lshrrev_b32 v4, 4, v2
    v_and_b32 v5, 1, v3
    v_lshlrev_b32 v5, 4, v5
    v_mov_b32 v11, 0xffff
    v_lshlrev_b32 v11, v5, v11
    v_lshrrev_b32 v5, 1, v3
    v_cmp_eq_u32 s[56:57], 0, v5
    v_cmp_eq_u32 s[58:59], 1, v5
    v_cmp_eq_u32 s[60:61], 2, v5
    v_cmp_eq_u32 s[62:63], 3, v5
    v_cndmask_b32 v6, 0, v11, s[56:57]
    v_cndmask_b32 v7, 0, v11, s[58:59]
    v_cndmask_b32 v8, 0, v11, s[60:61]
    v_cndmask_b32 v9, 0, v11, s[62:63]
    s_mov_b32 s92, 0xffff0000
    s_mov_b32 s93, 0x3fb8aa3b
    v_lshl_add_u32 v10, v2, 4, s48
    s_waitcnt vmcnt(4)
    buffer_load_dwordx4 v1, s[8:11], s7 offen offset:0 nt lds
    s_add_u32 m0, s48, 6144
    s_xor_b32 s7, s49, 0x6000
    s_waitcnt vmcnt(4)
    buffer_load_dwordx4 v1, s[8:11], s7 offen offset:0 nt lds
    s_add_u32 m0, s48, 7168
    s_xor_b32 s7, s49, 0x7000
    s_waitcnt vmcnt(4)
    buffer_load_dwordx4 v1, s[8:11], s7 offen offset:0 nt lds
    s_add_u32 m0, s48, 8192
    s_xor_b32 s7, s49, 0x8000
    s_waitcnt vmcnt(4)
    buffer_load_dwordx4 v1, s[8:11], s7 offen offset:0 nt lds
    s_add_u32 m0, s48, 9216
    s_xor_b32 s7, s49, 0x9000
    s_waitcnt vmcnt(4)
    buffer_load_dwordx4 v1, s[8:11], s7 offen offset:0 nt lds
    s_add_u32 m0, s48, 10240
    s_xor_b32 s7, s49, 0xa000
    s_waitcnt vmcnt(4)
    buffer_load_dwordx4 v1, s[8:11], s7 offen offset:0 nt lds
    s_add_u32 m0, s48, 11264
    s_xor_b32 s7, s49, 0xb000
    s_waitcnt vmcnt(4)
    buffer_load_dwordx4 v1, s[8:11], s7 offen offset:0 nt lds
    s_add_u32 m0, s48, 12288
    s_xor_b32 s7, s49, 0xc000
    s_waitcnt vmcnt(4)
    buffer_load_dwordx4 v1, s[8:11], s7 offen offset:0 nt lds
    s_add_u32 m0, s48, 13312
    s_xor_b32 s7, s49, 0xd000
    s_waitcnt vmcnt(4)
    buffer_load_dwordx4 v1, s[8:11], s7 offen offset:0 nt lds
    s_add_u32 m0, s48, 14336
    s_xor_b32 s7, s49, 0xe000
    s_waitcnt vmcnt(4)
    buffer_load_dwordx4 v1, s[8:11], s7 offen offset:0 nt lds
    s_add_u32 m0, s48, 15360
    s_xor_b32 s7, s49, 0xf000
    s_waitcnt vmcnt(4)
    buffer_load_dwordx4 v1, s[8:11], s7 offen offset:0 nt lds
    s_add_u32 m0, s48, 16384
    s_xor_b32 s7, s49, 0x10000
    s_waitcnt vmcnt(4)
    buffer_load_dwordx4 v1, s[8:11], s7 offen offset:0 nt lds
    s_add_u32 m0, s48, 17408
    s_xor_b32 s7, s49, 0x11000
    s_waitcnt vmcnt(4)
    buffer_load_dwordx4 v1, s[8:11], s7 offen offset:0 nt lds
    s_add_u32 m0, s48, 18432
    s_xor_b32 s7, s49, 0x12000
    s_waitcnt vmcnt(4)
    buffer_load_dwordx4 v1, s[8:11], s7 offen offset:0 nt lds
    s_add_u32 m0, s48, 19456
    s_xor_b32 s7, s49, 0x13000
    s_waitcnt vmcnt(4)
    buffer_load_dwordx4 v1, s[8:11], s7 offen offset:0 nt lds
    s_add_u32 m0, s48, 20480
    s_xor_b32 s7, s49, 0x14000
    s_waitcnt vmcnt(4)
    buffer_load_dwordx4 v1, s[8:11], s7 offen offset:0 nt lds
    s_add_u32 m0, s48, 21504
    s_xor_b32 s7, s49, 0x15000
    s_waitcnt vmcnt(4)
    buffer_load_dwordx4 v1, s[8:11], s7 offen offset:0 nt lds
    s_add_u32 m0, s48, 22528
    s_xor_b32 s7, s49, 0x16000
    s_waitcnt vmcnt(4)
    buffer_load_dwordx4 v1, s[8:11], s7 offen offset:0 nt lds
    s_add_u32 m0, s48, 23552
    s_xor_b32 s7, s49, 0x17000
    s_waitcnt vmcnt(4)
    buffer_load_dwordx4 v1, s[8:11], s7 offen offset:0 nt lds
    s_add_u32 m0, s48, 24576
    s_xor_b32 s7, s49, 0x18000
    s_waitcnt vmcnt(4)
    buffer_load_dwordx4 v1, s[8:11], s7 offen offset:0 nt lds
    s_add_u32 m0, s48, 25600
    s_xor_b32 s7, s49, 0x19000
    s_waitcnt vmcnt(4)
    buffer_load_dwordx4 v1, s[8:11], s7 offen offset:0 nt lds
    s_add_u32 m0, s48, 26624
    s_xor_b32 s7, s49, 0x1a000
    s_waitcnt vmcnt(4)
    buffer_load_dwordx4 v1, s[8:11], s7 offen offset:0 nt lds
    s_add_u32 m0, s48, 27648
    s_xor_b32 s7, s49, 0x1b000
    s_waitcnt vmcnt(4)
    buffer_load_dwordx4 v1, s[8:11], s7 offen offset:0 nt lds
    s_add_u32 m0, s48, 28672
    s_xor_b32 s7, s49, 0x1c000
    s_waitcnt vmcnt(4)
    buffer_load_dwordx4 v1, s[8:11], s7 offen offset:0 nt lds
    s_add_u32 m0, s48, 29696
    s_xor_b32 s7, s49, 0x1d000
    s_waitcnt vmcnt(4)
    buffer_load_dwordx4 v1, s[8:11], s7 offen offset:0 nt lds
    s_add_u32 m0, s48, 30720
    s_xor_b32 s7, s49, 0x1e000
    s_waitcnt vmcnt(4)
    buffer_load_dwordx4 v1, s[8:11], s7 offen offset:0 nt lds
    s_add_u32 m0, s48, 31744
    s_xor_b32 s7, s49, 0x1f000
    s_waitcnt vmcnt(4)
    buffer_load_dwordx4 v1, s[8:11], s7 offen offset:0 nt lds
    s_add_u32 m0, s48, 32768
    s_xor_b32 s7, s49, 0x20000
    s_waitcnt vmcnt(4)
    buffer_load_dwordx4 v1, s[8:11], s7 offen offset:0 nt lds
    s_add_u32 m0, s48, 33792
    s_xor_b32 s7, s49, 0x21000
    s_waitcnt vmcnt(4)
    buffer_load_dwordx4 v1, s[8:11], s7 offen offset:0 nt lds
    s_add_u32 m0, s48, 34816
    s_xor_b32 s7, s49, 0x22000
    s_waitcnt vmcnt(4)
    buffer_load_dwordx4 v1, s[8:11], s7 offen offset:0 nt lds
    s_add_u32 m0, s48, 35840
    s_xor_b32 s7, s49, 0x23000
    s_waitcnt vmcnt(4)
    buffer_load_dwordx4 v1, s[8:11], s7 offen offset:0 nt lds
    s_xor_b32 s7, s49, 0x24000
    s_waitcnt vmcnt(4)
    buffer_load_dwordx4 v[240:243], v1, s[8:11], s7 offen offset:0 nt
    s_xor_b32 s7, s49, 0x25000
    s_waitcnt vmcnt(4)
    buffer_load_dwordx4 v[244:247], v1, s[8:11], s7 offen offset:0 nt
    s_xor_b32 s7, s49, 0x26000
    s_waitcnt vmcnt(4)
    buffer_load_dwordx4 v[248:251], v1, s[8:11], s7 offen offset:0 nt
    s_xor_b32 s7, s49, 0x27000
    s_waitcnt vmcnt(4)
    buffer_load_dwordx4 v[252:255], v1, s[8:11], s7 offen offset:0 nt
    s_xor_b32 s7, s49, 0x28000
    s_waitcnt vmcnt(4)
    buffer_load_dwordx4 v[96:99], v1, s[8:11], s7 offen offset:0 nt
    s_xor_b32 s7, s49, 0x29000
    s_waitcnt vmcnt(4)
    buffer_load_dwordx4 v[100:103], v1, s[8:11], s7 offen offset:0 nt
    s_xor_b32 s7, s49, 0x2a000
    s_waitcnt vmcnt(4)
    buffer_load_dwordx4 v[104:107], v1, s[8:11], s7 offen offset:0 nt
    s_xor_b32 s7, s49, 0x2b000
    s_waitcnt vmcnt(4)
    buffer_load_dwordx4 v[108:111], v1, s[8:11], s7 offen offset:0 nt
    s_xor_b32 s7, s49, 0x2c000
    s_waitcnt vmcnt(4)
    buffer_load_dwordx4 v[112:115], v1, s[8:11], s7 offen offset:0 nt
    s_xor_b32 s7, s49, 0x2d000
    s_waitcnt vmcnt(4)
    buffer_load_dwordx4 v[116:119], v1, s[8:11], s7 offen offset:0 nt
    s_xor_b32 s7, s49, 0x2e000
    s_waitcnt vmcnt(4)
    buffer_load_dwordx4 v[120:123], v1, s[8:11], s7 offen offset:0 nt
    s_xor_b32 s7, s49, 0x2f000
    s_waitcnt vmcnt(4)
    buffer_load_dwordx4 v[124:127], v1, s[8:11], s7 offen offset:0 nt
    s_xor_b32 s7, s49, 0x30000
    s_waitcnt vmcnt(4)
    buffer_load_dwordx4 v[128:131], v1, s[8:11], s7 offen offset:0 nt
    s_xor_b32 s7, s49, 0x31000
    s_waitcnt vmcnt(4)
    buffer_load_dwordx4 v[132:135], v1, s[8:11], s7 offen offset:0 nt
    s_xor_b32 s7, s49, 0x32000
    s_waitcnt vmcnt(4)
    buffer_load_dwordx4 v[136:139], v1, s[8:11], s7 offen offset:0 nt
    s_xor_b32 s7, s49, 0x33000
    s_waitcnt vmcnt(4)
    buffer_load_dwordx4 v[140:143], v1, s[8:11], s7 offen offset:0 nt
    s_xor_b32 s7, s49, 0x34000
    s_waitcnt vmcnt(4)
    buffer_load_dwordx4 v[144:147], v1, s[8:11], s7 offen offset:0 nt
    s_xor_b32 s7, s49, 0x35000
    s_waitcnt vmcnt(4)
    buffer_load_dwordx4 v[148:151], v1, s[8:11], s7 offen offset:0 nt
    s_xor_b32 s7, s49, 0x36000
    s_waitcnt vmcnt(4)
    buffer_load_dwordx4 v[152:155], v1, s[8:11], s7 offen offset:0 nt
    s_xor_b32 s7, s49, 0x37000
    s_waitcnt vmcnt(4)
    buffer_load_dwordx4 v[156:159], v1, s[8:11], s7 offen offset:0 nt
    s_xor_b32 s7, s49, 0x38000
    s_waitcnt vmcnt(4)
    buffer_load_dwordx4 v[160:163], v1, s[8:11], s7 offen offset:0 nt
    s_xor_b32 s7, s49, 0x39000
    s_waitcnt vmcnt(4)
    buffer_load_dwordx4 v[164:167], v1, s[8:11], s7 offen offset:0 nt
    s_xor_b32 s7, s49, 0x3a000
    s_waitcnt vmcnt(4)
    buffer_load_dwordx4 v[168:171], v1, s[8:11], s7 offen offset:0 nt
    s_xor_b32 s7, s49, 0x3b000
    s_waitcnt vmcnt(4)
    buffer_load_dwordx4 v[172:175], v1, s[8:11], s7 offen offset:0 nt
    s_xor_b32 s7, s49, 0x3c000
    s_waitcnt vmcnt(4)
    buffer_load_dwordx4 v[176:179], v1, s[8:11], s7 offen offset:0 nt
    s_xor_b32 s7, s49, 0x3d000
    s_waitcnt vmcnt(4)
    buffer_load_dwordx4 v[180:183], v1, s[8:11], s7 offen offset:0 nt
    s_xor_b32 s7, s49, 0x3e000
    s_waitcnt vmcnt(4)
    buffer_load_dwordx4 v[184:187], v1, s[8:11], s7 offen offset:0 nt
    s_xor_b32 s7, s49, 0x3f000
    s_waitcnt vmcnt(4)
    buffer_load_dwordx4 v[188:191], v1, s[8:11], s7 offen offset:0 nt
    s_xor_b32 s7, s49, 0x40000
    s_waitcnt vmcnt(4)
    buffer_load_dwordx4 v[192:195], v1, s[8:11], s7 offen offset:0 nt
    s_xor_b32 s7, s49, 0x41000
    s_waitcnt vmcnt(4)
    buffer_load_dwordx4 v[196:199], v1, s[8:11], s7 offen offset:0 nt
    s_xor_b32 s7, s49, 0x42000
    s_waitcnt vmcnt(4)
    buffer_load_dwordx4 v[200:203], v1, s[8:11], s7 offen offset:0 nt
    s_xor_b32 s7, s49, 0x43000
    s_waitcnt vmcnt(4)
    buffer_load_dwordx4 v[204:207], v1, s[8:11], s7 offen offset:0 nt
    s_xor_b32 s7, s49, 0x44000
    s_waitcnt vmcnt(4)
    buffer_load_dwordx4 v[208:211], v1, s[8:11], s7 offen offset:0 nt
    s_xor_b32 s7, s49, 0x45000
    s_waitcnt vmcnt(4)
    buffer_load_dwordx4 v[212:215], v1, s[8:11], s7 offen offset:0 nt
    s_xor_b32 s7, s49, 0x46000
    s_waitcnt vmcnt(4)
    buffer_load_dwordx4 v[216:219], v1, s[8:11], s7 offen offset:0 nt
    s_xor_b32 s7, s49, 0x47000
    s_waitcnt vmcnt(4)
    buffer_load_dwordx4 v[220:223], v1, s[8:11], s7 offen offset:0 nt
    s_xor_b32 s7, s49, 0x48000
    s_waitcnt vmcnt(4)
    buffer_load_dwordx4 v[224:227], v1, s[8:11], s7 offen offset:0 nt
    s_xor_b32 s7, s49, 0x49000
    s_barrier
    v_lshlrev_b32 v5, 5, v3
    ds_read_b128 v[32:35], v5 offset:0
    ds_read_b128 v[36:39], v5 offset:16
    ds_read_b128 v[40:43], v5 offset:512
    ds_read_b128 v[44:47], v5 offset:528
    ds_read_b128 v[48:51], v5 offset:1024
    ds_read_b128 v[52:55], v5 offset:1040
    ds_read_b128 v[56:59], v5 offset:1536
    ds_read_b128 v[60:63], v5 offset:1552
    buffer_load_dwordx4 v[228:231], v1, s[8:11], s7 offen offset:0 nt
    s_xor_b32 s7, s49, 0x4a000
    buffer_load_dwordx4 v[232:235], v1, s[8:11], s7 offen offset:0 nt
    s_xor_b32 s7, s49, 0x4b000
    s_waitcnt lgkmcnt(0)
    v_add_f32 v32, v32, v40
    v_add_f32 v48, v48, v56
    v_add_f32 v33, v33, v41
    v_add_f32 v49, v49, v57
    v_add_f32 v34, v34, v42
    v_add_f32 v50, v50, v58
    v_add_f32 v35, v35, v43
    v_add_f32 v51, v51, v59
    v_add_f32 v36, v36, v44
    v_add_f32 v52, v52, v60
    v_add_f32 v37, v37, v45
    v_add_f32 v53, v53, v61
    v_add_f32 v38, v38, v46
    v_add_f32 v54, v54, v62
    v_add_f32 v39, v39, v47
    v_add_f32 v55, v55, v63
    v_add_f32 v32, v32, v48
    v_add_f32 v33, v33, v49
    v_add_f32 v34, v34, v50
    v_add_f32 v35, v35, v51
    v_add_f32 v36, v36, v52
    v_add_f32 v37, v37, v53
    v_add_f32 v38, v38, v54
    v_add_f32 v39, v39, v55
    v_cvt_pk_bf16_f32 v28, v32, v33
    v_cvt_pk_bf16_f32 v29, v34, v35
    v_cvt_pk_bf16_f32 v30, v36, v37
    v_cvt_pk_bf16_f32 v31, v38, v39
    ds_read_b128 v[16:19], v10 offset:0
    ds_read_b128 v[20:23], v10 offset:1024
    s_waitcnt vmcnt(4)
    buffer_load_dwordx4 v[236:239], v1, s[8:11], s7 offen offset:0 nt
    s_xor_b32 s7, s49, 0x4c000
    v_dot2_f32_bf16 v32, v240, v28, 0
    v_dot2_f32_bf16 v32, v241, v29, v32
    v_dot2_f32_bf16 v32, v242, v30, v32
    v_dot2_f32_bf16 v32, v243, v31, v32
    s_waitcnt lgkmcnt(1)
    v_dot2_f32_bf16 v33, v16, v28, 0
    v_dot2_f32_bf16 v33, v17, v29, v33
    v_dot2_f32_bf16 v33, v18, v30, v33
    v_dot2_f32_bf16 v33, v19, v31, v33
    ds_read_b128 v[24:27], v10 offset:2048
    s_waitcnt vmcnt(4)
    buffer_load_dwordx4 v[240:243], v1, s[8:11], s7 offen offset:0 nt
    s_xor_b32 s7, s49, 0x4d000
    v_dot2_f32_bf16 v34, v244, v28, 0
    v_dot2_f32_bf16 v34, v245, v29, v34
    v_dot2_f32_bf16 v34, v246, v30, v34
    v_dot2_f32_bf16 v34, v247, v31, v34
    v_add_f32_dpp v32, v32, v32 row_ror:8 row_mask:0xf bank_mask:0x3
    s_nop 1
    v_add_f32_dpp v32, v33, v33 row_ror:8 row_mask:0xf bank_mask:0xc
    s_waitcnt lgkmcnt(1)
    v_dot2_f32_bf16 v35, v20, v28, 0
    v_dot2_f32_bf16 v35, v21, v29, v35
    v_dot2_f32_bf16 v35, v22, v30, v35
    v_dot2_f32_bf16 v35, v23, v31, v35
    ds_read_b128 v[16:19], v10 offset:3072
    s_waitcnt vmcnt(4)
    buffer_load_dwordx4 v[244:247], v1, s[8:11], s7 offen offset:0 nt
    s_xor_b32 s7, s49, 0x4e000
    v_dot2_f32_bf16 v36, v248, v28, 0
    v_dot2_f32_bf16 v36, v249, v29, v36
    v_dot2_f32_bf16 v36, v250, v30, v36
    v_dot2_f32_bf16 v36, v251, v31, v36
    v_add_f32_dpp v34, v34, v34 row_ror:8 row_mask:0xf bank_mask:0x3
    s_nop 1
    v_add_f32_dpp v34, v35, v35 row_ror:8 row_mask:0xf bank_mask:0xc
    s_waitcnt lgkmcnt(1)
    v_dot2_f32_bf16 v37, v24, v28, 0
    v_dot2_f32_bf16 v37, v25, v29, v37
    v_dot2_f32_bf16 v37, v26, v30, v37
    v_dot2_f32_bf16 v37, v27, v31, v37
    v_add_f32_dpp v32, v32, v32 row_shl:4 row_mask:0xf bank_mask:0x5
    s_nop 1
    v_add_f32_dpp v32, v34, v34 row_shr:4 row_mask:0xf bank_mask:0xa
    ds_read_b128 v[20:23], v10 offset:4096
    s_waitcnt vmcnt(4)
    buffer_load_dwordx4 v[248:251], v1, s[8:11], s7 offen offset:0 nt
    s_xor_b32 s7, s49, 0x4f000
    v_dot2_f32_bf16 v38, v252, v28, 0
    v_dot2_f32_bf16 v38, v253, v29, v38
    v_dot2_f32_bf16 v38, v254, v30, v38
    v_dot2_f32_bf16 v38, v255, v31, v38
    v_add_f32_dpp v36, v36, v36 row_ror:8 row_mask:0xf bank_mask:0x3
    s_nop 1
    v_add_f32_dpp v36, v37, v37 row_ror:8 row_mask:0xf bank_mask:0xc
    s_waitcnt lgkmcnt(1)
    v_dot2_f32_bf16 v39, v16, v28, 0
    v_dot2_f32_bf16 v39, v17, v29, v39
    v_dot2_f32_bf16 v39, v18, v30, v39
    v_dot2_f32_bf16 v39, v19, v31, v39
    ds_read_b128 v[24:27], v10 offset:5120
    s_waitcnt vmcnt(4)
    buffer_load_dwordx4 v[252:255], v1, s[8:11], s7 offen offset:0 nt
    s_xor_b32 s7, s49, 0x50000
    v_dot2_f32_bf16 v40, v96, v28, 0
    v_dot2_f32_bf16 v40, v97, v29, v40
    v_dot2_f32_bf16 v40, v98, v30, v40
    v_dot2_f32_bf16 v40, v99, v31, v40
    v_add_f32_dpp v38, v38, v38 row_ror:8 row_mask:0xf bank_mask:0x3
    s_nop 1
    v_add_f32_dpp v38, v39, v39 row_ror:8 row_mask:0xf bank_mask:0xc
    s_waitcnt lgkmcnt(1)
    v_dot2_f32_bf16 v41, v20, v28, 0
    v_dot2_f32_bf16 v41, v21, v29, v41
    v_dot2_f32_bf16 v41, v22, v30, v41
    v_dot2_f32_bf16 v41, v23, v31, v41
    v_add_f32_dpp v36, v36, v36 row_shl:4 row_mask:0xf bank_mask:0x5
    s_nop 1
    v_add_f32_dpp v36, v38, v38 row_shr:4 row_mask:0xf bank_mask:0xa
    ds_read_b128 v[16:19], v10 offset:6144
    s_waitcnt vmcnt(4)
    buffer_load_dwordx4 v[96:99], v1, s[8:11], s7 offen offset:0 nt
    s_xor_b32 s7, s49, 0x51000
    v_dot2_f32_bf16 v42, v100, v28, 0
    v_dot2_f32_bf16 v42, v101, v29, v42
    v_dot2_f32_bf16 v42, v102, v30, v42
    v_dot2_f32_bf16 v42, v103, v31, v42
    v_add_f32_dpp v32, v32, v32 quad_perm:[2,3,0,1] row_mask:0xf bank_mask:0xf
    v_add_f32_dpp v36, v36, v36 quad_perm:[2,3,0,1] row_mask:0xf bank_mask:0xf
    v_cndmask_b32 v32, v32, v36, s[44:45]
    v_add_f32_dpp v40, v40, v40 row_ror:8 row_mask:0xf bank_mask:0x3
    s_nop 1
    v_add_f32_dpp v40, v41, v41 row_ror:8 row_mask:0xf bank_mask:0xc
    s_waitcnt lgkmcnt(1)
    v_dot2_f32_bf16 v43, v24, v28, 0
    v_dot2_f32_bf16 v43, v25, v29, v43
    v_dot2_f32_bf16 v43, v26, v30, v43
    v_dot2_f32_bf16 v43, v27, v31, v43
    ds_read_b128 v[20:23], v10 offset:7168
    s_waitcnt vmcnt(4)
    buffer_load_dwordx4 v[100:103], v1, s[8:11], s7 offen offset:0 nt
    s_xor_b32 s7, s49, 0x52000
    v_dot2_f32_bf16 v44, v104, v28, 0
    v_dot2_f32_bf16 v44, v105, v29, v44
    v_dot2_f32_bf16 v44, v106, v30, v44
    v_dot2_f32_bf16 v44, v107, v31, v44
    v_add_f32_dpp v42, v42, v42 row_ror:8 row_mask:0xf bank_mask:0x3
    s_nop 1
    v_add_f32_dpp v42, v43, v43 row_ror:8 row_mask:0xf bank_mask:0xc
    s_waitcnt lgkmcnt(1)
    v_dot2_f32_bf16 v45, v16, v28, 0
    v_dot2_f32_bf16 v45, v17, v29, v45
    v_dot2_f32_bf16 v45, v18, v30, v45
    v_dot2_f32_bf16 v45, v19, v31, v45
    v_add_f32_dpp v40, v40, v40 row_shl:4 row_mask:0xf bank_mask:0x5
    s_nop 1
    v_add_f32_dpp v40, v42, v42 row_shr:4 row_mask:0xf bank_mask:0xa
    ds_read_b128 v[24:27], v10 offset:8192
    s_waitcnt vmcnt(4)
    buffer_load_dwordx4 v[104:107], v1, s[8:11], s7 offen offset:0 nt
    s_xor_b32 s7, s49, 0x53000
    v_dot2_f32_bf16 v46, v108, v28, 0
    v_dot2_f32_bf16 v46, v109, v29, v46
    v_dot2_f32_bf16 v46, v110, v30, v46
    v_dot2_f32_bf16 v46, v111, v31, v46
    v_add_f32_dpp v44, v44, v44 row_ror:8 row_mask:0xf bank_mask:0x3
    s_nop 1
    v_add_f32_dpp v44, v45, v45 row_ror:8 row_mask:0xf bank_mask:0xc
    s_waitcnt lgkmcnt(1)
    v_dot2_f32_bf16 v47, v20, v28, 0
    v_dot2_f32_bf16 v47, v21, v29, v47
    v_dot2_f32_bf16 v47, v22, v30, v47
    v_dot2_f32_bf16 v47, v23, v31, v47
    ds_read_b128 v[16:19], v10 offset:9216
    s_waitcnt vmcnt(4)
    buffer_load_dwordx4 v[108:111], v1, s[8:11], s7 offen offset:0 nt
    s_xor_b32 s7, s49, 0x54000
    v_dot2_f32_bf16 v48, v112, v28, 0
    v_dot2_f32_bf16 v48, v113, v29, v48
    v_dot2_f32_bf16 v48, v114, v30, v48
    v_dot2_f32_bf16 v48, v115, v31, v48
    v_add_f32_dpp v46, v46, v46 row_ror:8 row_mask:0xf bank_mask:0x3
    s_nop 1
    v_add_f32_dpp v46, v47, v47 row_ror:8 row_mask:0xf bank_mask:0xc
    s_waitcnt lgkmcnt(1)
    v_dot2_f32_bf16 v49, v24, v28, 0
    v_dot2_f32_bf16 v49, v25, v29, v49
    v_dot2_f32_bf16 v49, v26, v30, v49
    v_dot2_f32_bf16 v49, v27, v31, v49
    v_add_f32_dpp v44, v44, v44 row_shl:4 row_mask:0xf bank_mask:0x5
    s_nop 1
    v_add_f32_dpp v44, v46, v46 row_shr:4 row_mask:0xf bank_mask:0xa
    ds_read_b128 v[20:23], v10 offset:10240
    s_waitcnt vmcnt(4)
    buffer_load_dwordx4 v[112:115], v1, s[8:11], s7 offen offset:0 nt
    s_xor_b32 s7, s49, 0x55000
    v_dot2_f32_bf16 v50, v116, v28, 0
    v_dot2_f32_bf16 v50, v117, v29, v50
    v_dot2_f32_bf16 v50, v118, v30, v50
    v_dot2_f32_bf16 v50, v119, v31, v50
    v_add_f32_dpp v40, v40, v40 quad_perm:[2,3,0,1] row_mask:0xf bank_mask:0xf
    v_add_f32_dpp v44, v44, v44 quad_perm:[2,3,0,1] row_mask:0xf bank_mask:0xf
    v_cndmask_b32 v40, v40, v44, s[44:45]
    v_add_f32_dpp v48, v48, v48 row_ror:8 row_mask:0xf bank_mask:0x3
    s_nop 1
    v_add_f32_dpp v48, v49, v49 row_ror:8 row_mask:0xf bank_mask:0xc
    s_waitcnt lgkmcnt(1)
    v_dot2_f32_bf16 v51, v16, v28, 0
    v_dot2_f32_bf16 v51, v17, v29, v51
    v_dot2_f32_bf16 v51, v18, v30, v51
    v_dot2_f32_bf16 v51, v19, v31, v51
    v_add_f32_dpp v32, v32, v32 quad_perm:[1,0,3,2] row_mask:0xf bank_mask:0xf
    v_add_f32_dpp v40, v40, v40 quad_perm:[1,0,3,2] row_mask:0xf bank_mask:0xf
    v_cndmask_b32 v32, v32, v40, s[46:47]
    v_cvt_pk_bf16_f32 v80, v32, v32
    v_and_b32 v80, s92, v80
    v_mul_f32 v80, 0x3db504f3, v80
    v_cvt_pk_bf16_f32 v64, v80, v80
    v_and_b32 v64, s92, v64
    v_mov_b32 v81, v64
    ds_read_b128 v[24:27], v10 offset:11264
    s_waitcnt vmcnt(4)
    buffer_load_dwordx4 v[116:119], v1, s[8:11], s7 offen offset:0 nt
    s_xor_b32 s7, s49, 0x56000
    v_dot2_f32_bf16 v52, v120, v28, 0
    v_dot2_f32_bf16 v52, v121, v29, v52
    v_dot2_f32_bf16 v52, v122, v30, v52
    v_dot2_f32_bf16 v52, v123, v31, v52
    v_add_f32_dpp v50, v50, v50 row_ror:8 row_mask:0xf bank_mask:0x3
    s_nop 1
    v_add_f32_dpp v50, v51, v51 row_ror:8 row_mask:0xf bank_mask:0xc
    s_waitcnt lgkmcnt(1)
    v_dot2_f32_bf16 v53, v20, v28, 0
    v_dot2_f32_bf16 v53, v21, v29, v53
    v_dot2_f32_bf16 v53, v22, v30, v53
    v_dot2_f32_bf16 v53, v23, v31, v53
    v_add_f32_dpp v48, v48, v48 row_shl:4 row_mask:0xf bank_mask:0x5
    s_nop 1
    v_add_f32_dpp v48, v50, v50 row_shr:4 row_mask:0xf bank_mask:0xa
    ds_read_b128 v[16:19], v10 offset:12288
    s_waitcnt vmcnt(4)
    buffer_load_dwordx4 v[120:123], v1, s[8:11], s7 offen offset:0 nt
    s_xor_b32 s7, s49, 0x57000
    v_dot2_f32_bf16 v54, v124, v28, 0
    v_dot2_f32_bf16 v54, v125, v29, v54
    v_dot2_f32_bf16 v54, v126, v30, v54
    v_dot2_f32_bf16 v54, v127, v31, v54
    v_add_f32_dpp v52, v52, v52 row_ror:8 row_mask:0xf bank_mask:0x3
    s_nop 1
    v_add_f32_dpp v52, v53, v53 row_ror:8 row_mask:0xf bank_mask:0xc
    s_waitcnt lgkmcnt(1)
    v_dot2_f32_bf16 v55, v24, v28, 0
    v_dot2_f32_bf16 v55, v25, v29, v55
    v_dot2_f32_bf16 v55, v26, v30, v55
    v_dot2_f32_bf16 v55, v27, v31, v55
    ds_read_b128 v[20:23], v10 offset:13312
    s_waitcnt vmcnt(4)
    buffer_load_dwordx4 v[124:127], v1, s[8:11], s7 offen offset:0 nt
    s_xor_b32 s7, s49, 0x58000
    v_dot2_f32_bf16 v56, v128, v28, 0
    v_dot2_f32_bf16 v56, v129, v29, v56
    v_dot2_f32_bf16 v56, v130, v30, v56
    v_dot2_f32_bf16 v56, v131, v31, v56
    v_add_f32_dpp v54, v54, v54 row_ror:8 row_mask:0xf bank_mask:0x3
    s_nop 1
    v_add_f32_dpp v54, v55, v55 row_ror:8 row_mask:0xf bank_mask:0xc
    s_waitcnt lgkmcnt(1)
    v_dot2_f32_bf16 v57, v16, v28, 0
    v_dot2_f32_bf16 v57, v17, v29, v57
    v_dot2_f32_bf16 v57, v18, v30, v57
    v_dot2_f32_bf16 v57, v19, v31, v57
    v_add_f32_dpp v52, v52, v52 row_shl:4 row_mask:0xf bank_mask:0x5
    s_nop 1
    v_add_f32_dpp v52, v54, v54 row_shr:4 row_mask:0xf bank_mask:0xa
    ds_read_b128 v[24:27], v10 offset:14336
    s_waitcnt vmcnt(4)
    buffer_load_dwordx4 v[128:131], v1, s[8:11], s7 offen offset:0 nt
    s_xor_b32 s7, s49, 0x59000
    v_dot2_f32_bf16 v58, v132, v28, 0
    v_dot2_f32_bf16 v58, v133, v29, v58
    v_dot2_f32_bf16 v58, v134, v30, v58
    v_dot2_f32_bf16 v58, v135, v31, v58
    v_add_f32_dpp v48, v48, v48 quad_perm:[2,3,0,1] row_mask:0xf bank_mask:0xf
    v_add_f32_dpp v52, v52, v52 quad_perm:[2,3,0,1] row_mask:0xf bank_mask:0xf
    v_cndmask_b32 v48, v48, v52, s[44:45]
    v_add_f32_dpp v56, v56, v56 row_ror:8 row_mask:0xf bank_mask:0x3
    s_nop 1
    v_add_f32_dpp v56, v57, v57 row_ror:8 row_mask:0xf bank_mask:0xc
    s_waitcnt lgkmcnt(1)
    v_dot2_f32_bf16 v59, v20, v28, 0
    v_dot2_f32_bf16 v59, v21, v29, v59
    v_dot2_f32_bf16 v59, v22, v30, v59
    v_dot2_f32_bf16 v59, v23, v31, v59
    ds_read_b128 v[16:19], v10 offset:15360
    s_waitcnt vmcnt(4)
    buffer_load_dwordx4 v[132:135], v1, s[8:11], s7 offen offset:0 nt
    s_xor_b32 s7, s49, 0x5a000
    v_dot2_f32_bf16 v60, v136, v28, 0
    v_dot2_f32_bf16 v60, v137, v29, v60
    v_dot2_f32_bf16 v60, v138, v30, v60
    v_dot2_f32_bf16 v60, v139, v31, v60
    v_add_f32_dpp v58, v58, v58 row_ror:8 row_mask:0xf bank_mask:0x3
    s_nop 1
    v_add_f32_dpp v58, v59, v59 row_ror:8 row_mask:0xf bank_mask:0xc
    s_waitcnt lgkmcnt(1)
    v_dot2_f32_bf16 v61, v24, v28, 0
    v_dot2_f32_bf16 v61, v25, v29, v61
    v_dot2_f32_bf16 v61, v26, v30, v61
    v_dot2_f32_bf16 v61, v27, v31, v61
    v_add_f32_dpp v56, v56, v56 row_shl:4 row_mask:0xf bank_mask:0x5
    s_nop 1
    v_add_f32_dpp v56, v58, v58 row_shr:4 row_mask:0xf bank_mask:0xa
    ds_read_b128 v[20:23], v10 offset:16384
    s_waitcnt vmcnt(4)
    buffer_load_dwordx4 v[136:139], v1, s[8:11], s7 offen offset:0 nt
    s_xor_b32 s7, s49, 0x5b000
    v_dot2_f32_bf16 v62, v140, v28, 0
    v_dot2_f32_bf16 v62, v141, v29, v62
    v_dot2_f32_bf16 v62, v142, v30, v62
    v_dot2_f32_bf16 v62, v143, v31, v62
    v_add_f32_dpp v60, v60, v60 row_ror:8 row_mask:0xf bank_mask:0x3
    s_nop 1
    v_add_f32_dpp v60, v61, v61 row_ror:8 row_mask:0xf bank_mask:0xc
    s_waitcnt lgkmcnt(1)
    v_dot2_f32_bf16 v63, v16, v28, 0
    v_dot2_f32_bf16 v63, v17, v29, v63
    v_dot2_f32_bf16 v63, v18, v30, v63
    v_dot2_f32_bf16 v63, v19, v31, v63
    ds_read_b128 v[24:27], v10 offset:17408
    s_waitcnt vmcnt(4)
    buffer_load_dwordx4 v[140:143], v1, s[8:11], s7 offen offset:0 nt
    s_xor_b32 s7, s49, 0x5c000
    v_dot2_f32_bf16 v32, v144, v28, 0
    v_dot2_f32_bf16 v32, v145, v29, v32
    v_dot2_f32_bf16 v32, v146, v30, v32
    v_dot2_f32_bf16 v32, v147, v31, v32
    v_add_f32_dpp v62, v62, v62 row_ror:8 row_mask:0xf bank_mask:0x3
    s_nop 1
    v_add_f32_dpp v62, v63, v63 row_ror:8 row_mask:0xf bank_mask:0xc
    s_waitcnt lgkmcnt(1)
    v_dot2_f32_bf16 v33, v20, v28, 0
    v_dot2_f32_bf16 v33, v21, v29, v33
    v_dot2_f32_bf16 v33, v22, v30, v33
    v_dot2_f32_bf16 v33, v23, v31, v33
    v_add_f32_dpp v60, v60, v60 row_shl:4 row_mask:0xf bank_mask:0x5
    s_nop 1
    v_add_f32_dpp v60, v62, v62 row_shr:4 row_mask:0xf bank_mask:0xa
    ds_read_b128 v[16:19], v10 offset:18432
    s_waitcnt vmcnt(4)
    buffer_load_dwordx4 v[144:147], v1, s[8:11], s7 offen offset:0 nt
    s_xor_b32 s7, s49, 0x5d000
    v_dot2_f32_bf16 v34, v148, v28, 0
    v_dot2_f32_bf16 v34, v149, v29, v34
    v_dot2_f32_bf16 v34, v150, v30, v34
    v_dot2_f32_bf16 v34, v151, v31, v34
    v_add_f32_dpp v56, v56, v56 quad_perm:[2,3,0,1] row_mask:0xf bank_mask:0xf
    v_add_f32_dpp v60, v60, v60 quad_perm:[2,3,0,1] row_mask:0xf bank_mask:0xf
    v_cndmask_b32 v56, v56, v60, s[44:45]
    v_add_f32_dpp v32, v32, v32 row_ror:8 row_mask:0xf bank_mask:0x3
    s_nop 1
    v_add_f32_dpp v32, v33, v33 row_ror:8 row_mask:0xf bank_mask:0xc
    s_waitcnt lgkmcnt(1)
    v_dot2_f32_bf16 v35, v24, v28, 0
    v_dot2_f32_bf16 v35, v25, v29, v35
    v_dot2_f32_bf16 v35, v26, v30, v35
    v_dot2_f32_bf16 v35, v27, v31, v35
    v_add_f32_dpp v48, v48, v48 quad_perm:[1,0,3,2] row_mask:0xf bank_mask:0xf
    v_add_f32_dpp v56, v56, v56 quad_perm:[1,0,3,2] row_mask:0xf bank_mask:0xf
    v_cndmask_b32 v48, v48, v56, s[46:47]
    v_cvt_pk_bf16_f32 v80, v48, v48
    v_and_b32 v80, s92, v80
    v_mul_f32 v80, 0x3db504f3, v80
    v_cvt_pk_bf16_f32 v65, v80, v80
    v_and_b32 v65, s92, v65
    v_max_f32 v81, v81, v65
    ds_read_b128 v[20:23], v10 offset:19456
    s_waitcnt vmcnt(4)
    buffer_load_dwordx4 v[148:151], v1, s[8:11], s7 offen offset:0 nt
    s_xor_b32 s7, s49, 0x5e000
    v_dot2_f32_bf16 v36, v152, v28, 0
    v_dot2_f32_bf16 v36, v153, v29, v36
    v_dot2_f32_bf16 v36, v154, v30, v36
    v_dot2_f32_bf16 v36, v155, v31, v36
    v_add_f32_dpp v34, v34, v34 row_ror:8 row_mask:0xf bank_mask:0x3
    s_nop 1
    v_add_f32_dpp v34, v35, v35 row_ror:8 row_mask:0xf bank_mask:0xc
    s_waitcnt lgkmcnt(1)
    v_dot2_f32_bf16 v37, v16, v28, 0
    v_dot2_f32_bf16 v37, v17, v29, v37
    v_dot2_f32_bf16 v37, v18, v30, v37
    v_dot2_f32_bf16 v37, v19, v31, v37
    v_add_f32_dpp v32, v32, v32 row_shl:4 row_mask:0xf bank_mask:0x5
    s_nop 1
    v_add_f32_dpp v32, v34, v34 row_shr:4 row_mask:0xf bank_mask:0xa
    ds_read_b128 v[24:27], v10 offset:20480
    s_waitcnt vmcnt(4)
    buffer_load_dwordx4 v[152:155], v1, s[8:11], s7 offen offset:0 nt
    s_xor_b32 s7, s49, 0x5f000
    v_dot2_f32_bf16 v38, v156, v28, 0
    v_dot2_f32_bf16 v38, v157, v29, v38
    v_dot2_f32_bf16 v38, v158, v30, v38
    v_dot2_f32_bf16 v38, v159, v31, v38
    v_add_f32_dpp v36, v36, v36 row_ror:8 row_mask:0xf bank_mask:0x3
    s_nop 1
    v_add_f32_dpp v36, v37, v37 row_ror:8 row_mask:0xf bank_mask:0xc
    s_waitcnt lgkmcnt(1)
    v_dot2_f32_bf16 v39, v20, v28, 0
    v_dot2_f32_bf16 v39, v21, v29, v39
    v_dot2_f32_bf16 v39, v22, v30, v39
    v_dot2_f32_bf16 v39, v23, v31, v39
    ds_read_b128 v[16:19], v10 offset:21504
    s_waitcnt vmcnt(4)
    buffer_load_dwordx4 v[156:159], v1, s[8:11], s7 offen offset:0 nt
    s_xor_b32 s7, s49, 0x60000
    v_dot2_f32_bf16 v40, v160, v28, 0
    v_dot2_f32_bf16 v40, v161, v29, v40
    v_dot2_f32_bf16 v40, v162, v30, v40
    v_dot2_f32_bf16 v40, v163, v31, v40
    v_add_f32_dpp v38, v38, v38 row_ror:8 row_mask:0xf bank_mask:0x3
    s_nop 1
    v_add_f32_dpp v38, v39, v39 row_ror:8 row_mask:0xf bank_mask:0xc
    s_waitcnt lgkmcnt(1)
    v_dot2_f32_bf16 v41, v24, v28, 0
    v_dot2_f32_bf16 v41, v25, v29, v41
    v_dot2_f32_bf16 v41, v26, v30, v41
    v_dot2_f32_bf16 v41, v27, v31, v41
    v_add_f32_dpp v36, v36, v36 row_shl:4 row_mask:0xf bank_mask:0x5
    s_nop 1
    v_add_f32_dpp v36, v38, v38 row_shr:4 row_mask:0xf bank_mask:0xa
    ds_read_b128 v[20:23], v10 offset:22528
    s_waitcnt vmcnt(4)
    buffer_load_dwordx4 v[160:163], v1, s[8:11], s7 offen offset:0 nt
    s_xor_b32 s7, s49, 0x61000
    v_dot2_f32_bf16 v42, v164, v28, 0
    v_dot2_f32_bf16 v42, v165, v29, v42
    v_dot2_f32_bf16 v42, v166, v30, v42
    v_dot2_f32_bf16 v42, v167, v31, v42
    v_add_f32_dpp v32, v32, v32 quad_perm:[2,3,0,1] row_mask:0xf bank_mask:0xf
    v_add_f32_dpp v36, v36, v36 quad_perm:[2,3,0,1] row_mask:0xf bank_mask:0xf
    v_cndmask_b32 v32, v32, v36, s[44:45]
    v_add_f32_dpp v40, v40, v40 row_ror:8 row_mask:0xf bank_mask:0x3
    s_nop 1
    v_add_f32_dpp v40, v41, v41 row_ror:8 row_mask:0xf bank_mask:0xc
    s_waitcnt lgkmcnt(1)
    v_dot2_f32_bf16 v43, v16, v28, 0
    v_dot2_f32_bf16 v43, v17, v29, v43
    v_dot2_f32_bf16 v43, v18, v30, v43
    v_dot2_f32_bf16 v43, v19, v31, v43
    ds_read_b128 v[24:27], v10 offset:23552
    s_waitcnt vmcnt(4)
    buffer_load_dwordx4 v[164:167], v1, s[8:11], s7 offen offset:0 nt
    s_xor_b32 s7, s49, 0x62000
    v_dot2_f32_bf16 v44, v168, v28, 0
    v_dot2_f32_bf16 v44, v169, v29, v44
    v_dot2_f32_bf16 v44, v170, v30, v44
    v_dot2_f32_bf16 v44, v171, v31, v44
    v_add_f32_dpp v42, v42, v42 row_ror:8 row_mask:0xf bank_mask:0x3
    s_nop 1
    v_add_f32_dpp v42, v43, v43 row_ror:8 row_mask:0xf bank_mask:0xc
    s_waitcnt lgkmcnt(1)
    v_dot2_f32_bf16 v45, v20, v28, 0
    v_dot2_f32_bf16 v45, v21, v29, v45
    v_dot2_f32_bf16 v45, v22, v30, v45
    v_dot2_f32_bf16 v45, v23, v31, v45
    v_add_f32_dpp v40, v40, v40 row_shl:4 row_mask:0xf bank_mask:0x5
    s_nop 1
    v_add_f32_dpp v40, v42, v42 row_shr:4 row_mask:0xf bank_mask:0xa
    ds_read_b128 v[16:19], v10 offset:24576
    s_waitcnt vmcnt(4)
    buffer_load_dwordx4 v[168:171], v1, s[8:11], s7 offen offset:0 nt
    s_xor_b32 s7, s49, 0x63000
    v_dot2_f32_bf16 v46, v172, v28, 0
    v_dot2_f32_bf16 v46, v173, v29, v46
    v_dot2_f32_bf16 v46, v174, v30, v46
    v_dot2_f32_bf16 v46, v175, v31, v46
    v_add_f32_dpp v44, v44, v44 row_ror:8 row_mask:0xf bank_mask:0x3
    s_nop 1
    v_add_f32_dpp v44, v45, v45 row_ror:8 row_mask:0xf bank_mask:0xc
    s_waitcnt lgkmcnt(1)
    v_dot2_f32_bf16 v47, v24, v28, 0
    v_dot2_f32_bf16 v47, v25, v29, v47
    v_dot2_f32_bf16 v47, v26, v30, v47
    v_dot2_f32_bf16 v47, v27, v31, v47
    ds_read_b128 v[20:23], v10 offset:25600
    s_waitcnt vmcnt(4)
    buffer_load_dwordx4 v[172:175], v1, s[8:11], s7 offen offset:0 nt
    s_xor_b32 s7, s49, 0x64000
    v_dot2_f32_bf16 v48, v176, v28, 0
    v_dot2_f32_bf16 v48, v177, v29, v48
    v_dot2_f32_bf16 v48, v178, v30, v48
    v_dot2_f32_bf16 v48, v179, v31, v48
    v_add_f32_dpp v46, v46, v46 row_ror:8 row_mask:0xf bank_mask:0x3
    s_nop 1
    v_add_f32_dpp v46, v47, v47 row_ror:8 row_mask:0xf bank_mask:0xc
    s_waitcnt lgkmcnt(1)
    v_dot2_f32_bf16 v49, v16, v28, 0
    v_dot2_f32_bf16 v49, v17, v29, v49
    v_dot2_f32_bf16 v49, v18, v30, v49
    v_dot2_f32_bf16 v49, v19, v31, v49
    v_add_f32_dpp v44, v44, v44 row_shl:4 row_mask:0xf bank_mask:0x5
    s_nop 1
    v_add_f32_dpp v44, v46, v46 row_shr:4 row_mask:0xf bank_mask:0xa
    ds_read_b128 v[24:27], v10 offset:26624
    s_waitcnt vmcnt(4)
    buffer_load_dwordx4 v[176:179], v1, s[8:11], s7 offen offset:0 nt
    s_xor_b32 s7, s49, 0x65000
    v_dot2_f32_bf16 v50, v180, v28, 0
    v_dot2_f32_bf16 v50, v181, v29, v50
    v_dot2_f32_bf16 v50, v182, v30, v50
    v_dot2_f32_bf16 v50, v183, v31, v50
    v_add_f32_dpp v40, v40, v40 quad_perm:[2,3,0,1] row_mask:0xf bank_mask:0xf
    v_add_f32_dpp v44, v44, v44 quad_perm:[2,3,0,1] row_mask:0xf bank_mask:0xf
    v_cndmask_b32 v40, v40, v44, s[44:45]
    v_add_f32_dpp v48, v48, v48 row_ror:8 row_mask:0xf bank_mask:0x3
    s_nop 1
    v_add_f32_dpp v48, v49, v49 row_ror:8 row_mask:0xf bank_mask:0xc
    s_waitcnt lgkmcnt(1)
    v_dot2_f32_bf16 v51, v20, v28, 0
    v_dot2_f32_bf16 v51, v21, v29, v51
    v_dot2_f32_bf16 v51, v22, v30, v51
    v_dot2_f32_bf16 v51, v23, v31, v51
    v_add_f32_dpp v32, v32, v32 quad_perm:[1,0,3,2] row_mask:0xf bank_mask:0xf
    v_add_f32_dpp v40, v40, v40 quad_perm:[1,0,3,2] row_mask:0xf bank_mask:0xf
    v_cndmask_b32 v32, v32, v40, s[46:47]
    v_cvt_pk_bf16_f32 v80, v32, v32
    v_and_b32 v80, s92, v80
    v_mul_f32 v80, 0x3db504f3, v80
    v_cvt_pk_bf16_f32 v66, v80, v80
    v_and_b32 v66, s92, v66
    v_max_f32 v81, v81, v66
    ds_read_b128 v[16:19], v10 offset:27648
    s_waitcnt vmcnt(4)
    buffer_load_dwordx4 v[180:183], v1, s[8:11], s7 offen offset:0 nt
    s_xor_b32 s7, s49, 0x66000
    v_dot2_f32_bf16 v52, v184, v28, 0
    v_dot2_f32_bf16 v52, v185, v29, v52
    v_dot2_f32_bf16 v52, v186, v30, v52
    v_dot2_f32_bf16 v52, v187, v31, v52
    v_add_f32_dpp v50, v50, v50 row_ror:8 row_mask:0xf bank_mask:0x3
    s_nop 1
    v_add_f32_dpp v50, v51, v51 row_ror:8 row_mask:0xf bank_mask:0xc
    s_waitcnt lgkmcnt(1)
    v_dot2_f32_bf16 v53, v24, v28, 0
    v_dot2_f32_bf16 v53, v25, v29, v53
    v_dot2_f32_bf16 v53, v26, v30, v53
    v_dot2_f32_bf16 v53, v27, v31, v53
    v_add_f32_dpp v48, v48, v48 row_shl:4 row_mask:0xf bank_mask:0x5
    s_nop 1
    v_add_f32_dpp v48, v50, v50 row_shr:4 row_mask:0xf bank_mask:0xa
    ds_read_b128 v[20:23], v10 offset:28672
    s_waitcnt vmcnt(4)
    buffer_load_dwordx4 v[184:187], v1, s[8:11], s7 offen offset:0 nt
    s_xor_b32 s7, s49, 0x67000
    v_dot2_f32_bf16 v54, v188, v28, 0
    v_dot2_f32_bf16 v54, v189, v29, v54
    v_dot2_f32_bf16 v54, v190, v30, v54
    v_dot2_f32_bf16 v54, v191, v31, v54
    v_add_f32_dpp v52, v52, v52 row_ror:8 row_mask:0xf bank_mask:0x3
    s_nop 1
    v_add_f32_dpp v52, v53, v53 row_ror:8 row_mask:0xf bank_mask:0xc
    s_waitcnt lgkmcnt(1)
    v_dot2_f32_bf16 v55, v16, v28, 0
    v_dot2_f32_bf16 v55, v17, v29, v55
    v_dot2_f32_bf16 v55, v18, v30, v55
    v_dot2_f32_bf16 v55, v19, v31, v55
    ds_read_b128 v[24:27], v10 offset:29696
    s_waitcnt vmcnt(4)
    buffer_load_dwordx4 v[188:191], v1, s[8:11], s7 offen offset:0 nt
    s_xor_b32 s7, s49, 0x68000
    v_dot2_f32_bf16 v56, v192, v28, 0
    v_dot2_f32_bf16 v56, v193, v29, v56
    v_dot2_f32_bf16 v56, v194, v30, v56
    v_dot2_f32_bf16 v56, v195, v31, v56
    v_add_f32_dpp v54, v54, v54 row_ror:8 row_mask:0xf bank_mask:0x3
    s_nop 1
    v_add_f32_dpp v54, v55, v55 row_ror:8 row_mask:0xf bank_mask:0xc
    s_waitcnt lgkmcnt(1)
    v_dot2_f32_bf16 v57, v20, v28, 0
    v_dot2_f32_bf16 v57, v21, v29, v57
    v_dot2_f32_bf16 v57, v22, v30, v57
    v_dot2_f32_bf16 v57, v23, v31, v57
    v_add_f32_dpp v52, v52, v52 row_shl:4 row_mask:0xf bank_mask:0x5
    s_nop 1
    v_add_f32_dpp v52, v54, v54 row_shr:4 row_mask:0xf bank_mask:0xa
    ds_read_b128 v[16:19], v10 offset:30720
    s_waitcnt vmcnt(4)
    buffer_load_dwordx4 v[192:195], v1, s[8:11], s7 offen offset:0 nt
    s_xor_b32 s7, s49, 0x69000
    v_dot2_f32_bf16 v58, v196, v28, 0
    v_dot2_f32_bf16 v58, v197, v29, v58
    v_dot2_f32_bf16 v58, v198, v30, v58
    v_dot2_f32_bf16 v58, v199, v31, v58
    v_add_f32_dpp v48, v48, v48 quad_perm:[2,3,0,1] row_mask:0xf bank_mask:0xf
    v_add_f32_dpp v52, v52, v52 quad_perm:[2,3,0,1] row_mask:0xf bank_mask:0xf
    v_cndmask_b32 v48, v48, v52, s[44:45]
    v_add_f32_dpp v56, v56, v56 row_ror:8 row_mask:0xf bank_mask:0x3
    s_nop 1
    v_add_f32_dpp v56, v57, v57 row_ror:8 row_mask:0xf bank_mask:0xc
    s_waitcnt lgkmcnt(1)
    v_dot2_f32_bf16 v59, v24, v28, 0
    v_dot2_f32_bf16 v59, v25, v29, v59
    v_dot2_f32_bf16 v59, v26, v30, v59
    v_dot2_f32_bf16 v59, v27, v31, v59
    ds_read_b128 v[20:23], v10 offset:31744
    s_waitcnt vmcnt(4)
    buffer_load_dwordx4 v[196:199], v1, s[8:11], s7 offen offset:0 nt
    s_xor_b32 s7, s49, 0x6a000
    v_dot2_f32_bf16 v60, v200, v28, 0
    v_dot2_f32_bf16 v60, v201, v29, v60
    v_dot2_f32_bf16 v60, v202, v30, v60
    v_dot2_f32_bf16 v60, v203, v31, v60
    v_add_f32_dpp v58, v58, v58 row_ror:8 row_mask:0xf bank_mask:0x3
    s_nop 1
    v_add_f32_dpp v58, v59, v59 row_ror:8 row_mask:0xf bank_mask:0xc
    s_waitcnt lgkmcnt(1)
    v_dot2_f32_bf16 v61, v16, v28, 0
    v_dot2_f32_bf16 v61, v17, v29, v61
    v_dot2_f32_bf16 v61, v18, v30, v61
    v_dot2_f32_bf16 v61, v19, v31, v61
    v_add_f32_dpp v56, v56, v56 row_shl:4 row_mask:0xf bank_mask:0x5
    s_nop 1
    v_add_f32_dpp v56, v58, v58 row_shr:4 row_mask:0xf bank_mask:0xa
    ds_read_b128 v[24:27], v10 offset:32768
    s_waitcnt vmcnt(4)
    buffer_load_dwordx4 v[200:203], v1, s[8:11], s7 offen offset:0 nt
    s_xor_b32 s7, s49, 0x6b000
    v_dot2_f32_bf16 v62, v204, v28, 0
    v_dot2_f32_bf16 v62, v205, v29, v62
    v_dot2_f32_bf16 v62, v206, v30, v62
    v_dot2_f32_bf16 v62, v207, v31, v62
    v_add_f32_dpp v60, v60, v60 row_ror:8 row_mask:0xf bank_mask:0x3
    s_nop 1
    v_add_f32_dpp v60, v61, v61 row_ror:8 row_mask:0xf bank_mask:0xc
    s_waitcnt lgkmcnt(1)
    v_dot2_f32_bf16 v63, v20, v28, 0
    v_dot2_f32_bf16 v63, v21, v29, v63
    v_dot2_f32_bf16 v63, v22, v30, v63
    v_dot2_f32_bf16 v63, v23, v31, v63
    ds_read_b128 v[16:19], v10 offset:33792
    s_waitcnt vmcnt(4)
    buffer_load_dwordx4 v[204:207], v1, s[8:11], s7 offen offset:0 nt
    s_xor_b32 s7, s49, 0x6c000
    v_dot2_f32_bf16 v32, v208, v28, 0
    v_dot2_f32_bf16 v32, v209, v29, v32
    v_dot2_f32_bf16 v32, v210, v30, v32
    v_dot2_f32_bf16 v32, v211, v31, v32
    v_add_f32_dpp v62, v62, v62 row_ror:8 row_mask:0xf bank_mask:0x3
    s_nop 1
    v_add_f32_dpp v62, v63, v63 row_ror:8 row_mask:0xf bank_mask:0xc
    s_waitcnt lgkmcnt(1)
    v_dot2_f32_bf16 v33, v24, v28, 0
    v_dot2_f32_bf16 v33, v25, v29, v33
    v_dot2_f32_bf16 v33, v26, v30, v33
    v_dot2_f32_bf16 v33, v27, v31, v33
    v_add_f32_dpp v60, v60, v60 row_shl:4 row_mask:0xf bank_mask:0x5
    s_nop 1
    v_add_f32_dpp v60, v62, v62 row_shr:4 row_mask:0xf bank_mask:0xa
    ds_read_b128 v[20:23], v10 offset:34816
    s_waitcnt vmcnt(4)
    buffer_load_dwordx4 v[208:211], v1, s[8:11], s7 offen offset:0 nt
    s_xor_b32 s7, s49, 0x6d000
    v_dot2_f32_bf16 v34, v212, v28, 0
    v_dot2_f32_bf16 v34, v213, v29, v34
    v_dot2_f32_bf16 v34, v214, v30, v34
    v_dot2_f32_bf16 v34, v215, v31, v34
    v_add_f32_dpp v56, v56, v56 quad_perm:[2,3,0,1] row_mask:0xf bank_mask:0xf
    v_add_f32_dpp v60, v60, v60 quad_perm:[2,3,0,1] row_mask:0xf bank_mask:0xf
    v_cndmask_b32 v56, v56, v60, s[44:45]
    v_add_f32_dpp v32, v32, v32 row_ror:8 row_mask:0xf bank_mask:0x3
    s_nop 1
    v_add_f32_dpp v32, v33, v33 row_ror:8 row_mask:0xf bank_mask:0xc
    s_waitcnt lgkmcnt(1)
    v_dot2_f32_bf16 v35, v16, v28, 0
    v_dot2_f32_bf16 v35, v17, v29, v35
    v_dot2_f32_bf16 v35, v18, v30, v35
    v_dot2_f32_bf16 v35, v19, v31, v35
    v_add_f32_dpp v48, v48, v48 quad_perm:[1,0,3,2] row_mask:0xf bank_mask:0xf
    v_add_f32_dpp v56, v56, v56 quad_perm:[1,0,3,2] row_mask:0xf bank_mask:0xf
    v_cndmask_b32 v48, v48, v56, s[46:47]
    v_cvt_pk_bf16_f32 v80, v48, v48
    v_and_b32 v80, s92, v80
    v_mul_f32 v80, 0x3db504f3, v80
    v_cvt_pk_bf16_f32 v67, v80, v80
    v_and_b32 v67, s92, v67
    v_max_f32 v81, v81, v67
    ds_read_b128 v[24:27], v10 offset:35840
    s_waitcnt vmcnt(4)
    buffer_load_dwordx4 v[212:215], v1, s[8:11], s7 offen offset:0 nt
    s_xor_b32 s7, s49, 0x6e000
    v_dot2_f32_bf16 v36, v216, v28, 0
    v_dot2_f32_bf16 v36, v217, v29, v36
    v_dot2_f32_bf16 v36, v218, v30, v36
    v_dot2_f32_bf16 v36, v219, v31, v36
    v_add_f32_dpp v34, v34, v34 row_ror:8 row_mask:0xf bank_mask:0x3
    s_nop 1
    v_add_f32_dpp v34, v35, v35 row_ror:8 row_mask:0xf bank_mask:0xc
    s_waitcnt lgkmcnt(1)
    v_dot2_f32_bf16 v37, v20, v28, 0
    v_dot2_f32_bf16 v37, v21, v29, v37
    v_dot2_f32_bf16 v37, v22, v30, v37
    v_dot2_f32_bf16 v37, v23, v31, v37
    v_add_f32_dpp v32, v32, v32 row_shl:4 row_mask:0xf bank_mask:0x5
    s_nop 1
    v_add_f32_dpp v32, v34, v34 row_shr:4 row_mask:0xf bank_mask:0xa
    s_waitcnt vmcnt(4)
    buffer_load_dwordx4 v[216:219], v1, s[8:11], s7 offen offset:0 nt
    s_xor_b32 s7, s49, 0x6f000
    v_dot2_f32_bf16 v38, v220, v28, 0
    v_dot2_f32_bf16 v38, v221, v29, v38
    v_dot2_f32_bf16 v38, v222, v30, v38
    v_dot2_f32_bf16 v38, v223, v31, v38
    v_add_f32_dpp v36, v36, v36 row_ror:8 row_mask:0xf bank_mask:0x3
    s_nop 1
    v_add_f32_dpp v36, v37, v37 row_ror:8 row_mask:0xf bank_mask:0xc
    s_waitcnt lgkmcnt(0)
    v_dot2_f32_bf16 v39, v24, v28, 0
    v_dot2_f32_bf16 v39, v25, v29, v39
    v_dot2_f32_bf16 v39, v26, v30, v39
    v_dot2_f32_bf16 v39, v27, v31, v39
    s_waitcnt vmcnt(4)
    buffer_load_dwordx4 v[220:223], v1, s[8:11], s7 offen offset:0 nt
    s_xor_b32 s7, s49, 0x70000
    v_dot2_f32_bf16 v40, v224, v28, 0
    v_dot2_f32_bf16 v40, v225, v29, v40
    v_dot2_f32_bf16 v40, v226, v30, v40
    v_dot2_f32_bf16 v40, v227, v31, v40
    v_add_f32_dpp v38, v38, v38 row_ror:8 row_mask:0xf bank_mask:0x3
    s_nop 1
    v_add_f32_dpp v38, v39, v39 row_ror:8 row_mask:0xf bank_mask:0xc
    v_dot2_f32_bf16 v41, v228, v28, 0
    v_dot2_f32_bf16 v41, v229, v29, v41
    v_dot2_f32_bf16 v41, v230, v30, v41
    v_dot2_f32_bf16 v41, v231, v31, v41
    v_add_f32_dpp v36, v36, v36 row_shl:4 row_mask:0xf bank_mask:0x5
    s_nop 1
    v_add_f32_dpp v36, v38, v38 row_shr:4 row_mask:0xf bank_mask:0xa
    s_waitcnt vmcnt(4)
    buffer_load_dwordx4 v[224:227], v1, s[8:11], s7 offen offset:0 nt
    s_xor_b32 s7, s49, 0x71000
    v_dot2_f32_bf16 v42, v232, v28, 0
    v_dot2_f32_bf16 v42, v233, v29, v42
    v_dot2_f32_bf16 v42, v234, v30, v42
    v_dot2_f32_bf16 v42, v235, v31, v42
    v_add_f32_dpp v32, v32, v32 quad_perm:[2,3,0,1] row_mask:0xf bank_mask:0xf
    v_add_f32_dpp v36, v36, v36 quad_perm:[2,3,0,1] row_mask:0xf bank_mask:0xf
    v_cndmask_b32 v32, v32, v36, s[44:45]
    v_add_f32_dpp v40, v40, v40 row_ror:8 row_mask:0xf bank_mask:0x3
    s_nop 1
    v_add_f32_dpp v40, v41, v41 row_ror:8 row_mask:0xf bank_mask:0xc
    v_dot2_f32_bf16 v43, v236, v28, 0
    v_dot2_f32_bf16 v43, v237, v29, v43
    v_dot2_f32_bf16 v43, v238, v30, v43
    v_dot2_f32_bf16 v43, v239, v31, v43
    s_waitcnt vmcnt(4)
    buffer_load_dwordx4 v[228:231], v1, s[8:11], s7 offen offset:0 nt
    s_xor_b32 s7, s49, 0x72000
    v_dot2_f32_bf16 v44, v240, v28, 0
    v_dot2_f32_bf16 v44, v241, v29, v44
    v_dot2_f32_bf16 v44, v242, v30, v44
    v_dot2_f32_bf16 v44, v243, v31, v44
    v_add_f32_dpp v42, v42, v42 row_ror:8 row_mask:0xf bank_mask:0x3
    s_nop 1
    v_add_f32_dpp v42, v43, v43 row_ror:8 row_mask:0xf bank_mask:0xc
    v_dot2_f32_bf16 v45, v244, v28, 0
    v_dot2_f32_bf16 v45, v245, v29, v45
    v_dot2_f32_bf16 v45, v246, v30, v45
    v_dot2_f32_bf16 v45, v247, v31, v45
    v_add_f32_dpp v40, v40, v40 row_shl:4 row_mask:0xf bank_mask:0x5
    s_nop 1
    v_add_f32_dpp v40, v42, v42 row_shr:4 row_mask:0xf bank_mask:0xa
    s_waitcnt vmcnt(4)
    buffer_load_dwordx4 v[232:235], v1, s[8:11], s7 offen offset:0 nt
    s_xor_b32 s7, s49, 0x73000
    v_dot2_f32_bf16 v46, v248, v28, 0
    v_dot2_f32_bf16 v46, v249, v29, v46
    v_dot2_f32_bf16 v46, v250, v30, v46
    v_dot2_f32_bf16 v46, v251, v31, v46
    v_add_f32_dpp v44, v44, v44 row_ror:8 row_mask:0xf bank_mask:0x3
    s_nop 1
    v_add_f32_dpp v44, v45, v45 row_ror:8 row_mask:0xf bank_mask:0xc
    v_dot2_f32_bf16 v47, v252, v28, 0
    v_dot2_f32_bf16 v47, v253, v29, v47
    v_dot2_f32_bf16 v47, v254, v30, v47
    v_dot2_f32_bf16 v47, v255, v31, v47
    s_waitcnt vmcnt(4)
    buffer_load_dwordx4 v[236:239], v1, s[8:11], s7 offen offset:0 nt
    s_xor_b32 s7, s49, 0x74000
    v_dot2_f32_bf16 v48, v96, v28, 0
    v_dot2_f32_bf16 v48, v97, v29, v48
    v_dot2_f32_bf16 v48, v98, v30, v48
    v_dot2_f32_bf16 v48, v99, v31, v48
    v_add_f32_dpp v46, v46, v46 row_ror:8 row_mask:0xf bank_mask:0x3
    s_nop 1
    v_add_f32_dpp v46, v47, v47 row_ror:8 row_mask:0xf bank_mask:0xc
    v_dot2_f32_bf16 v49, v100, v28, 0
    v_dot2_f32_bf16 v49, v101, v29, v49
    v_dot2_f32_bf16 v49, v102, v30, v49
    v_dot2_f32_bf16 v49, v103, v31, v49
    v_add_f32_dpp v44, v44, v44 row_shl:4 row_mask:0xf bank_mask:0x5
    s_nop 1
    v_add_f32_dpp v44, v46, v46 row_shr:4 row_mask:0xf bank_mask:0xa
    s_waitcnt vmcnt(4)
    buffer_load_dwordx4 v[240:243], v1, s[8:11], s7 offen offset:0 nt
    s_xor_b32 s7, s49, 0x75000
    v_dot2_f32_bf16 v50, v104, v28, 0
    v_dot2_f32_bf16 v50, v105, v29, v50
    v_dot2_f32_bf16 v50, v106, v30, v50
    v_dot2_f32_bf16 v50, v107, v31, v50
    v_add_f32_dpp v40, v40, v40 quad_perm:[2,3,0,1] row_mask:0xf bank_mask:0xf
    v_add_f32_dpp v44, v44, v44 quad_perm:[2,3,0,1] row_mask:0xf bank_mask:0xf
    v_cndmask_b32 v40, v40, v44, s[44:45]
    v_add_f32_dpp v48, v48, v48 row_ror:8 row_mask:0xf bank_mask:0x3
    s_nop 1
    v_add_f32_dpp v48, v49, v49 row_ror:8 row_mask:0xf bank_mask:0xc
    v_dot2_f32_bf16 v51, v108, v28, 0
    v_dot2_f32_bf16 v51, v109, v29, v51
    v_dot2_f32_bf16 v51, v110, v30, v51
    v_dot2_f32_bf16 v51, v111, v31, v51
    v_add_f32_dpp v32, v32, v32 quad_perm:[1,0,3,2] row_mask:0xf bank_mask:0xf
    v_add_f32_dpp v40, v40, v40 quad_perm:[1,0,3,2] row_mask:0xf bank_mask:0xf
    v_cndmask_b32 v32, v32, v40, s[46:47]
    v_cvt_pk_bf16_f32 v80, v32, v32
    v_and_b32 v80, s92, v80
    v_mul_f32 v80, 0x3db504f3, v80
    v_cvt_pk_bf16_f32 v68, v80, v80
    v_and_b32 v68, s92, v68
    v_max_f32 v81, v81, v68
    s_waitcnt vmcnt(4)
    buffer_load_dwordx4 v[244:247], v1, s[8:11], s7 offen offset:0 nt
    s_xor_b32 s7, s49, 0x76000
    v_dot2_f32_bf16 v52, v112, v28, 0
    v_dot2_f32_bf16 v52, v113, v29, v52
    v_dot2_f32_bf16 v52, v114, v30, v52
    v_dot2_f32_bf16 v52, v115, v31, v52
    v_add_f32_dpp v50, v50, v50 row_ror:8 row_mask:0xf bank_mask:0x3
    s_nop 1
    v_add_f32_dpp v50, v51, v51 row_ror:8 row_mask:0xf bank_mask:0xc
    v_dot2_f32_bf16 v53, v116, v28, 0
    v_dot2_f32_bf16 v53, v117, v29, v53
    v_dot2_f32_bf16 v53, v118, v30, v53
    v_dot2_f32_bf16 v53, v119, v31, v53
    v_add_f32_dpp v48, v48, v48 row_shl:4 row_mask:0xf bank_mask:0x5
    s_nop 1
    v_add_f32_dpp v48, v50, v50 row_shr:4 row_mask:0xf bank_mask:0xa
    s_waitcnt vmcnt(4)
    buffer_load_dwordx4 v[248:251], v1, s[8:11], s7 offen offset:0 nt
    s_xor_b32 s7, s49, 0x77000
    v_dot2_f32_bf16 v54, v120, v28, 0
    v_dot2_f32_bf16 v54, v121, v29, v54
    v_dot2_f32_bf16 v54, v122, v30, v54
    v_dot2_f32_bf16 v54, v123, v31, v54
    v_add_f32_dpp v52, v52, v52 row_ror:8 row_mask:0xf bank_mask:0x3
    s_nop 1
    v_add_f32_dpp v52, v53, v53 row_ror:8 row_mask:0xf bank_mask:0xc
    v_dot2_f32_bf16 v55, v124, v28, 0
    v_dot2_f32_bf16 v55, v125, v29, v55
    v_dot2_f32_bf16 v55, v126, v30, v55
    v_dot2_f32_bf16 v55, v127, v31, v55
    s_waitcnt vmcnt(4)
    buffer_load_dwordx4 v[252:255], v1, s[8:11], s7 offen offset:0 nt
    s_xor_b32 s7, s49, 0x78000
    v_dot2_f32_bf16 v56, v128, v28, 0
    v_dot2_f32_bf16 v56, v129, v29, v56
    v_dot2_f32_bf16 v56, v130, v30, v56
    v_dot2_f32_bf16 v56, v131, v31, v56
    v_add_f32_dpp v54, v54, v54 row_ror:8 row_mask:0xf bank_mask:0x3
    s_nop 1
    v_add_f32_dpp v54, v55, v55 row_ror:8 row_mask:0xf bank_mask:0xc
    v_dot2_f32_bf16 v57, v132, v28, 0
    v_dot2_f32_bf16 v57, v133, v29, v57
    v_dot2_f32_bf16 v57, v134, v30, v57
    v_dot2_f32_bf16 v57, v135, v31, v57
    v_add_f32_dpp v52, v52, v52 row_shl:4 row_mask:0xf bank_mask:0x5
    s_nop 1
    v_add_f32_dpp v52, v54, v54 row_shr:4 row_mask:0xf bank_mask:0xa
    s_waitcnt vmcnt(4)
    buffer_load_dwordx4 v[96:99], v1, s[8:11], s7 offen offset:0 nt
    s_xor_b32 s7, s49, 0x79000
    v_dot2_f32_bf16 v58, v136, v28, 0
    v_dot2_f32_bf16 v58, v137, v29, v58
    v_dot2_f32_bf16 v58, v138, v30, v58
    v_dot2_f32_bf16 v58, v139, v31, v58
    v_add_f32_dpp v48, v48, v48 quad_perm:[2,3,0,1] row_mask:0xf bank_mask:0xf
    v_add_f32_dpp v52, v52, v52 quad_perm:[2,3,0,1] row_mask:0xf bank_mask:0xf
    v_cndmask_b32 v48, v48, v52, s[44:45]
    v_add_f32_dpp v56, v56, v56 row_ror:8 row_mask:0xf bank_mask:0x3
    s_nop 1
    v_add_f32_dpp v56, v57, v57 row_ror:8 row_mask:0xf bank_mask:0xc
    v_dot2_f32_bf16 v59, v140, v28, 0
    v_dot2_f32_bf16 v59, v141, v29, v59
    v_dot2_f32_bf16 v59, v142, v30, v59
    v_dot2_f32_bf16 v59, v143, v31, v59
    s_waitcnt vmcnt(4)
    buffer_load_dwordx4 v[100:103], v1, s[8:11], s7 offen offset:0 nt
    s_xor_b32 s7, s49, 0x7a000
    v_dot2_f32_bf16 v60, v144, v28, 0
    v_dot2_f32_bf16 v60, v145, v29, v60
    v_dot2_f32_bf16 v60, v146, v30, v60
    v_dot2_f32_bf16 v60, v147, v31, v60
    v_add_f32_dpp v58, v58, v58 row_ror:8 row_mask:0xf bank_mask:0x3
    s_nop 1
    v_add_f32_dpp v58, v59, v59 row_ror:8 row_mask:0xf bank_mask:0xc
    v_dot2_f32_bf16 v61, v148, v28, 0
    v_dot2_f32_bf16 v61, v149, v29, v61
    v_dot2_f32_bf16 v61, v150, v30, v61
    v_dot2_f32_bf16 v61, v151, v31, v61
    v_add_f32_dpp v56, v56, v56 row_shl:4 row_mask:0xf bank_mask:0x5
    s_nop 1
    v_add_f32_dpp v56, v58, v58 row_shr:4 row_mask:0xf bank_mask:0xa
    s_waitcnt vmcnt(4)
    buffer_load_dwordx4 v[104:107], v1, s[8:11], s7 offen offset:0 nt
    s_xor_b32 s7, s49, 0x7b000
    v_dot2_f32_bf16 v62, v152, v28, 0
    v_dot2_f32_bf16 v62, v153, v29, v62
    v_dot2_f32_bf16 v62, v154, v30, v62
    v_dot2_f32_bf16 v62, v155, v31, v62
    v_add_f32_dpp v60, v60, v60 row_ror:8 row_mask:0xf bank_mask:0x3
    s_nop 1
    v_add_f32_dpp v60, v61, v61 row_ror:8 row_mask:0xf bank_mask:0xc
    v_dot2_f32_bf16 v63, v156, v28, 0
    v_dot2_f32_bf16 v63, v157, v29, v63
    v_dot2_f32_bf16 v63, v158, v30, v63
    v_dot2_f32_bf16 v63, v159, v31, v63
    s_waitcnt vmcnt(4)
    buffer_load_dwordx4 v[108:111], v1, s[8:11], s7 offen offset:0 nt
    s_xor_b32 s7, s49, 0x7c000
    v_dot2_f32_bf16 v32, v160, v28, 0
    v_dot2_f32_bf16 v32, v161, v29, v32
    v_dot2_f32_bf16 v32, v162, v30, v32
    v_dot2_f32_bf16 v32, v163, v31, v32
    v_add_f32_dpp v62, v62, v62 row_ror:8 row_mask:0xf bank_mask:0x3
    s_nop 1
    v_add_f32_dpp v62, v63, v63 row_ror:8 row_mask:0xf bank_mask:0xc
    v_dot2_f32_bf16 v33, v164, v28, 0
    v_dot2_f32_bf16 v33, v165, v29, v33
    v_dot2_f32_bf16 v33, v166, v30, v33
    v_dot2_f32_bf16 v33, v167, v31, v33
    v_add_f32_dpp v60, v60, v60 row_shl:4 row_mask:0xf bank_mask:0x5
    s_nop 1
    v_add_f32_dpp v60, v62, v62 row_shr:4 row_mask:0xf bank_mask:0xa
    s_waitcnt vmcnt(4)
    buffer_load_dwordx4 v[112:115], v1, s[8:11], s7 offen offset:0 nt
    s_xor_b32 s7, s49, 0x7d000
    v_dot2_f32_bf16 v34, v168, v28, 0
    v_dot2_f32_bf16 v34, v169, v29, v34
    v_dot2_f32_bf16 v34, v170, v30, v34
    v_dot2_f32_bf16 v34, v171, v31, v34
    v_add_f32_dpp v56, v56, v56 quad_perm:[2,3,0,1] row_mask:0xf bank_mask:0xf
    v_add_f32_dpp v60, v60, v60 quad_perm:[2,3,0,1] row_mask:0xf bank_mask:0xf
    v_cndmask_b32 v56, v56, v60, s[44:45]
    v_add_f32_dpp v32, v32, v32 row_ror:8 row_mask:0xf bank_mask:0x3
    s_nop 1
    v_add_f32_dpp v32, v33, v33 row_ror:8 row_mask:0xf bank_mask:0xc
    v_dot2_f32_bf16 v35, v172, v28, 0
    v_dot2_f32_bf16 v35, v173, v29, v35
    v_dot2_f32_bf16 v35, v174, v30, v35
    v_dot2_f32_bf16 v35, v175, v31, v35
    v_add_f32_dpp v48, v48, v48 quad_perm:[1,0,3,2] row_mask:0xf bank_mask:0xf
    v_add_f32_dpp v56, v56, v56 quad_perm:[1,0,3,2] row_mask:0xf bank_mask:0xf
    v_cndmask_b32 v48, v48, v56, s[46:47]
    v_cvt_pk_bf16_f32 v80, v48, v48
    v_and_b32 v80, s92, v80
    v_mul_f32 v80, 0x3db504f3, v80
    v_cvt_pk_bf16_f32 v69, v80, v80
    v_and_b32 v69, s92, v69
    v_max_f32 v81, v81, v69
    s_waitcnt vmcnt(4)
    buffer_load_dwordx4 v[116:119], v1, s[8:11], s7 offen offset:0 nt
    s_xor_b32 s7, s49, 0x7e000
    v_dot2_f32_bf16 v36, v176, v28, 0
    v_dot2_f32_bf16 v36, v177, v29, v36
    v_dot2_f32_bf16 v36, v178, v30, v36
    v_dot2_f32_bf16 v36, v179, v31, v36
    v_add_f32_dpp v34, v34, v34 row_ror:8 row_mask:0xf bank_mask:0x3
    s_nop 1
    v_add_f32_dpp v34, v35, v35 row_ror:8 row_mask:0xf bank_mask:0xc
    v_dot2_f32_bf16 v37, v180, v28, 0
    v_dot2_f32_bf16 v37, v181, v29, v37
    v_dot2_f32_bf16 v37, v182, v30, v37
    v_dot2_f32_bf16 v37, v183, v31, v37
    v_add_f32_dpp v32, v32, v32 row_shl:4 row_mask:0xf bank_mask:0x5
    s_nop 1
    v_add_f32_dpp v32, v34, v34 row_shr:4 row_mask:0xf bank_mask:0xa
    s_waitcnt vmcnt(4)
    buffer_load_dwordx4 v[120:123], v1, s[8:11], s7 offen offset:0 nt
    s_xor_b32 s7, s49, 0x7f000
    v_dot2_f32_bf16 v38, v184, v28, 0
    v_dot2_f32_bf16 v38, v185, v29, v38
    v_dot2_f32_bf16 v38, v186, v30, v38
    v_dot2_f32_bf16 v38, v187, v31, v38
    v_add_f32_dpp v36, v36, v36 row_ror:8 row_mask:0xf bank_mask:0x3
    s_nop 1
    v_add_f32_dpp v36, v37, v37 row_ror:8 row_mask:0xf bank_mask:0xc
    v_dot2_f32_bf16 v39, v188, v28, 0
    v_dot2_f32_bf16 v39, v189, v29, v39
    v_dot2_f32_bf16 v39, v190, v30, v39
    v_dot2_f32_bf16 v39, v191, v31, v39
    s_waitcnt vmcnt(4)
    buffer_load_dwordx4 v[124:127], v1, s[8:11], s7 offen offset:0 nt
    s_xor_b32 s7, s49, 0x80000
    v_dot2_f32_bf16 v40, v192, v28, 0
    v_dot2_f32_bf16 v40, v193, v29, v40
    v_dot2_f32_bf16 v40, v194, v30, v40
    v_dot2_f32_bf16 v40, v195, v31, v40
    v_add_f32_dpp v38, v38, v38 row_ror:8 row_mask:0xf bank_mask:0x3
    s_nop 1
    v_add_f32_dpp v38, v39, v39 row_ror:8 row_mask:0xf bank_mask:0xc
    v_dot2_f32_bf16 v41, v196, v28, 0
    v_dot2_f32_bf16 v41, v197, v29, v41
    v_dot2_f32_bf16 v41, v198, v30, v41
    v_dot2_f32_bf16 v41, v199, v31, v41
    v_add_f32_dpp v36, v36, v36 row_shl:4 row_mask:0xf bank_mask:0x5
    s_nop 1
    v_add_f32_dpp v36, v38, v38 row_shr:4 row_mask:0xf bank_mask:0xa
    s_waitcnt vmcnt(4)
    buffer_load_dwordx4 v[128:131], v1, s[8:11], s7 offen offset:0 nt
    s_xor_b32 s7, s49, 0x81000
    v_dot2_f32_bf16 v42, v200, v28, 0
    v_dot2_f32_bf16 v42, v201, v29, v42
    v_dot2_f32_bf16 v42, v202, v30, v42
    v_dot2_f32_bf16 v42, v203, v31, v42
    v_add_f32_dpp v32, v32, v32 quad_perm:[2,3,0,1] row_mask:0xf bank_mask:0xf
    v_add_f32_dpp v36, v36, v36 quad_perm:[2,3,0,1] row_mask:0xf bank_mask:0xf
    v_cndmask_b32 v32, v32, v36, s[44:45]
    v_add_f32_dpp v40, v40, v40 row_ror:8 row_mask:0xf bank_mask:0x3
    s_nop 1
    v_add_f32_dpp v40, v41, v41 row_ror:8 row_mask:0xf bank_mask:0xc
    v_dot2_f32_bf16 v43, v204, v28, 0
    v_dot2_f32_bf16 v43, v205, v29, v43
    v_dot2_f32_bf16 v43, v206, v30, v43
    v_dot2_f32_bf16 v43, v207, v31, v43
    s_waitcnt vmcnt(4)
    buffer_load_dwordx4 v[132:135], v1, s[8:11], s7 offen offset:0 nt
    s_xor_b32 s7, s49, 0x82000
    v_dot2_f32_bf16 v44, v208, v28, 0
    v_dot2_f32_bf16 v44, v209, v29, v44
    v_dot2_f32_bf16 v44, v210, v30, v44
    v_dot2_f32_bf16 v44, v211, v31, v44
    v_add_f32_dpp v42, v42, v42 row_ror:8 row_mask:0xf bank_mask:0x3
    s_nop 1
    v_add_f32_dpp v42, v43, v43 row_ror:8 row_mask:0xf bank_mask:0xc
    v_dot2_f32_bf16 v45, v212, v28, 0
    v_dot2_f32_bf16 v45, v213, v29, v45
    v_dot2_f32_bf16 v45, v214, v30, v45
    v_dot2_f32_bf16 v45, v215, v31, v45
    v_add_f32_dpp v40, v40, v40 row_shl:4 row_mask:0xf bank_mask:0x5
    s_nop 1
    v_add_f32_dpp v40, v42, v42 row_shr:4 row_mask:0xf bank_mask:0xa
    s_waitcnt vmcnt(4)
    buffer_load_dwordx4 v[136:139], v1, s[8:11], s7 offen offset:0 nt
    s_xor_b32 s7, s49, 0x83000
    v_dot2_f32_bf16 v46, v216, v28, 0
    v_dot2_f32_bf16 v46, v217, v29, v46
    v_dot2_f32_bf16 v46, v218, v30, v46
    v_dot2_f32_bf16 v46, v219, v31, v46
    v_add_f32_dpp v44, v44, v44 row_ror:8 row_mask:0xf bank_mask:0x3
    s_nop 1
    v_add_f32_dpp v44, v45, v45 row_ror:8 row_mask:0xf bank_mask:0xc
    v_dot2_f32_bf16 v47, v220, v28, 0
    v_dot2_f32_bf16 v47, v221, v29, v47
    v_dot2_f32_bf16 v47, v222, v30, v47
    v_dot2_f32_bf16 v47, v223, v31, v47
    s_waitcnt vmcnt(4)
    buffer_load_dwordx4 v[140:143], v1, s[8:11], s7 offen offset:0 nt
    s_xor_b32 s7, s49, 0x84000
    v_dot2_f32_bf16 v48, v224, v28, 0
    v_dot2_f32_bf16 v48, v225, v29, v48
    v_dot2_f32_bf16 v48, v226, v30, v48
    v_dot2_f32_bf16 v48, v227, v31, v48
    v_add_f32_dpp v46, v46, v46 row_ror:8 row_mask:0xf bank_mask:0x3
    s_nop 1
    v_add_f32_dpp v46, v47, v47 row_ror:8 row_mask:0xf bank_mask:0xc
    v_dot2_f32_bf16 v49, v228, v28, 0
    v_dot2_f32_bf16 v49, v229, v29, v49
    v_dot2_f32_bf16 v49, v230, v30, v49
    v_dot2_f32_bf16 v49, v231, v31, v49
    v_add_f32_dpp v44, v44, v44 row_shl:4 row_mask:0xf bank_mask:0x5
    s_nop 1
    v_add_f32_dpp v44, v46, v46 row_shr:4 row_mask:0xf bank_mask:0xa
    s_waitcnt vmcnt(4)
    buffer_load_dwordx4 v[144:147], v1, s[8:11], s7 offen offset:0 nt
    s_xor_b32 s7, s49, 0x85000
    v_dot2_f32_bf16 v50, v232, v28, 0
    v_dot2_f32_bf16 v50, v233, v29, v50
    v_dot2_f32_bf16 v50, v234, v30, v50
    v_dot2_f32_bf16 v50, v235, v31, v50
    v_add_f32_dpp v40, v40, v40 quad_perm:[2,3,0,1] row_mask:0xf bank_mask:0xf
    v_add_f32_dpp v44, v44, v44 quad_perm:[2,3,0,1] row_mask:0xf bank_mask:0xf
    v_cndmask_b32 v40, v40, v44, s[44:45]
    v_add_f32_dpp v48, v48, v48 row_ror:8 row_mask:0xf bank_mask:0x3
    s_nop 1
    v_add_f32_dpp v48, v49, v49 row_ror:8 row_mask:0xf bank_mask:0xc
    v_dot2_f32_bf16 v51, v236, v28, 0
    v_dot2_f32_bf16 v51, v237, v29, v51
    v_dot2_f32_bf16 v51, v238, v30, v51
    v_dot2_f32_bf16 v51, v239, v31, v51
    v_add_f32_dpp v32, v32, v32 quad_perm:[1,0,3,2] row_mask:0xf bank_mask:0xf
    v_add_f32_dpp v40, v40, v40 quad_perm:[1,0,3,2] row_mask:0xf bank_mask:0xf
    v_cndmask_b32 v32, v32, v40, s[46:47]
    v_cvt_pk_bf16_f32 v80, v32, v32
    v_and_b32 v80, s92, v80
    v_mul_f32 v80, 0x3db504f3, v80
    v_cvt_pk_bf16_f32 v70, v80, v80
    v_and_b32 v70, s92, v70
    v_max_f32 v81, v81, v70
    s_waitcnt vmcnt(4)
    buffer_load_dwordx4 v[148:151], v1, s[8:11], s7 offen offset:0 nt
    s_xor_b32 s7, s49, 0x86000
    v_dot2_f32_bf16 v52, v240, v28, 0
    v_dot2_f32_bf16 v52, v241, v29, v52
    v_dot2_f32_bf16 v52, v242, v30, v52
    v_dot2_f32_bf16 v52, v243, v31, v52
    v_add_f32_dpp v50, v50, v50 row_ror:8 row_mask:0xf bank_mask:0x3
    s_nop 1
    v_add_f32_dpp v50, v51, v51 row_ror:8 row_mask:0xf bank_mask:0xc
    v_dot2_f32_bf16 v53, v244, v28, 0
    v_dot2_f32_bf16 v53, v245, v29, v53
    v_dot2_f32_bf16 v53, v246, v30, v53
    v_dot2_f32_bf16 v53, v247, v31, v53
    v_add_f32_dpp v48, v48, v48 row_shl:4 row_mask:0xf bank_mask:0x5
    s_nop 1
    v_add_f32_dpp v48, v50, v50 row_shr:4 row_mask:0xf bank_mask:0xa
    s_waitcnt vmcnt(4)
    buffer_load_dwordx4 v[152:155], v1, s[8:11], s7 offen offset:0 nt
    s_xor_b32 s7, s49, 0x87000
    v_dot2_f32_bf16 v54, v248, v28, 0
    v_dot2_f32_bf16 v54, v249, v29, v54
    v_dot2_f32_bf16 v54, v250, v30, v54
    v_dot2_f32_bf16 v54, v251, v31, v54
    v_add_f32_dpp v52, v52, v52 row_ror:8 row_mask:0xf bank_mask:0x3
    s_nop 1
    v_add_f32_dpp v52, v53, v53 row_ror:8 row_mask:0xf bank_mask:0xc
    v_dot2_f32_bf16 v55, v252, v28, 0
    v_dot2_f32_bf16 v55, v253, v29, v55
    v_dot2_f32_bf16 v55, v254, v30, v55
    v_dot2_f32_bf16 v55, v255, v31, v55
    s_waitcnt vmcnt(4)
    buffer_load_dwordx4 v[156:159], v1, s[8:11], s7 offen offset:0 nt
    s_xor_b32 s7, s49, 0x88000
    v_dot2_f32_bf16 v56, v96, v28, 0
    v_dot2_f32_bf16 v56, v97, v29, v56
    v_dot2_f32_bf16 v56, v98, v30, v56
    v_dot2_f32_bf16 v56, v99, v31, v56
    v_add_f32_dpp v54, v54, v54 row_ror:8 row_mask:0xf bank_mask:0x3
    s_nop 1
    v_add_f32_dpp v54, v55, v55 row_ror:8 row_mask:0xf bank_mask:0xc
    v_dot2_f32_bf16 v57, v100, v28, 0
    v_dot2_f32_bf16 v57, v101, v29, v57
    v_dot2_f32_bf16 v57, v102, v30, v57
    v_dot2_f32_bf16 v57, v103, v31, v57
    v_add_f32_dpp v52, v52, v52 row_shl:4 row_mask:0xf bank_mask:0x5
    s_nop 1
    v_add_f32_dpp v52, v54, v54 row_shr:4 row_mask:0xf bank_mask:0xa
    s_waitcnt vmcnt(4)
    buffer_load_dwordx4 v[160:163], v1, s[8:11], s7 offen offset:0 nt
    s_xor_b32 s7, s49, 0x89000
    v_dot2_f32_bf16 v58, v104, v28, 0
    v_dot2_f32_bf16 v58, v105, v29, v58
    v_dot2_f32_bf16 v58, v106, v30, v58
    v_dot2_f32_bf16 v58, v107, v31, v58
    v_add_f32_dpp v48, v48, v48 quad_perm:[2,3,0,1] row_mask:0xf bank_mask:0xf
    v_add_f32_dpp v52, v52, v52 quad_perm:[2,3,0,1] row_mask:0xf bank_mask:0xf
    v_cndmask_b32 v48, v48, v52, s[44:45]
    v_add_f32_dpp v56, v56, v56 row_ror:8 row_mask:0xf bank_mask:0x3
    s_nop 1
    v_add_f32_dpp v56, v57, v57 row_ror:8 row_mask:0xf bank_mask:0xc
    v_dot2_f32_bf16 v59, v108, v28, 0
    v_dot2_f32_bf16 v59, v109, v29, v59
    v_dot2_f32_bf16 v59, v110, v30, v59
    v_dot2_f32_bf16 v59, v111, v31, v59
    s_waitcnt vmcnt(4)
    buffer_load_dwordx4 v[164:167], v1, s[8:11], s7 offen offset:0 nt
    s_xor_b32 s7, s49, 0x8a000
    v_dot2_f32_bf16 v60, v112, v28, 0
    v_dot2_f32_bf16 v60, v113, v29, v60
    v_dot2_f32_bf16 v60, v114, v30, v60
    v_dot2_f32_bf16 v60, v115, v31, v60
    v_add_f32_dpp v58, v58, v58 row_ror:8 row_mask:0xf bank_mask:0x3
    s_nop 1
    v_add_f32_dpp v58, v59, v59 row_ror:8 row_mask:0xf bank_mask:0xc
    v_dot2_f32_bf16 v61, v116, v28, 0
    v_dot2_f32_bf16 v61, v117, v29, v61
    v_dot2_f32_bf16 v61, v118, v30, v61
    v_dot2_f32_bf16 v61, v119, v31, v61
    v_add_f32_dpp v56, v56, v56 row_shl:4 row_mask:0xf bank_mask:0x5
    s_nop 1
    v_add_f32_dpp v56, v58, v58 row_shr:4 row_mask:0xf bank_mask:0xa
    s_waitcnt vmcnt(4)
    buffer_load_dwordx4 v[168:171], v1, s[8:11], s7 offen offset:0 nt
    s_xor_b32 s7, s49, 0x8b000
    v_dot2_f32_bf16 v62, v120, v28, 0
    v_dot2_f32_bf16 v62, v121, v29, v62
    v_dot2_f32_bf16 v62, v122, v30, v62
    v_dot2_f32_bf16 v62, v123, v31, v62
    v_add_f32_dpp v60, v60, v60 row_ror:8 row_mask:0xf bank_mask:0x3
    s_nop 1
    v_add_f32_dpp v60, v61, v61 row_ror:8 row_mask:0xf bank_mask:0xc
    v_dot2_f32_bf16 v63, v124, v28, 0
    v_dot2_f32_bf16 v63, v125, v29, v63
    v_dot2_f32_bf16 v63, v126, v30, v63
    v_dot2_f32_bf16 v63, v127, v31, v63
    s_waitcnt vmcnt(4)
    buffer_load_dwordx4 v[172:175], v1, s[8:11], s7 offen offset:0 nt
    s_xor_b32 s7, s49, 0x8c000
    v_dot2_f32_bf16 v32, v128, v28, 0
    v_dot2_f32_bf16 v32, v129, v29, v32
    v_dot2_f32_bf16 v32, v130, v30, v32
    v_dot2_f32_bf16 v32, v131, v31, v32
    v_add_f32_dpp v62, v62, v62 row_ror:8 row_mask:0xf bank_mask:0x3
    s_nop 1
    v_add_f32_dpp v62, v63, v63 row_ror:8 row_mask:0xf bank_mask:0xc
    v_dot2_f32_bf16 v33, v132, v28, 0
    v_dot2_f32_bf16 v33, v133, v29, v33
    v_dot2_f32_bf16 v33, v134, v30, v33
    v_dot2_f32_bf16 v33, v135, v31, v33
    v_add_f32_dpp v60, v60, v60 row_shl:4 row_mask:0xf bank_mask:0x5
    s_nop 1
    v_add_f32_dpp v60, v62, v62 row_shr:4 row_mask:0xf bank_mask:0xa
    s_waitcnt vmcnt(4)
    buffer_load_dwordx4 v[176:179], v1, s[8:11], s7 offen offset:0 nt
    s_xor_b32 s7, s49, 0x8d000
    v_dot2_f32_bf16 v34, v136, v28, 0
    v_dot2_f32_bf16 v34, v137, v29, v34
    v_dot2_f32_bf16 v34, v138, v30, v34
    v_dot2_f32_bf16 v34, v139, v31, v34
    v_add_f32_dpp v56, v56, v56 quad_perm:[2,3,0,1] row_mask:0xf bank_mask:0xf
    v_add_f32_dpp v60, v60, v60 quad_perm:[2,3,0,1] row_mask:0xf bank_mask:0xf
    v_cndmask_b32 v56, v56, v60, s[44:45]
    v_add_f32_dpp v32, v32, v32 row_ror:8 row_mask:0xf bank_mask:0x3
    s_nop 1
    v_add_f32_dpp v32, v33, v33 row_ror:8 row_mask:0xf bank_mask:0xc
    v_dot2_f32_bf16 v35, v140, v28, 0
    v_dot2_f32_bf16 v35, v141, v29, v35
    v_dot2_f32_bf16 v35, v142, v30, v35
    v_dot2_f32_bf16 v35, v143, v31, v35
    v_add_f32_dpp v48, v48, v48 quad_perm:[1,0,3,2] row_mask:0xf bank_mask:0xf
    v_add_f32_dpp v56, v56, v56 quad_perm:[1,0,3,2] row_mask:0xf bank_mask:0xf
    v_cndmask_b32 v48, v48, v56, s[46:47]
    v_cvt_pk_bf16_f32 v80, v48, v48
    v_and_b32 v80, s92, v80
    v_mul_f32 v80, 0x3db504f3, v80
    v_cvt_pk_bf16_f32 v71, v80, v80
    v_and_b32 v71, s92, v71
    v_max_f32 v81, v81, v71
    s_waitcnt vmcnt(4)
    buffer_load_dwordx4 v[180:183], v1, s[8:11], s7 offen offset:0 nt
    s_xor_b32 s7, s49, 0x8e000
    v_dot2_f32_bf16 v36, v144, v28, 0
    v_dot2_f32_bf16 v36, v145, v29, v36
    v_dot2_f32_bf16 v36, v146, v30, v36
    v_dot2_f32_bf16 v36, v147, v31, v36
    v_add_f32_dpp v34, v34, v34 row_ror:8 row_mask:0xf bank_mask:0x3
    s_nop 1
    v_add_f32_dpp v34, v35, v35 row_ror:8 row_mask:0xf bank_mask:0xc
    v_dot2_f32_bf16 v37, v148, v28, 0
    v_dot2_f32_bf16 v37, v149, v29, v37
    v_dot2_f32_bf16 v37, v150, v30, v37
    v_dot2_f32_bf16 v37, v151, v31, v37
    v_add_f32_dpp v32, v32, v32 row_shl:4 row_mask:0xf bank_mask:0x5
    s_nop 1
    v_add_f32_dpp v32, v34, v34 row_shr:4 row_mask:0xf bank_mask:0xa
    s_waitcnt vmcnt(4)
    buffer_load_dwordx4 v[184:187], v1, s[8:11], s7 offen offset:0 nt
    s_xor_b32 s7, s49, 0x8f000
    v_dot2_f32_bf16 v38, v152, v28, 0
    v_dot2_f32_bf16 v38, v153, v29, v38
    v_dot2_f32_bf16 v38, v154, v30, v38
    v_dot2_f32_bf16 v38, v155, v31, v38
    v_add_f32_dpp v36, v36, v36 row_ror:8 row_mask:0xf bank_mask:0x3
    s_nop 1
    v_add_f32_dpp v36, v37, v37 row_ror:8 row_mask:0xf bank_mask:0xc
    v_dot2_f32_bf16 v39, v156, v28, 0
    v_dot2_f32_bf16 v39, v157, v29, v39
    v_dot2_f32_bf16 v39, v158, v30, v39
    v_dot2_f32_bf16 v39, v159, v31, v39
    s_waitcnt vmcnt(4)
    buffer_load_dwordx4 v[188:191], v1, s[8:11], s7 offen offset:0 nt
    s_xor_b32 s7, s49, 0x90000
    v_dot2_f32_bf16 v40, v160, v28, 0
    v_dot2_f32_bf16 v40, v161, v29, v40
    v_dot2_f32_bf16 v40, v162, v30, v40
    v_dot2_f32_bf16 v40, v163, v31, v40
    v_add_f32_dpp v38, v38, v38 row_ror:8 row_mask:0xf bank_mask:0x3
    s_nop 1
    v_add_f32_dpp v38, v39, v39 row_ror:8 row_mask:0xf bank_mask:0xc
    v_dot2_f32_bf16 v41, v164, v28, 0
    v_dot2_f32_bf16 v41, v165, v29, v41
    v_dot2_f32_bf16 v41, v166, v30, v41
    v_dot2_f32_bf16 v41, v167, v31, v41
    v_add_f32_dpp v36, v36, v36 row_shl:4 row_mask:0xf bank_mask:0x5
    s_nop 1
    v_add_f32_dpp v36, v38, v38 row_shr:4 row_mask:0xf bank_mask:0xa
    s_waitcnt vmcnt(4)
    buffer_load_dwordx4 v[192:195], v1, s[8:11], s7 offen offset:0 nt
    s_xor_b32 s7, s49, 0x91000
    v_dot2_f32_bf16 v42, v168, v28, 0
    v_dot2_f32_bf16 v42, v169, v29, v42
    v_dot2_f32_bf16 v42, v170, v30, v42
    v_dot2_f32_bf16 v42, v171, v31, v42
    v_add_f32_dpp v32, v32, v32 quad_perm:[2,3,0,1] row_mask:0xf bank_mask:0xf
    v_add_f32_dpp v36, v36, v36 quad_perm:[2,3,0,1] row_mask:0xf bank_mask:0xf
    v_cndmask_b32 v32, v32, v36, s[44:45]
    v_add_f32_dpp v40, v40, v40 row_ror:8 row_mask:0xf bank_mask:0x3
    s_nop 1
    v_add_f32_dpp v40, v41, v41 row_ror:8 row_mask:0xf bank_mask:0xc
    v_dot2_f32_bf16 v43, v172, v28, 0
    v_dot2_f32_bf16 v43, v173, v29, v43
    v_dot2_f32_bf16 v43, v174, v30, v43
    v_dot2_f32_bf16 v43, v175, v31, v43
    s_waitcnt vmcnt(4)
    buffer_load_dwordx4 v[196:199], v1, s[8:11], s7 offen offset:0 nt
    s_xor_b32 s7, s49, 0x92000
    v_dot2_f32_bf16 v44, v176, v28, 0
    v_dot2_f32_bf16 v44, v177, v29, v44
    v_dot2_f32_bf16 v44, v178, v30, v44
    v_dot2_f32_bf16 v44, v179, v31, v44
    v_add_f32_dpp v42, v42, v42 row_ror:8 row_mask:0xf bank_mask:0x3
    s_nop 1
    v_add_f32_dpp v42, v43, v43 row_ror:8 row_mask:0xf bank_mask:0xc
    s_waitcnt vmcnt(4)
    buffer_load_dwordx4 v[200:203], v1, s[8:11], s7 offen offset:0 nt
    s_xor_b32 s7, s49, 0x93000
    v_dot2_f32_bf16 v45, v180, v28, 0
    v_dot2_f32_bf16 v45, v181, v29, v45
    v_dot2_f32_bf16 v45, v182, v30, v45
    v_dot2_f32_bf16 v45, v183, v31, v45
    v_add_f32_dpp v40, v40, v40 row_shl:4 row_mask:0xf bank_mask:0x5
    s_nop 1
    v_add_f32_dpp v40, v42, v42 row_shr:4 row_mask:0xf bank_mask:0xa
    s_waitcnt vmcnt(4)
    buffer_load_dwordx4 v[204:207], v1, s[8:11], s7 offen offset:0 nt
    s_xor_b32 s7, s49, 0x94000
    v_dot2_f32_bf16 v46, v184, v28, 0
    v_dot2_f32_bf16 v46, v185, v29, v46
    v_dot2_f32_bf16 v46, v186, v30, v46
    v_dot2_f32_bf16 v46, v187, v31, v46
    v_add_f32_dpp v44, v44, v44 row_ror:8 row_mask:0xf bank_mask:0x3
    s_nop 1
    v_add_f32_dpp v44, v45, v45 row_ror:8 row_mask:0xf bank_mask:0xc
    s_waitcnt vmcnt(4)
    buffer_load_dwordx4 v[208:211], v1, s[8:11], s7 offen offset:0 nt
    s_xor_b32 s7, s49, 0x95000
    v_dot2_f32_bf16 v47, v188, v28, 0
    v_dot2_f32_bf16 v47, v189, v29, v47
    v_dot2_f32_bf16 v47, v190, v30, v47
    v_dot2_f32_bf16 v47, v191, v31, v47
    s_waitcnt vmcnt(4)
    buffer_load_dwordx4 v[212:215], v1, s[8:11], s7 offen offset:0 nt
    s_xor_b32 s7, s49, 0x96000
    v_dot2_f32_bf16 v48, v192, v28, 0
    v_dot2_f32_bf16 v48, v193, v29, v48
    v_dot2_f32_bf16 v48, v194, v30, v48
    v_dot2_f32_bf16 v48, v195, v31, v48
    v_add_f32_dpp v46, v46, v46 row_ror:8 row_mask:0xf bank_mask:0x3
    s_nop 1
    v_add_f32_dpp v46, v47, v47 row_ror:8 row_mask:0xf bank_mask:0xc
    s_waitcnt vmcnt(4)
    buffer_load_dwordx4 v[216:219], v1, s[8:11], s7 offen offset:0 nt
    s_xor_b32 s7, s49, 0x97000
    v_dot2_f32_bf16 v49, v196, v28, 0
    v_dot2_f32_bf16 v49, v197, v29, v49
    v_dot2_f32_bf16 v49, v198, v30, v49
    v_dot2_f32_bf16 v49, v199, v31, v49
    v_add_f32_dpp v44, v44, v44 row_shl:4 row_mask:0xf bank_mask:0x5
    s_nop 1
    v_add_f32_dpp v44, v46, v46 row_shr:4 row_mask:0xf bank_mask:0xa
    s_waitcnt vmcnt(4)
    buffer_load_dwordx4 v[220:223], v1, s[8:11], s7 offen offset:0 nt
    s_xor_b32 s7, s49, 0x98000
    v_dot2_f32_bf16 v50, v200, v28, 0
    v_dot2_f32_bf16 v50, v201, v29, v50
    v_dot2_f32_bf16 v50, v202, v30, v50
    v_dot2_f32_bf16 v50, v203, v31, v50
    v_add_f32_dpp v40, v40, v40 quad_perm:[2,3,0,1] row_mask:0xf bank_mask:0xf
    v_add_f32_dpp v44, v44, v44 quad_perm:[2,3,0,1] row_mask:0xf bank_mask:0xf
    v_cndmask_b32 v40, v40, v44, s[44:45]
    v_add_f32_dpp v48, v48, v48 row_ror:8 row_mask:0xf bank_mask:0x3
    s_nop 1
    v_add_f32_dpp v48, v49, v49 row_ror:8 row_mask:0xf bank_mask:0xc
    s_waitcnt vmcnt(4)
    buffer_load_dwordx4 v[224:227], v1, s[8:11], s7 offen offset:0 nt
    s_xor_b32 s7, s49, 0x99000
    v_dot2_f32_bf16 v51, v204, v28, 0
    v_dot2_f32_bf16 v51, v205, v29, v51
    v_dot2_f32_bf16 v51, v206, v30, v51
    v_dot2_f32_bf16 v51, v207, v31, v51
    v_add_f32_dpp v32, v32, v32 quad_perm:[1,0,3,2] row_mask:0xf bank_mask:0xf
    v_add_f32_dpp v40, v40, v40 quad_perm:[1,0,3,2] row_mask:0xf bank_mask:0xf
    v_cndmask_b32 v32, v32, v40, s[46:47]
    v_cvt_pk_bf16_f32 v80, v32, v32
    v_and_b32 v80, s92, v80
    v_mul_f32 v80, 0x3db504f3, v80
    v_cvt_pk_bf16_f32 v72, v80, v80
    v_and_b32 v72, s92, v72
    v_max_f32 v81, v81, v72
    s_waitcnt vmcnt(4)
    buffer_load_dwordx4 v[228:231], v1, s[8:11], s7 offen offset:0 nt
    s_xor_b32 s7, s49, 0x9a000
    v_dot2_f32_bf16 v52, v208, v28, 0
    v_dot2_f32_bf16 v52, v209, v29, v52
    v_dot2_f32_bf16 v52, v210, v30, v52
    v_dot2_f32_bf16 v52, v211, v31, v52
    v_add_f32_dpp v50, v50, v50 row_ror:8 row_mask:0xf bank_mask:0x3
    s_nop 1
    v_add_f32_dpp v50, v51, v51 row_ror:8 row_mask:0xf bank_mask:0xc
    s_waitcnt vmcnt(4)
    buffer_load_dwordx4 v[232:235], v1, s[8:11], s7 offen offset:0 nt
    s_xor_b32 s7, s49, 0x9b000
    v_dot2_f32_bf16 v53, v212, v28, 0
    v_dot2_f32_bf16 v53, v213, v29, v53
    v_dot2_f32_bf16 v53, v214, v30, v53
    v_dot2_f32_bf16 v53, v215, v31, v53
    v_add_f32_dpp v48, v48, v48 row_shl:4 row_mask:0xf bank_mask:0x5
    s_nop 1
    v_add_f32_dpp v48, v50, v50 row_shr:4 row_mask:0xf bank_mask:0xa
    s_waitcnt vmcnt(4)
    buffer_load_dwordx4 v[236:239], v1, s[8:11], s7 offen offset:0 nt
    s_xor_b32 s7, s49, 0x9c000
    v_dot2_f32_bf16 v54, v216, v28, 0
    v_dot2_f32_bf16 v54, v217, v29, v54
    v_dot2_f32_bf16 v54, v218, v30, v54
    v_dot2_f32_bf16 v54, v219, v31, v54
    v_add_f32_dpp v52, v52, v52 row_ror:8 row_mask:0xf bank_mask:0x3
    s_nop 1
    v_add_f32_dpp v52, v53, v53 row_ror:8 row_mask:0xf bank_mask:0xc
    s_waitcnt vmcnt(4)
    buffer_load_dwordx4 v[240:243], v1, s[8:11], s7 offen offset:0 nt
    s_xor_b32 s7, s49, 0x9d000
    v_dot2_f32_bf16 v55, v220, v28, 0
    v_dot2_f32_bf16 v55, v221, v29, v55
    v_dot2_f32_bf16 v55, v222, v30, v55
    v_dot2_f32_bf16 v55, v223, v31, v55
    s_waitcnt vmcnt(4)
    buffer_load_dwordx4 v[244:247], v1, s[8:11], s7 offen offset:0 nt
    s_xor_b32 s7, s49, 0x9e000
    v_dot2_f32_bf16 v56, v224, v28, 0
    v_dot2_f32_bf16 v56, v225, v29, v56
    v_dot2_f32_bf16 v56, v226, v30, v56
    v_dot2_f32_bf16 v56, v227, v31, v56
    v_add_f32_dpp v54, v54, v54 row_ror:8 row_mask:0xf bank_mask:0x3
    s_nop 1
    v_add_f32_dpp v54, v55, v55 row_ror:8 row_mask:0xf bank_mask:0xc
    s_waitcnt vmcnt(4)
    buffer_load_dwordx4 v[248:251], v1, s[8:11], s7 offen offset:0 nt
    s_xor_b32 s7, s49, 0x9f000
    v_dot2_f32_bf16 v57, v228, v28, 0
    v_dot2_f32_bf16 v57, v229, v29, v57
    v_dot2_f32_bf16 v57, v230, v30, v57
    v_dot2_f32_bf16 v57, v231, v31, v57
    v_add_f32_dpp v52, v52, v52 row_shl:4 row_mask:0xf bank_mask:0x5
    s_nop 1
    v_add_f32_dpp v52, v54, v54 row_shr:4 row_mask:0xf bank_mask:0xa
    s_waitcnt vmcnt(4)
    buffer_load_dwordx4 v[252:255], v1, s[8:11], s7 offen offset:0 nt
    s_xor_b32 s7, s49, 0xa0000
    v_dot2_f32_bf16 v58, v232, v28, 0
    v_dot2_f32_bf16 v58, v233, v29, v58
    v_dot2_f32_bf16 v58, v234, v30, v58
    v_dot2_f32_bf16 v58, v235, v31, v58
    v_add_f32_dpp v48, v48, v48 quad_perm:[2,3,0,1] row_mask:0xf bank_mask:0xf
    v_add_f32_dpp v52, v52, v52 quad_perm:[2,3,0,1] row_mask:0xf bank_mask:0xf
    v_cndmask_b32 v48, v48, v52, s[44:45]
    v_add_f32_dpp v56, v56, v56 row_ror:8 row_mask:0xf bank_mask:0x3
    s_nop 1
    v_add_f32_dpp v56, v57, v57 row_ror:8 row_mask:0xf bank_mask:0xc
    s_waitcnt vmcnt(4)
    buffer_load_dwordx4 v[96:99], v1, s[8:11], s7 offen offset:0 nt
    s_xor_b32 s7, s49, 0xa1000
    v_dot2_f32_bf16 v59, v236, v28, 0
    v_dot2_f32_bf16 v59, v237, v29, v59
    v_dot2_f32_bf16 v59, v238, v30, v59
    v_dot2_f32_bf16 v59, v239, v31, v59
    s_waitcnt vmcnt(4)
    buffer_load_dwordx4 v[100:103], v1, s[8:11], s7 offen offset:0 nt
    s_xor_b32 s7, s49, 0xa2000
    v_dot2_f32_bf16 v60, v240, v28, 0
    v_dot2_f32_bf16 v60, v241, v29, v60
    v_dot2_f32_bf16 v60, v242, v30, v60
    v_dot2_f32_bf16 v60, v243, v31, v60
    v_add_f32_dpp v58, v58, v58 row_ror:8 row_mask:0xf bank_mask:0x3
    s_nop 1
    v_add_f32_dpp v58, v59, v59 row_ror:8 row_mask:0xf bank_mask:0xc
    s_waitcnt vmcnt(4)
    buffer_load_dwordx4 v[104:107], v1, s[8:11], s7 offen offset:0 nt
    s_xor_b32 s7, s49, 0xa3000
    v_dot2_f32_bf16 v61, v244, v28, 0
    v_dot2_f32_bf16 v61, v245, v29, v61
    v_dot2_f32_bf16 v61, v246, v30, v61
    v_dot2_f32_bf16 v61, v247, v31, v61
    v_add_f32_dpp v56, v56, v56 row_shl:4 row_mask:0xf bank_mask:0x5
    s_nop 1
    v_add_f32_dpp v56, v58, v58 row_shr:4 row_mask:0xf bank_mask:0xa
    s_waitcnt vmcnt(4)
    buffer_load_dwordx4 v[108:111], v1, s[8:11], s7 offen offset:0 nt
    s_xor_b32 s7, s49, 0xa4000
    v_dot2_f32_bf16 v62, v248, v28, 0
    v_dot2_f32_bf16 v62, v249, v29, v62
    v_dot2_f32_bf16 v62, v250, v30, v62
    v_dot2_f32_bf16 v62, v251, v31, v62
    v_add_f32_dpp v60, v60, v60 row_ror:8 row_mask:0xf bank_mask:0x3
    s_nop 1
    v_add_f32_dpp v60, v61, v61 row_ror:8 row_mask:0xf bank_mask:0xc
    s_waitcnt vmcnt(4)
    buffer_load_dwordx4 v[112:115], v1, s[8:11], s7 offen offset:0 nt
    s_xor_b32 s7, s49, 0xa5000
    v_dot2_f32_bf16 v63, v252, v28, 0
    v_dot2_f32_bf16 v63, v253, v29, v63
    v_dot2_f32_bf16 v63, v254, v30, v63
    v_dot2_f32_bf16 v63, v255, v31, v63
    s_waitcnt vmcnt(4)
    buffer_load_dwordx4 v[116:119], v1, s[8:11], s7 offen offset:0 nt
    s_xor_b32 s7, s49, 0xa6000
    v_dot2_f32_bf16 v32, v96, v28, 0
    v_dot2_f32_bf16 v32, v97, v29, v32
    v_dot2_f32_bf16 v32, v98, v30, v32
    v_dot2_f32_bf16 v32, v99, v31, v32
    v_add_f32_dpp v62, v62, v62 row_ror:8 row_mask:0xf bank_mask:0x3
    s_nop 1
    v_add_f32_dpp v62, v63, v63 row_ror:8 row_mask:0xf bank_mask:0xc
    s_waitcnt vmcnt(4)
    buffer_load_dwordx4 v[120:123], v1, s[8:11], s7 offen offset:0 nt
    s_xor_b32 s7, s49, 0xa7000
    v_dot2_f32_bf16 v33, v100, v28, 0
    v_dot2_f32_bf16 v33, v101, v29, v33
    v_dot2_f32_bf16 v33, v102, v30, v33
    v_dot2_f32_bf16 v33, v103, v31, v33
    v_add_f32_dpp v60, v60, v60 row_shl:4 row_mask:0xf bank_mask:0x5
    s_nop 1
    v_add_f32_dpp v60, v62, v62 row_shr:4 row_mask:0xf bank_mask:0xa
    s_waitcnt vmcnt(4)
    buffer_load_dwordx4 v[124:127], v1, s[8:11], s7 offen offset:0 nt
    s_xor_b32 s7, s49, 0xa8000
    v_dot2_f32_bf16 v34, v104, v28, 0
    v_dot2_f32_bf16 v34, v105, v29, v34
    v_dot2_f32_bf16 v34, v106, v30, v34
    v_dot2_f32_bf16 v34, v107, v31, v34
    v_add_f32_dpp v56, v56, v56 quad_perm:[2,3,0,1] row_mask:0xf bank_mask:0xf
    v_add_f32_dpp v60, v60, v60 quad_perm:[2,3,0,1] row_mask:0xf bank_mask:0xf
    v_cndmask_b32 v56, v56, v60, s[44:45]
    v_add_f32_dpp v32, v32, v32 row_ror:8 row_mask:0xf bank_mask:0x3
    s_nop 1
    v_add_f32_dpp v32, v33, v33 row_ror:8 row_mask:0xf bank_mask:0xc
    s_waitcnt vmcnt(4)
    buffer_load_dwordx4 v[128:131], v1, s[8:11], s7 offen offset:0 nt
    s_xor_b32 s7, s49, 0xa9000
    v_dot2_f32_bf16 v35, v108, v28, 0
    v_dot2_f32_bf16 v35, v109, v29, v35
    v_dot2_f32_bf16 v35, v110, v30, v35
    v_dot2_f32_bf16 v35, v111, v31, v35
    v_add_f32_dpp v48, v48, v48 quad_perm:[1,0,3,2] row_mask:0xf bank_mask:0xf
    v_add_f32_dpp v56, v56, v56 quad_perm:[1,0,3,2] row_mask:0xf bank_mask:0xf
    v_cndmask_b32 v48, v48, v56, s[46:47]
    v_cvt_pk_bf16_f32 v80, v48, v48
    v_and_b32 v80, s92, v80
    v_mul_f32 v80, 0x3db504f3, v80
    v_cvt_pk_bf16_f32 v73, v80, v80
    v_and_b32 v73, s92, v73
    v_max_f32 v81, v81, v73
    s_waitcnt vmcnt(4)
    buffer_load_dwordx4 v[132:135], v1, s[8:11], s7 offen offset:0 nt
    s_xor_b32 s7, s49, 0xaa000
    v_dot2_f32_bf16 v36, v112, v28, 0
    v_dot2_f32_bf16 v36, v113, v29, v36
    v_dot2_f32_bf16 v36, v114, v30, v36
    v_dot2_f32_bf16 v36, v115, v31, v36
    v_add_f32_dpp v34, v34, v34 row_ror:8 row_mask:0xf bank_mask:0x3
    s_nop 1
    v_add_f32_dpp v34, v35, v35 row_ror:8 row_mask:0xf bank_mask:0xc
    s_waitcnt vmcnt(4)
    buffer_load_dwordx4 v[136:139], v1, s[8:11], s7 offen offset:0 nt
    s_xor_b32 s7, s49, 0xab000
    v_dot2_f32_bf16 v37, v116, v28, 0
    v_dot2_f32_bf16 v37, v117, v29, v37
    v_dot2_f32_bf16 v37, v118, v30, v37
    v_dot2_f32_bf16 v37, v119, v31, v37
    v_add_f32_dpp v32, v32, v32 row_shl:4 row_mask:0xf bank_mask:0x5
    s_nop 1
    v_add_f32_dpp v32, v34, v34 row_shr:4 row_mask:0xf bank_mask:0xa
    s_waitcnt vmcnt(4)
    buffer_load_dwordx4 v[140:143], v1, s[8:11], s7 offen offset:0 nt
    s_xor_b32 s7, s49, 0xac000
    v_dot2_f32_bf16 v38, v120, v28, 0
    v_dot2_f32_bf16 v38, v121, v29, v38
    v_dot2_f32_bf16 v38, v122, v30, v38
    v_dot2_f32_bf16 v38, v123, v31, v38
    v_add_f32_dpp v36, v36, v36 row_ror:8 row_mask:0xf bank_mask:0x3
    s_nop 1
    v_add_f32_dpp v36, v37, v37 row_ror:8 row_mask:0xf bank_mask:0xc
    s_waitcnt vmcnt(4)
    buffer_load_dwordx4 v[144:147], v1, s[8:11], s7 offen offset:0 nt
    s_xor_b32 s7, s49, 0xad000
    v_dot2_f32_bf16 v39, v124, v28, 0
    v_dot2_f32_bf16 v39, v125, v29, v39
    v_dot2_f32_bf16 v39, v126, v30, v39
    v_dot2_f32_bf16 v39, v127, v31, v39
    s_waitcnt vmcnt(4)
    buffer_load_dwordx4 v[148:151], v1, s[8:11], s7 offen offset:0 nt
    s_xor_b32 s7, s49, 0xae000
    v_dot2_f32_bf16 v40, v128, v28, 0
    v_dot2_f32_bf16 v40, v129, v29, v40
    v_dot2_f32_bf16 v40, v130, v30, v40
    v_dot2_f32_bf16 v40, v131, v31, v40
    v_add_f32_dpp v38, v38, v38 row_ror:8 row_mask:0xf bank_mask:0x3
    s_nop 1
    v_add_f32_dpp v38, v39, v39 row_ror:8 row_mask:0xf bank_mask:0xc
    s_waitcnt vmcnt(4)
    buffer_load_dwordx4 v[152:155], v1, s[8:11], s7 offen offset:0 nt
    s_xor_b32 s7, s49, 0xaf000
    v_dot2_f32_bf16 v41, v132, v28, 0
    v_dot2_f32_bf16 v41, v133, v29, v41
    v_dot2_f32_bf16 v41, v134, v30, v41
    v_dot2_f32_bf16 v41, v135, v31, v41
    v_add_f32_dpp v36, v36, v36 row_shl:4 row_mask:0xf bank_mask:0x5
    s_nop 1
    v_add_f32_dpp v36, v38, v38 row_shr:4 row_mask:0xf bank_mask:0xa
    s_waitcnt vmcnt(4)
    buffer_load_dwordx4 v[156:159], v1, s[8:11], s7 offen offset:0 nt
    s_xor_b32 s7, s49, 0xb0000
    v_dot2_f32_bf16 v42, v136, v28, 0
    v_dot2_f32_bf16 v42, v137, v29, v42
    v_dot2_f32_bf16 v42, v138, v30, v42
    v_dot2_f32_bf16 v42, v139, v31, v42
    v_add_f32_dpp v32, v32, v32 quad_perm:[2,3,0,1] row_mask:0xf bank_mask:0xf
    v_add_f32_dpp v36, v36, v36 quad_perm:[2,3,0,1] row_mask:0xf bank_mask:0xf
    v_cndmask_b32 v32, v32, v36, s[44:45]
    v_add_f32_dpp v40, v40, v40 row_ror:8 row_mask:0xf bank_mask:0x3
    s_nop 1
    v_add_f32_dpp v40, v41, v41 row_ror:8 row_mask:0xf bank_mask:0xc
    s_waitcnt vmcnt(4)
    buffer_load_dwordx4 v[160:163], v1, s[8:11], s7 offen offset:0 nt
    s_xor_b32 s7, s49, 0xb1000
    v_dot2_f32_bf16 v43, v140, v28, 0
    v_dot2_f32_bf16 v43, v141, v29, v43
    v_dot2_f32_bf16 v43, v142, v30, v43
    v_dot2_f32_bf16 v43, v143, v31, v43
    s_waitcnt vmcnt(4)
    buffer_load_dwordx4 v[164:167], v1, s[8:11], s7 offen offset:0 nt
    s_xor_b32 s7, s49, 0xb2000
    v_dot2_f32_bf16 v44, v144, v28, 0
    v_dot2_f32_bf16 v44, v145, v29, v44
    v_dot2_f32_bf16 v44, v146, v30, v44
    v_dot2_f32_bf16 v44, v147, v31, v44
    v_add_f32_dpp v42, v42, v42 row_ror:8 row_mask:0xf bank_mask:0x3
    s_nop 1
    v_add_f32_dpp v42, v43, v43 row_ror:8 row_mask:0xf bank_mask:0xc
    s_waitcnt vmcnt(4)
    buffer_load_dwordx4 v[168:171], v1, s[8:11], s7 offen offset:0 nt
    s_xor_b32 s7, s49, 0xb3000
    v_dot2_f32_bf16 v45, v148, v28, 0
    v_dot2_f32_bf16 v45, v149, v29, v45
    v_dot2_f32_bf16 v45, v150, v30, v45
    v_dot2_f32_bf16 v45, v151, v31, v45
    v_add_f32_dpp v40, v40, v40 row_shl:4 row_mask:0xf bank_mask:0x5
    s_nop 1
    v_add_f32_dpp v40, v42, v42 row_shr:4 row_mask:0xf bank_mask:0xa
    s_waitcnt vmcnt(4)
    buffer_load_dwordx4 v[172:175], v1, s[8:11], s7 offen offset:0 nt
    s_xor_b32 s7, s49, 0xb4000
    v_dot2_f32_bf16 v46, v152, v28, 0
    v_dot2_f32_bf16 v46, v153, v29, v46
    v_dot2_f32_bf16 v46, v154, v30, v46
    v_dot2_f32_bf16 v46, v155, v31, v46
    v_add_f32_dpp v44, v44, v44 row_ror:8 row_mask:0xf bank_mask:0x3
    s_nop 1
    v_add_f32_dpp v44, v45, v45 row_ror:8 row_mask:0xf bank_mask:0xc
    s_waitcnt vmcnt(4)
    buffer_load_dwordx4 v[176:179], v1, s[8:11], s7 offen offset:0 nt
    s_xor_b32 s7, s49, 0xb5000
    v_dot2_f32_bf16 v47, v156, v28, 0
    v_dot2_f32_bf16 v47, v157, v29, v47
    v_dot2_f32_bf16 v47, v158, v30, v47
    v_dot2_f32_bf16 v47, v159, v31, v47
    s_waitcnt vmcnt(4)
    buffer_load_dwordx4 v[180:183], v1, s[8:11], s7 offen offset:0 nt
    s_xor_b32 s7, s49, 0xb6000
    v_dot2_f32_bf16 v48, v160, v28, 0
    v_dot2_f32_bf16 v48, v161, v29, v48
    v_dot2_f32_bf16 v48, v162, v30, v48
    v_dot2_f32_bf16 v48, v163, v31, v48
    v_add_f32_dpp v46, v46, v46 row_ror:8 row_mask:0xf bank_mask:0x3
    s_nop 1
    v_add_f32_dpp v46, v47, v47 row_ror:8 row_mask:0xf bank_mask:0xc
    s_waitcnt vmcnt(4)
    buffer_load_dwordx4 v[184:187], v1, s[8:11], s7 offen offset:0 nt
    s_xor_b32 s7, s49, 0xb7000
    v_dot2_f32_bf16 v49, v164, v28, 0
    v_dot2_f32_bf16 v49, v165, v29, v49
    v_dot2_f32_bf16 v49, v166, v30, v49
    v_dot2_f32_bf16 v49, v167, v31, v49
    v_add_f32_dpp v44, v44, v44 row_shl:4 row_mask:0xf bank_mask:0x5
    s_nop 1
    v_add_f32_dpp v44, v46, v46 row_shr:4 row_mask:0xf bank_mask:0xa
    s_waitcnt vmcnt(4)
    buffer_load_dwordx4 v[188:191], v1, s[8:11], s7 offen offset:0 nt
    s_xor_b32 s7, s49, 0xb8000
    v_dot2_f32_bf16 v50, v168, v28, 0
    v_dot2_f32_bf16 v50, v169, v29, v50
    v_dot2_f32_bf16 v50, v170, v30, v50
    v_dot2_f32_bf16 v50, v171, v31, v50
    v_add_f32_dpp v40, v40, v40 quad_perm:[2,3,0,1] row_mask:0xf bank_mask:0xf
    v_add_f32_dpp v44, v44, v44 quad_perm:[2,3,0,1] row_mask:0xf bank_mask:0xf
    v_cndmask_b32 v40, v40, v44, s[44:45]
    v_add_f32_dpp v48, v48, v48 row_ror:8 row_mask:0xf bank_mask:0x3
    s_nop 1
    v_add_f32_dpp v48, v49, v49 row_ror:8 row_mask:0xf bank_mask:0xc
    s_waitcnt vmcnt(4)
    buffer_load_dwordx4 v[192:195], v1, s[8:11], s7 offen offset:0 nt
    s_xor_b32 s7, s49, 0xb9000
    v_dot2_f32_bf16 v51, v172, v28, 0
    v_dot2_f32_bf16 v51, v173, v29, v51
    v_dot2_f32_bf16 v51, v174, v30, v51
    v_dot2_f32_bf16 v51, v175, v31, v51
    v_add_f32_dpp v32, v32, v32 quad_perm:[1,0,3,2] row_mask:0xf bank_mask:0xf
    v_add_f32_dpp v40, v40, v40 quad_perm:[1,0,3,2] row_mask:0xf bank_mask:0xf
    v_cndmask_b32 v32, v32, v40, s[46:47]
    v_cvt_pk_bf16_f32 v80, v32, v32
    v_and_b32 v80, s92, v80
    v_mul_f32 v80, 0x3db504f3, v80
    v_cvt_pk_bf16_f32 v74, v80, v80
    v_and_b32 v74, s92, v74
    v_max_f32 v81, v81, v74
    s_waitcnt vmcnt(4)
    buffer_load_dwordx4 v[196:199], v1, s[8:11], s7 offen offset:0 nt
    s_xor_b32 s7, s49, 0xba000
    v_dot2_f32_bf16 v52, v176, v28, 0
    v_dot2_f32_bf16 v52, v177, v29, v52
    v_dot2_f32_bf16 v52, v178, v30, v52
    v_dot2_f32_bf16 v52, v179, v31, v52
    v_add_f32_dpp v50, v50, v50 row_ror:8 row_mask:0xf bank_mask:0x3
    s_nop 1
    v_add_f32_dpp v50, v51, v51 row_ror:8 row_mask:0xf bank_mask:0xc
    s_waitcnt vmcnt(4)
    buffer_load_dwordx4 v[200:203], v1, s[8:11], s7 offen offset:0 nt
    s_xor_b32 s7, s49, 0xbb000
    v_dot2_f32_bf16 v53, v180, v28, 0
    v_dot2_f32_bf16 v53, v181, v29, v53
    v_dot2_f32_bf16 v53, v182, v30, v53
    v_dot2_f32_bf16 v53, v183, v31, v53
    v_add_f32_dpp v48, v48, v48 row_shl:4 row_mask:0xf bank_mask:0x5
    s_nop 1
    v_add_f32_dpp v48, v50, v50 row_shr:4 row_mask:0xf bank_mask:0xa
    s_waitcnt vmcnt(4)
    buffer_load_dwordx4 v[204:207], v1, s[8:11], s7 offen offset:0 nt
    s_xor_b32 s7, s49, 0xbc000
    v_dot2_f32_bf16 v54, v184, v28, 0
    v_dot2_f32_bf16 v54, v185, v29, v54
    v_dot2_f32_bf16 v54, v186, v30, v54
    v_dot2_f32_bf16 v54, v187, v31, v54
    v_add_f32_dpp v52, v52, v52 row_ror:8 row_mask:0xf bank_mask:0x3
    s_nop 1
    v_add_f32_dpp v52, v53, v53 row_ror:8 row_mask:0xf bank_mask:0xc
    s_waitcnt vmcnt(4)
    buffer_load_dwordx4 v[208:211], v1, s[8:11], s7 offen offset:0 nt
    s_xor_b32 s7, s49, 0xbd000
    v_dot2_f32_bf16 v55, v188, v28, 0
    v_dot2_f32_bf16 v55, v189, v29, v55
    v_dot2_f32_bf16 v55, v190, v30, v55
    v_dot2_f32_bf16 v55, v191, v31, v55
    s_waitcnt vmcnt(4)
    buffer_load_dwordx4 v[212:215], v1, s[8:11], s7 offen offset:0 nt
    s_xor_b32 s7, s49, 0xbe000
    v_dot2_f32_bf16 v56, v192, v28, 0
    v_dot2_f32_bf16 v56, v193, v29, v56
    v_dot2_f32_bf16 v56, v194, v30, v56
    v_dot2_f32_bf16 v56, v195, v31, v56
    v_add_f32_dpp v54, v54, v54 row_ror:8 row_mask:0xf bank_mask:0x3
    s_nop 1
    v_add_f32_dpp v54, v55, v55 row_ror:8 row_mask:0xf bank_mask:0xc
    s_waitcnt vmcnt(4)
    buffer_load_dwordx4 v[216:219], v1, s[8:11], s7 offen offset:0 nt
    s_xor_b32 s7, s49, 0xbf000
    v_dot2_f32_bf16 v57, v196, v28, 0
    v_dot2_f32_bf16 v57, v197, v29, v57
    v_dot2_f32_bf16 v57, v198, v30, v57
    v_dot2_f32_bf16 v57, v199, v31, v57
    v_add_f32_dpp v52, v52, v52 row_shl:4 row_mask:0xf bank_mask:0x5
    s_nop 1
    v_add_f32_dpp v52, v54, v54 row_shr:4 row_mask:0xf bank_mask:0xa
    s_waitcnt vmcnt(4)
    buffer_load_dwordx4 v[220:223], v1, s[8:11], s7 offen offset:0 nt
    s_xor_b32 s7, s49, 0xc0000
    v_dot2_f32_bf16 v58, v200, v28, 0
    v_dot2_f32_bf16 v58, v201, v29, v58
    v_dot2_f32_bf16 v58, v202, v30, v58
    v_dot2_f32_bf16 v58, v203, v31, v58
    v_add_f32_dpp v48, v48, v48 quad_perm:[2,3,0,1] row_mask:0xf bank_mask:0xf
    v_add_f32_dpp v52, v52, v52 quad_perm:[2,3,0,1] row_mask:0xf bank_mask:0xf
    v_cndmask_b32 v48, v48, v52, s[44:45]
    v_add_f32_dpp v56, v56, v56 row_ror:8 row_mask:0xf bank_mask:0x3
    s_nop 1
    v_add_f32_dpp v56, v57, v57 row_ror:8 row_mask:0xf bank_mask:0xc
    s_waitcnt vmcnt(4)
    buffer_load_dwordx4 v[224:227], v1, s[8:11], s7 offen offset:0 nt
    s_xor_b32 s7, s49, 0xc1000
    v_dot2_f32_bf16 v59, v204, v28, 0
    v_dot2_f32_bf16 v59, v205, v29, v59
    v_dot2_f32_bf16 v59, v206, v30, v59
    v_dot2_f32_bf16 v59, v207, v31, v59
    s_waitcnt vmcnt(4)
    buffer_load_dwordx4 v[228:231], v1, s[8:11], s7 offen offset:0 nt
    s_xor_b32 s7, s49, 0xc2000
    v_dot2_f32_bf16 v60, v208, v28, 0
    v_dot2_f32_bf16 v60, v209, v29, v60
    v_dot2_f32_bf16 v60, v210, v30, v60
    v_dot2_f32_bf16 v60, v211, v31, v60
    v_add_f32_dpp v58, v58, v58 row_ror:8 row_mask:0xf bank_mask:0x3
    s_nop 1
    v_add_f32_dpp v58, v59, v59 row_ror:8 row_mask:0xf bank_mask:0xc
    s_waitcnt vmcnt(4)
    buffer_load_dwordx4 v[232:235], v1, s[8:11], s7 offen offset:0 nt
    s_xor_b32 s7, s49, 0xc3000
    v_dot2_f32_bf16 v61, v212, v28, 0
    v_dot2_f32_bf16 v61, v213, v29, v61
    v_dot2_f32_bf16 v61, v214, v30, v61
    v_dot2_f32_bf16 v61, v215, v31, v61
    v_add_f32_dpp v56, v56, v56 row_shl:4 row_mask:0xf bank_mask:0x5
    s_nop 1
    v_add_f32_dpp v56, v58, v58 row_shr:4 row_mask:0xf bank_mask:0xa
    s_waitcnt vmcnt(4)
    buffer_load_dwordx4 v[236:239], v1, s[8:11], s7 offen offset:0 nt
    s_xor_b32 s7, s49, 0xc4000
    v_dot2_f32_bf16 v62, v216, v28, 0
    v_dot2_f32_bf16 v62, v217, v29, v62
    v_dot2_f32_bf16 v62, v218, v30, v62
    v_dot2_f32_bf16 v62, v219, v31, v62
    v_add_f32_dpp v60, v60, v60 row_ror:8 row_mask:0xf bank_mask:0x3
    s_nop 1
    v_add_f32_dpp v60, v61, v61 row_ror:8 row_mask:0xf bank_mask:0xc
    s_waitcnt vmcnt(4)
    buffer_load_dwordx4 v[240:243], v1, s[8:11], s7 offen offset:0 nt
    s_xor_b32 s7, s49, 0xc5000
    v_dot2_f32_bf16 v63, v220, v28, 0
    v_dot2_f32_bf16 v63, v221, v29, v63
    v_dot2_f32_bf16 v63, v222, v30, v63
    v_dot2_f32_bf16 v63, v223, v31, v63
    s_waitcnt vmcnt(4)
    buffer_load_dwordx4 v[244:247], v1, s[8:11], s7 offen offset:0 nt
    s_xor_b32 s7, s49, 0xc6000
    v_dot2_f32_bf16 v32, v224, v28, 0
    v_dot2_f32_bf16 v32, v225, v29, v32
    v_dot2_f32_bf16 v32, v226, v30, v32
    v_dot2_f32_bf16 v32, v227, v31, v32
    v_add_f32_dpp v62, v62, v62 row_ror:8 row_mask:0xf bank_mask:0x3
    s_nop 1
    v_add_f32_dpp v62, v63, v63 row_ror:8 row_mask:0xf bank_mask:0xc
    s_waitcnt vmcnt(4)
    buffer_load_dwordx4 v[248:251], v1, s[8:11], s7 offen offset:0 nt
    s_xor_b32 s7, s49, 0xc7000
    v_dot2_f32_bf16 v33, v228, v28, 0
    v_dot2_f32_bf16 v33, v229, v29, v33
    v_dot2_f32_bf16 v33, v230, v30, v33
    v_dot2_f32_bf16 v33, v231, v31, v33
    v_add_f32_dpp v60, v60, v60 row_shl:4 row_mask:0xf bank_mask:0x5
    s_nop 1
    v_add_f32_dpp v60, v62, v62 row_shr:4 row_mask:0xf bank_mask:0xa
    s_waitcnt vmcnt(4)
    buffer_load_dwordx4 v[252:255], v1, s[8:11], s7 offen offset:0 nt
    s_xor_b32 s7, s49, 0xc8000
    v_dot2_f32_bf16 v34, v232, v28, 0
    v_dot2_f32_bf16 v34, v233, v29, v34
    v_dot2_f32_bf16 v34, v234, v30, v34
    v_dot2_f32_bf16 v34, v235, v31, v34
    v_add_f32_dpp v56, v56, v56 quad_perm:[2,3,0,1] row_mask:0xf bank_mask:0xf
    v_add_f32_dpp v60, v60, v60 quad_perm:[2,3,0,1] row_mask:0xf bank_mask:0xf
    v_cndmask_b32 v56, v56, v60, s[44:45]
    v_add_f32_dpp v32, v32, v32 row_ror:8 row_mask:0xf bank_mask:0x3
    s_nop 1
    v_add_f32_dpp v32, v33, v33 row_ror:8 row_mask:0xf bank_mask:0xc
    s_waitcnt vmcnt(4)
    buffer_load_dwordx4 v[96:99], v1, s[8:11], s7 offen offset:0 nt
    s_xor_b32 s7, s49, 0xc9000
    v_dot2_f32_bf16 v35, v236, v28, 0
    v_dot2_f32_bf16 v35, v237, v29, v35
    v_dot2_f32_bf16 v35, v238, v30, v35
    v_dot2_f32_bf16 v35, v239, v31, v35
    v_add_f32_dpp v48, v48, v48 quad_perm:[1,0,3,2] row_mask:0xf bank_mask:0xf
    v_add_f32_dpp v56, v56, v56 quad_perm:[1,0,3,2] row_mask:0xf bank_mask:0xf
    v_cndmask_b32 v48, v48, v56, s[46:47]
    v_cvt_pk_bf16_f32 v80, v48, v48
    v_and_b32 v80, s92, v80
    v_mul_f32 v80, 0x3db504f3, v80
    v_cvt_pk_bf16_f32 v75, v80, v80
    v_and_b32 v75, s92, v75
    v_max_f32 v81, v81, v75
    s_waitcnt vmcnt(4)
    buffer_load_dwordx4 v[100:103], v1, s[8:11], s7 offen offset:0 nt
    s_xor_b32 s7, s49, 0xca000
    v_dot2_f32_bf16 v36, v240, v28, 0
    v_dot2_f32_bf16 v36, v241, v29, v36
    v_dot2_f32_bf16 v36, v242, v30, v36
    v_dot2_f32_bf16 v36, v243, v31, v36
    v_add_f32_dpp v34, v34, v34 row_ror:8 row_mask:0xf bank_mask:0x3
    s_nop 1
    v_add_f32_dpp v34, v35, v35 row_ror:8 row_mask:0xf bank_mask:0xc
    s_waitcnt vmcnt(4)
    buffer_load_dwordx4 v[104:107], v1, s[8:11], s7 offen offset:0 nt
    s_xor_b32 s7, s49, 0xcb000
    v_dot2_f32_bf16 v37, v244, v28, 0
    v_dot2_f32_bf16 v37, v245, v29, v37
    v_dot2_f32_bf16 v37, v246, v30, v37
    v_dot2_f32_bf16 v37, v247, v31, v37
    v_add_f32_dpp v32, v32, v32 row_shl:4 row_mask:0xf bank_mask:0x5
    s_nop 1
    v_add_f32_dpp v32, v34, v34 row_shr:4 row_mask:0xf bank_mask:0xa
    s_waitcnt vmcnt(4)
    buffer_load_dwordx4 v[108:111], v1, s[8:11], s7 offen offset:0 nt
    s_xor_b32 s7, s49, 0xcc000
    v_dot2_f32_bf16 v38, v248, v28, 0
    v_dot2_f32_bf16 v38, v249, v29, v38
    v_dot2_f32_bf16 v38, v250, v30, v38
    v_dot2_f32_bf16 v38, v251, v31, v38
    v_add_f32_dpp v36, v36, v36 row_ror:8 row_mask:0xf bank_mask:0x3
    s_nop 1
    v_add_f32_dpp v36, v37, v37 row_ror:8 row_mask:0xf bank_mask:0xc
    s_waitcnt vmcnt(4)
    buffer_load_dwordx4 v[112:115], v1, s[8:11], s7 offen offset:0 nt
    s_xor_b32 s7, s49, 0xcd000
    v_dot2_f32_bf16 v39, v252, v28, 0
    v_dot2_f32_bf16 v39, v253, v29, v39
    v_dot2_f32_bf16 v39, v254, v30, v39
    v_dot2_f32_bf16 v39, v255, v31, v39
    s_waitcnt vmcnt(4)
    buffer_load_dwordx4 v[116:119], v1, s[8:11], s7 offen offset:0 nt
    s_xor_b32 s7, s49, 0xce000
    v_dot2_f32_bf16 v40, v96, v28, 0
    v_dot2_f32_bf16 v40, v97, v29, v40
    v_dot2_f32_bf16 v40, v98, v30, v40
    v_dot2_f32_bf16 v40, v99, v31, v40
    v_add_f32_dpp v38, v38, v38 row_ror:8 row_mask:0xf bank_mask:0x3
    s_nop 1
    v_add_f32_dpp v38, v39, v39 row_ror:8 row_mask:0xf bank_mask:0xc
    s_waitcnt vmcnt(4)
    buffer_load_dwordx4 v[120:123], v1, s[8:11], s7 offen offset:0 nt
    s_xor_b32 s7, s49, 0xcf000
    v_dot2_f32_bf16 v41, v100, v28, 0
    v_dot2_f32_bf16 v41, v101, v29, v41
    v_dot2_f32_bf16 v41, v102, v30, v41
    v_dot2_f32_bf16 v41, v103, v31, v41
    v_add_f32_dpp v36, v36, v36 row_shl:4 row_mask:0xf bank_mask:0x5
    s_nop 1
    v_add_f32_dpp v36, v38, v38 row_shr:4 row_mask:0xf bank_mask:0xa
    s_waitcnt vmcnt(4)
    buffer_load_dwordx4 v[124:127], v1, s[8:11], s7 offen offset:0 nt
    s_xor_b32 s7, s49, 0xd0000
    v_dot2_f32_bf16 v42, v104, v28, 0
    v_dot2_f32_bf16 v42, v105, v29, v42
    v_dot2_f32_bf16 v42, v106, v30, v42
    v_dot2_f32_bf16 v42, v107, v31, v42
    v_add_f32_dpp v32, v32, v32 quad_perm:[2,3,0,1] row_mask:0xf bank_mask:0xf
    v_add_f32_dpp v36, v36, v36 quad_perm:[2,3,0,1] row_mask:0xf bank_mask:0xf
    v_cndmask_b32 v32, v32, v36, s[44:45]
    v_add_f32_dpp v40, v40, v40 row_ror:8 row_mask:0xf bank_mask:0x3
    s_nop 1
    v_add_f32_dpp v40, v41, v41 row_ror:8 row_mask:0xf bank_mask:0xc
    s_waitcnt vmcnt(4)
    buffer_load_dwordx4 v[128:131], v1, s[8:11], s7 offen offset:0 nt
    s_xor_b32 s7, s49, 0xd1000
    v_dot2_f32_bf16 v43, v108, v28, 0
    v_dot2_f32_bf16 v43, v109, v29, v43
    v_dot2_f32_bf16 v43, v110, v30, v43
    v_dot2_f32_bf16 v43, v111, v31, v43
    s_waitcnt vmcnt(4)
    buffer_load_dwordx4 v[132:135], v1, s[8:11], s7 offen offset:0 nt
    s_xor_b32 s7, s49, 0xd2000
    v_dot2_f32_bf16 v44, v112, v28, 0
    v_dot2_f32_bf16 v44, v113, v29, v44
    v_dot2_f32_bf16 v44, v114, v30, v44
    v_dot2_f32_bf16 v44, v115, v31, v44
    v_add_f32_dpp v42, v42, v42 row_ror:8 row_mask:0xf bank_mask:0x3
    s_nop 1
    v_add_f32_dpp v42, v43, v43 row_ror:8 row_mask:0xf bank_mask:0xc
    s_waitcnt vmcnt(4)
    buffer_load_dwordx4 v[136:139], v1, s[8:11], s7 offen offset:0 nt
    s_xor_b32 s7, s49, 0xd3000
    v_dot2_f32_bf16 v45, v116, v28, 0
    v_dot2_f32_bf16 v45, v117, v29, v45
    v_dot2_f32_bf16 v45, v118, v30, v45
    v_dot2_f32_bf16 v45, v119, v31, v45
    v_add_f32_dpp v40, v40, v40 row_shl:4 row_mask:0xf bank_mask:0x5
    s_nop 1
    v_add_f32_dpp v40, v42, v42 row_shr:4 row_mask:0xf bank_mask:0xa
    s_waitcnt vmcnt(4)
    buffer_load_dwordx4 v[140:143], v1, s[8:11], s7 offen offset:0 nt
    s_xor_b32 s7, s49, 0xd4000
    v_dot2_f32_bf16 v46, v120, v28, 0
    v_dot2_f32_bf16 v46, v121, v29, v46
    v_dot2_f32_bf16 v46, v122, v30, v46
    v_dot2_f32_bf16 v46, v123, v31, v46
    v_add_f32_dpp v44, v44, v44 row_ror:8 row_mask:0xf bank_mask:0x3
    s_nop 1
    v_add_f32_dpp v44, v45, v45 row_ror:8 row_mask:0xf bank_mask:0xc
    s_waitcnt vmcnt(4)
    buffer_load_dwordx4 v[144:147], v1, s[8:11], s7 offen offset:0 nt
    s_xor_b32 s7, s49, 0xd5000
    v_dot2_f32_bf16 v47, v124, v28, 0
    v_dot2_f32_bf16 v47, v125, v29, v47
    v_dot2_f32_bf16 v47, v126, v30, v47
    v_dot2_f32_bf16 v47, v127, v31, v47
    s_waitcnt vmcnt(4)
    buffer_load_dwordx4 v[148:151], v1, s[8:11], s7 offen offset:0 nt
    s_xor_b32 s7, s49, 0xd6000
    v_dot2_f32_bf16 v48, v128, v28, 0
    v_dot2_f32_bf16 v48, v129, v29, v48
    v_dot2_f32_bf16 v48, v130, v30, v48
    v_dot2_f32_bf16 v48, v131, v31, v48
    v_add_f32_dpp v46, v46, v46 row_ror:8 row_mask:0xf bank_mask:0x3
    s_nop 1
    v_add_f32_dpp v46, v47, v47 row_ror:8 row_mask:0xf bank_mask:0xc
    s_waitcnt vmcnt(4)
    buffer_load_dwordx4 v[152:155], v1, s[8:11], s7 offen offset:0 nt
    s_xor_b32 s7, s49, 0xd7000
    v_dot2_f32_bf16 v49, v132, v28, 0
    v_dot2_f32_bf16 v49, v133, v29, v49
    v_dot2_f32_bf16 v49, v134, v30, v49
    v_dot2_f32_bf16 v49, v135, v31, v49
    v_add_f32_dpp v44, v44, v44 row_shl:4 row_mask:0xf bank_mask:0x5
    s_nop 1
    v_add_f32_dpp v44, v46, v46 row_shr:4 row_mask:0xf bank_mask:0xa
    s_waitcnt vmcnt(4)
    buffer_load_dwordx4 v[156:159], v1, s[8:11], s7 offen offset:0 nt
    s_xor_b32 s7, s49, 0xd8000
    v_dot2_f32_bf16 v50, v136, v28, 0
    v_dot2_f32_bf16 v50, v137, v29, v50
    v_dot2_f32_bf16 v50, v138, v30, v50
    v_dot2_f32_bf16 v50, v139, v31, v50
    v_add_f32_dpp v40, v40, v40 quad_perm:[2,3,0,1] row_mask:0xf bank_mask:0xf
    v_add_f32_dpp v44, v44, v44 quad_perm:[2,3,0,1] row_mask:0xf bank_mask:0xf
    v_cndmask_b32 v40, v40, v44, s[44:45]
    v_add_f32_dpp v48, v48, v48 row_ror:8 row_mask:0xf bank_mask:0x3
    s_nop 1
    v_add_f32_dpp v48, v49, v49 row_ror:8 row_mask:0xf bank_mask:0xc
    s_waitcnt vmcnt(4)
    buffer_load_dwordx4 v[160:163], v1, s[8:11], s7 offen offset:0 nt
    s_xor_b32 s7, s49, 0xd9000
    v_dot2_f32_bf16 v51, v140, v28, 0
    v_dot2_f32_bf16 v51, v141, v29, v51
    v_dot2_f32_bf16 v51, v142, v30, v51
    v_dot2_f32_bf16 v51, v143, v31, v51
    v_add_f32_dpp v32, v32, v32 quad_perm:[1,0,3,2] row_mask:0xf bank_mask:0xf
    v_add_f32_dpp v40, v40, v40 quad_perm:[1,0,3,2] row_mask:0xf bank_mask:0xf
    v_cndmask_b32 v32, v32, v40, s[46:47]
    v_cvt_pk_bf16_f32 v80, v32, v32
    v_and_b32 v80, s92, v80
    v_mul_f32 v80, 0x3db504f3, v80
    v_cvt_pk_bf16_f32 v76, v80, v80
    v_and_b32 v76, s92, v76
    v_max_f32 v81, v81, v76
    s_waitcnt vmcnt(4)
    buffer_load_dwordx4 v[164:167], v1, s[8:11], s7 offen offset:0 nt
    s_xor_b32 s7, s49, 0xda000
    v_dot2_f32_bf16 v52, v144, v28, 0
    v_dot2_f32_bf16 v52, v145, v29, v52
    v_dot2_f32_bf16 v52, v146, v30, v52
    v_dot2_f32_bf16 v52, v147, v31, v52
    v_add_f32_dpp v50, v50, v50 row_ror:8 row_mask:0xf bank_mask:0x3
    s_nop 1
    v_add_f32_dpp v50, v51, v51 row_ror:8 row_mask:0xf bank_mask:0xc
    s_waitcnt vmcnt(4)
    buffer_load_dwordx4 v[168:171], v1, s[8:11], s7 offen offset:0 nt
    s_xor_b32 s7, s49, 0xdb000
    v_dot2_f32_bf16 v53, v148, v28, 0
    v_dot2_f32_bf16 v53, v149, v29, v53
    v_dot2_f32_bf16 v53, v150, v30, v53
    v_dot2_f32_bf16 v53, v151, v31, v53
    v_add_f32_dpp v48, v48, v48 row_shl:4 row_mask:0xf bank_mask:0x5
    s_nop 1
    v_add_f32_dpp v48, v50, v50 row_shr:4 row_mask:0xf bank_mask:0xa
    s_waitcnt vmcnt(4)
    buffer_load_dwordx4 v[172:175], v1, s[8:11], s7 offen offset:0 nt
    s_xor_b32 s7, s49, 0xdc000
    v_dot2_f32_bf16 v54, v152, v28, 0
    v_dot2_f32_bf16 v54, v153, v29, v54
    v_dot2_f32_bf16 v54, v154, v30, v54
    v_dot2_f32_bf16 v54, v155, v31, v54
    v_add_f32_dpp v52, v52, v52 row_ror:8 row_mask:0xf bank_mask:0x3
    s_nop 1
    v_add_f32_dpp v52, v53, v53 row_ror:8 row_mask:0xf bank_mask:0xc
    s_waitcnt vmcnt(4)
    buffer_load_dwordx4 v[176:179], v1, s[8:11], s7 offen offset:0 nt
    s_xor_b32 s7, s49, 0xdd000
    v_dot2_f32_bf16 v55, v156, v28, 0
    v_dot2_f32_bf16 v55, v157, v29, v55
    v_dot2_f32_bf16 v55, v158, v30, v55
    v_dot2_f32_bf16 v55, v159, v31, v55
    s_waitcnt vmcnt(4)
    buffer_load_dwordx4 v[180:183], v1, s[8:11], s7 offen offset:0 nt
    s_xor_b32 s7, s49, 0xde000
    v_dot2_f32_bf16 v56, v160, v28, 0
    v_dot2_f32_bf16 v56, v161, v29, v56
    v_dot2_f32_bf16 v56, v162, v30, v56
    v_dot2_f32_bf16 v56, v163, v31, v56
    v_add_f32_dpp v54, v54, v54 row_ror:8 row_mask:0xf bank_mask:0x3
    s_nop 1
    v_add_f32_dpp v54, v55, v55 row_ror:8 row_mask:0xf bank_mask:0xc
    s_waitcnt vmcnt(4)
    buffer_load_dwordx4 v[184:187], v1, s[8:11], s7 offen offset:0 nt
    s_xor_b32 s7, s49, 0xdf000
    v_dot2_f32_bf16 v57, v164, v28, 0
    v_dot2_f32_bf16 v57, v165, v29, v57
    v_dot2_f32_bf16 v57, v166, v30, v57
    v_dot2_f32_bf16 v57, v167, v31, v57
    v_add_f32_dpp v52, v52, v52 row_shl:4 row_mask:0xf bank_mask:0x5
    s_nop 1
    v_add_f32_dpp v52, v54, v54 row_shr:4 row_mask:0xf bank_mask:0xa
    s_waitcnt vmcnt(4)
    buffer_load_dwordx4 v[188:191], v1, s[8:11], s7 offen offset:0 nt
    s_xor_b32 s7, s49, 0xe0000
    v_dot2_f32_bf16 v58, v168, v28, 0
    v_dot2_f32_bf16 v58, v169, v29, v58
    v_dot2_f32_bf16 v58, v170, v30, v58
    v_dot2_f32_bf16 v58, v171, v31, v58
    v_add_f32_dpp v48, v48, v48 quad_perm:[2,3,0,1] row_mask:0xf bank_mask:0xf
    v_add_f32_dpp v52, v52, v52 quad_perm:[2,3,0,1] row_mask:0xf bank_mask:0xf
    v_cndmask_b32 v48, v48, v52, s[44:45]
    v_add_f32_dpp v56, v56, v56 row_ror:8 row_mask:0xf bank_mask:0x3
    s_nop 1
    v_add_f32_dpp v56, v57, v57 row_ror:8 row_mask:0xf bank_mask:0xc
    s_waitcnt vmcnt(4)
    buffer_load_dwordx4 v[192:195], v1, s[8:11], s7 offen offset:0 nt
    s_xor_b32 s7, s49, 0xe1000
    v_dot2_f32_bf16 v59, v172, v28, 0
    v_dot2_f32_bf16 v59, v173, v29, v59
    v_dot2_f32_bf16 v59, v174, v30, v59
    v_dot2_f32_bf16 v59, v175, v31, v59
    s_waitcnt vmcnt(4)
    buffer_load_dwordx4 v[196:199], v1, s[8:11], s7 offen offset:0 nt
    s_xor_b32 s7, s49, 0xe2000
    v_dot2_f32_bf16 v60, v176, v28, 0
    v_dot2_f32_bf16 v60, v177, v29, v60
    v_dot2_f32_bf16 v60, v178, v30, v60
    v_dot2_f32_bf16 v60, v179, v31, v60
    v_add_f32_dpp v58, v58, v58 row_ror:8 row_mask:0xf bank_mask:0x3
    s_nop 1
    v_add_f32_dpp v58, v59, v59 row_ror:8 row_mask:0xf bank_mask:0xc
    s_waitcnt vmcnt(4)
    buffer_load_dwordx4 v[200:203], v1, s[8:11], s7 offen offset:0 nt
    s_xor_b32 s7, s49, 0xe3000
    v_dot2_f32_bf16 v61, v180, v28, 0
    v_dot2_f32_bf16 v61, v181, v29, v61
    v_dot2_f32_bf16 v61, v182, v30, v61
    v_dot2_f32_bf16 v61, v183, v31, v61
    v_add_f32_dpp v56, v56, v56 row_shl:4 row_mask:0xf bank_mask:0x5
    s_nop 1
    v_add_f32_dpp v56, v58, v58 row_shr:4 row_mask:0xf bank_mask:0xa
    s_waitcnt vmcnt(4)
    buffer_load_dwordx4 v[204:207], v1, s[8:11], s7 offen offset:0 nt
    s_xor_b32 s7, s49, 0xe4000
    v_dot2_f32_bf16 v62, v184, v28, 0
    v_dot2_f32_bf16 v62, v185, v29, v62
    v_dot2_f32_bf16 v62, v186, v30, v62
    v_dot2_f32_bf16 v62, v187, v31, v62
    v_add_f32_dpp v60, v60, v60 row_ror:8 row_mask:0xf bank_mask:0x3
    s_nop 1
    v_add_f32_dpp v60, v61, v61 row_ror:8 row_mask:0xf bank_mask:0xc
    s_waitcnt vmcnt(4)
    buffer_load_dwordx4 v[208:211], v1, s[8:11], s7 offen offset:0 nt
    s_xor_b32 s7, s49, 0xe5000
    v_dot2_f32_bf16 v63, v188, v28, 0
    v_dot2_f32_bf16 v63, v189, v29, v63
    v_dot2_f32_bf16 v63, v190, v30, v63
    v_dot2_f32_bf16 v63, v191, v31, v63
    s_waitcnt vmcnt(4)
    buffer_load_dwordx4 v[212:215], v1, s[8:11], s7 offen offset:0 nt
    s_xor_b32 s7, s49, 0xe6000
    v_dot2_f32_bf16 v32, v192, v28, 0
    v_dot2_f32_bf16 v32, v193, v29, v32
    v_dot2_f32_bf16 v32, v194, v30, v32
    v_dot2_f32_bf16 v32, v195, v31, v32
    v_add_f32_dpp v62, v62, v62 row_ror:8 row_mask:0xf bank_mask:0x3
    s_nop 1
    v_add_f32_dpp v62, v63, v63 row_ror:8 row_mask:0xf bank_mask:0xc
    s_waitcnt vmcnt(4)
    buffer_load_dwordx4 v[216:219], v1, s[8:11], s7 offen offset:0 nt
    s_xor_b32 s7, s49, 0xe7000
    v_dot2_f32_bf16 v33, v196, v28, 0
    v_dot2_f32_bf16 v33, v197, v29, v33
    v_dot2_f32_bf16 v33, v198, v30, v33
    v_dot2_f32_bf16 v33, v199, v31, v33
    v_add_f32_dpp v60, v60, v60 row_shl:4 row_mask:0xf bank_mask:0x5
    s_nop 1
    v_add_f32_dpp v60, v62, v62 row_shr:4 row_mask:0xf bank_mask:0xa
    s_waitcnt vmcnt(4)
    buffer_load_dwordx4 v[220:223], v1, s[8:11], s7 offen offset:0 nt
    s_xor_b32 s7, s49, 0xe8000
    v_dot2_f32_bf16 v34, v200, v28, 0
    v_dot2_f32_bf16 v34, v201, v29, v34
    v_dot2_f32_bf16 v34, v202, v30, v34
    v_dot2_f32_bf16 v34, v203, v31, v34
    v_add_f32_dpp v56, v56, v56 quad_perm:[2,3,0,1] row_mask:0xf bank_mask:0xf
    v_add_f32_dpp v60, v60, v60 quad_perm:[2,3,0,1] row_mask:0xf bank_mask:0xf
    v_cndmask_b32 v56, v56, v60, s[44:45]
    v_add_f32_dpp v32, v32, v32 row_ror:8 row_mask:0xf bank_mask:0x3
    s_nop 1
    v_add_f32_dpp v32, v33, v33 row_ror:8 row_mask:0xf bank_mask:0xc
    s_waitcnt vmcnt(4)
    buffer_load_dwordx4 v[224:227], v1, s[8:11], s7 offen offset:0 nt
    s_xor_b32 s7, s49, 0xe9000
    v_dot2_f32_bf16 v35, v204, v28, 0
    v_dot2_f32_bf16 v35, v205, v29, v35
    v_dot2_f32_bf16 v35, v206, v30, v35
    v_dot2_f32_bf16 v35, v207, v31, v35
    v_add_f32_dpp v48, v48, v48 quad_perm:[1,0,3,2] row_mask:0xf bank_mask:0xf
    v_add_f32_dpp v56, v56, v56 quad_perm:[1,0,3,2] row_mask:0xf bank_mask:0xf
    v_cndmask_b32 v48, v48, v56, s[46:47]
    v_cvt_pk_bf16_f32 v80, v48, v48
    v_and_b32 v80, s92, v80
    v_mul_f32 v80, 0x3db504f3, v80
    v_cvt_pk_bf16_f32 v77, v80, v80
    v_and_b32 v77, s92, v77
    v_max_f32 v81, v81, v77
    s_waitcnt vmcnt(4)
    buffer_load_dwordx4 v[228:231], v1, s[8:11], s7 offen offset:0 nt
    s_xor_b32 s7, s49, 0xea000
    v_dot2_f32_bf16 v36, v208, v28, 0
    v_dot2_f32_bf16 v36, v209, v29, v36
    v_dot2_f32_bf16 v36, v210, v30, v36
    v_dot2_f32_bf16 v36, v211, v31, v36
    v_add_f32_dpp v34, v34, v34 row_ror:8 row_mask:0xf bank_mask:0x3
    s_nop 1
    v_add_f32_dpp v34, v35, v35 row_ror:8 row_mask:0xf bank_mask:0xc
    s_waitcnt vmcnt(4)
    buffer_load_dwordx4 v[232:235], v1, s[8:11], s7 offen offset:0 nt
    s_xor_b32 s7, s49, 0xeb000
    v_dot2_f32_bf16 v37, v212, v28, 0
    v_dot2_f32_bf16 v37, v213, v29, v37
    v_dot2_f32_bf16 v37, v214, v30, v37
    v_dot2_f32_bf16 v37, v215, v31, v37
    v_add_f32_dpp v32, v32, v32 row_shl:4 row_mask:0xf bank_mask:0x5
    s_nop 1
    v_add_f32_dpp v32, v34, v34 row_shr:4 row_mask:0xf bank_mask:0xa
    s_waitcnt vmcnt(4)
    buffer_load_dwordx4 v[236:239], v1, s[8:11], s7 offen offset:0 nt
    s_xor_b32 s7, s49, 0xec000
    v_dot2_f32_bf16 v38, v216, v28, 0
    v_dot2_f32_bf16 v38, v217, v29, v38
    v_dot2_f32_bf16 v38, v218, v30, v38
    v_dot2_f32_bf16 v38, v219, v31, v38
    v_add_f32_dpp v36, v36, v36 row_ror:8 row_mask:0xf bank_mask:0x3
    s_nop 1
    v_add_f32_dpp v36, v37, v37 row_ror:8 row_mask:0xf bank_mask:0xc
    s_waitcnt vmcnt(4)
    buffer_load_dwordx4 v[240:243], v1, s[8:11], s7 offen offset:0 nt
    s_xor_b32 s7, s49, 0xed000
    v_dot2_f32_bf16 v39, v220, v28, 0
    v_dot2_f32_bf16 v39, v221, v29, v39
    v_dot2_f32_bf16 v39, v222, v30, v39
    v_dot2_f32_bf16 v39, v223, v31, v39
    s_waitcnt vmcnt(4)
    buffer_load_dwordx4 v[244:247], v1, s[8:11], s7 offen offset:0 nt
    s_xor_b32 s7, s49, 0xee000
    v_dot2_f32_bf16 v40, v224, v28, 0
    v_dot2_f32_bf16 v40, v225, v29, v40
    v_dot2_f32_bf16 v40, v226, v30, v40
    v_dot2_f32_bf16 v40, v227, v31, v40
    v_add_f32_dpp v38, v38, v38 row_ror:8 row_mask:0xf bank_mask:0x3
    s_nop 1
    v_add_f32_dpp v38, v39, v39 row_ror:8 row_mask:0xf bank_mask:0xc
    s_waitcnt vmcnt(4)
    buffer_load_dwordx4 v[248:251], v1, s[8:11], s7 offen offset:0 nt
    s_xor_b32 s7, s49, 0xef000
    v_dot2_f32_bf16 v41, v228, v28, 0
    v_dot2_f32_bf16 v41, v229, v29, v41
    v_dot2_f32_bf16 v41, v230, v30, v41
    v_dot2_f32_bf16 v41, v231, v31, v41
    v_add_f32_dpp v36, v36, v36 row_shl:4 row_mask:0xf bank_mask:0x5
    s_nop 1
    v_add_f32_dpp v36, v38, v38 row_shr:4 row_mask:0xf bank_mask:0xa
    s_waitcnt vmcnt(4)
    buffer_load_dwordx4 v[252:255], v1, s[8:11], s7 offen offset:0 nt
    s_xor_b32 s7, s49, 0xf0000
    v_dot2_f32_bf16 v42, v232, v28, 0
    v_dot2_f32_bf16 v42, v233, v29, v42
    v_dot2_f32_bf16 v42, v234, v30, v42
    v_dot2_f32_bf16 v42, v235, v31, v42
    v_add_f32_dpp v32, v32, v32 quad_perm:[2,3,0,1] row_mask:0xf bank_mask:0xf
    v_add_f32_dpp v36, v36, v36 quad_perm:[2,3,0,1] row_mask:0xf bank_mask:0xf
    v_cndmask_b32 v32, v32, v36, s[44:45]
    v_add_f32_dpp v40, v40, v40 row_ror:8 row_mask:0xf bank_mask:0x3
    s_nop 1
    v_add_f32_dpp v40, v41, v41 row_ror:8 row_mask:0xf bank_mask:0xc
    s_waitcnt vmcnt(4)
    buffer_load_dwordx4 v[96:99], v1, s[8:11], s7 offen offset:0 nt
    s_xor_b32 s7, s49, 0xf1000
    v_dot2_f32_bf16 v43, v236, v28, 0
    v_dot2_f32_bf16 v43, v237, v29, v43
    v_dot2_f32_bf16 v43, v238, v30, v43
    v_dot2_f32_bf16 v43, v239, v31, v43
    s_waitcnt vmcnt(4)
    buffer_load_dwordx4 v[100:103], v1, s[8:11], s7 offen offset:0 nt
    s_xor_b32 s7, s49, 0xf2000
    v_dot2_f32_bf16 v44, v240, v28, 0
    v_dot2_f32_bf16 v44, v241, v29, v44
    v_dot2_f32_bf16 v44, v242, v30, v44
    v_dot2_f32_bf16 v44, v243, v31, v44
    v_add_f32_dpp v42, v42, v42 row_ror:8 row_mask:0xf bank_mask:0x3
    s_nop 1
    v_add_f32_dpp v42, v43, v43 row_ror:8 row_mask:0xf bank_mask:0xc
    s_waitcnt vmcnt(4)
    buffer_load_dwordx4 v[104:107], v1, s[8:11], s7 offen offset:0 nt
    s_xor_b32 s7, s49, 0xf3000
    v_dot2_f32_bf16 v45, v244, v28, 0
    v_dot2_f32_bf16 v45, v245, v29, v45
    v_dot2_f32_bf16 v45, v246, v30, v45
    v_dot2_f32_bf16 v45, v247, v31, v45
    v_add_f32_dpp v40, v40, v40 row_shl:4 row_mask:0xf bank_mask:0x5
    s_nop 1
    v_add_f32_dpp v40, v42, v42 row_shr:4 row_mask:0xf bank_mask:0xa
    s_waitcnt vmcnt(4)
    buffer_load_dwordx4 v[108:111], v1, s[8:11], s7 offen offset:0 nt
    s_xor_b32 s7, s49, 0xf4000
    v_dot2_f32_bf16 v46, v248, v28, 0
    v_dot2_f32_bf16 v46, v249, v29, v46
    v_dot2_f32_bf16 v46, v250, v30, v46
    v_dot2_f32_bf16 v46, v251, v31, v46
    v_add_f32_dpp v44, v44, v44 row_ror:8 row_mask:0xf bank_mask:0x3
    s_nop 1
    v_add_f32_dpp v44, v45, v45 row_ror:8 row_mask:0xf bank_mask:0xc
    s_waitcnt vmcnt(4)
    buffer_load_dwordx4 v[112:115], v1, s[8:11], s7 offen offset:0 nt
    s_xor_b32 s7, s49, 0xf5000
    v_dot2_f32_bf16 v47, v252, v28, 0
    v_dot2_f32_bf16 v47, v253, v29, v47
    v_dot2_f32_bf16 v47, v254, v30, v47
    v_dot2_f32_bf16 v47, v255, v31, v47
    s_waitcnt vmcnt(4)
    buffer_load_dwordx4 v[116:119], v1, s[8:11], s7 offen offset:0 nt
    s_xor_b32 s7, s49, 0xf6000
    v_dot2_f32_bf16 v48, v96, v28, 0
    v_dot2_f32_bf16 v48, v97, v29, v48
    v_dot2_f32_bf16 v48, v98, v30, v48
    v_dot2_f32_bf16 v48, v99, v31, v48
    v_add_f32_dpp v46, v46, v46 row_ror:8 row_mask:0xf bank_mask:0x3
    s_nop 1
    v_add_f32_dpp v46, v47, v47 row_ror:8 row_mask:0xf bank_mask:0xc
    s_waitcnt vmcnt(4)
    buffer_load_dwordx4 v[120:123], v1, s[8:11], s7 offen offset:0 nt
    s_xor_b32 s7, s49, 0xf7000
    v_dot2_f32_bf16 v49, v100, v28, 0
    v_dot2_f32_bf16 v49, v101, v29, v49
    v_dot2_f32_bf16 v49, v102, v30, v49
    v_dot2_f32_bf16 v49, v103, v31, v49
    v_add_f32_dpp v44, v44, v44 row_shl:4 row_mask:0xf bank_mask:0x5
    s_nop 1
    v_add_f32_dpp v44, v46, v46 row_shr:4 row_mask:0xf bank_mask:0xa
    s_waitcnt vmcnt(4)
    buffer_load_dwordx4 v[124:127], v1, s[8:11], s7 offen offset:0 nt
    s_xor_b32 s7, s49, 0xf8000
    v_dot2_f32_bf16 v50, v104, v28, 0
    v_dot2_f32_bf16 v50, v105, v29, v50
    v_dot2_f32_bf16 v50, v106, v30, v50
    v_dot2_f32_bf16 v50, v107, v31, v50
    v_add_f32_dpp v40, v40, v40 quad_perm:[2,3,0,1] row_mask:0xf bank_mask:0xf
    v_add_f32_dpp v44, v44, v44 quad_perm:[2,3,0,1] row_mask:0xf bank_mask:0xf
    v_cndmask_b32 v40, v40, v44, s[44:45]
    v_add_f32_dpp v48, v48, v48 row_ror:8 row_mask:0xf bank_mask:0x3
    s_nop 1
    v_add_f32_dpp v48, v49, v49 row_ror:8 row_mask:0xf bank_mask:0xc
    s_waitcnt vmcnt(4)
    buffer_load_dwordx4 v[128:131], v1, s[8:11], s7 offen offset:0 nt
    s_xor_b32 s7, s49, 0xf9000
    v_dot2_f32_bf16 v51, v108, v28, 0
    v_dot2_f32_bf16 v51, v109, v29, v51
    v_dot2_f32_bf16 v51, v110, v30, v51
    v_dot2_f32_bf16 v51, v111, v31, v51
    v_add_f32_dpp v32, v32, v32 quad_perm:[1,0,3,2] row_mask:0xf bank_mask:0xf
    v_add_f32_dpp v40, v40, v40 quad_perm:[1,0,3,2] row_mask:0xf bank_mask:0xf
    v_cndmask_b32 v32, v32, v40, s[46:47]
    v_cvt_pk_bf16_f32 v80, v32, v32
    v_and_b32 v80, s92, v80
    v_mul_f32 v80, 0x3db504f3, v80
    v_cvt_pk_bf16_f32 v78, v80, v80
    v_and_b32 v78, s92, v78
    v_max_f32 v81, v81, v78
    s_waitcnt vmcnt(4)
    buffer_load_dwordx4 v[132:135], v1, s[8:11], s7 offen offset:0 nt
    s_xor_b32 s7, s49, 0xfa000
    v_dot2_f32_bf16 v52, v112, v28, 0
    v_dot2_f32_bf16 v52, v113, v29, v52
    v_dot2_f32_bf16 v52, v114, v30, v52
    v_dot2_f32_bf16 v52, v115, v31, v52
    v_add_f32_dpp v50, v50, v50 row_ror:8 row_mask:0xf bank_mask:0x3
    s_nop 1
    v_add_f32_dpp v50, v51, v51 row_ror:8 row_mask:0xf bank_mask:0xc
    s_waitcnt vmcnt(4)
    buffer_load_dwordx4 v[136:139], v1, s[8:11], s7 offen offset:0 nt
    s_xor_b32 s7, s49, 0xfb000
    v_dot2_f32_bf16 v53, v116, v28, 0
    v_dot2_f32_bf16 v53, v117, v29, v53
    v_dot2_f32_bf16 v53, v118, v30, v53
    v_dot2_f32_bf16 v53, v119, v31, v53
    v_add_f32_dpp v48, v48, v48 row_shl:4 row_mask:0xf bank_mask:0x5
    s_nop 1
    v_add_f32_dpp v48, v50, v50 row_shr:4 row_mask:0xf bank_mask:0xa
    s_waitcnt vmcnt(4)
    buffer_load_dwordx4 v[140:143], v1, s[8:11], s7 offen offset:0 nt
    s_xor_b32 s7, s49, 0xfc000
    v_dot2_f32_bf16 v54, v120, v28, 0
    v_dot2_f32_bf16 v54, v121, v29, v54
    v_dot2_f32_bf16 v54, v122, v30, v54
    v_dot2_f32_bf16 v54, v123, v31, v54
    v_add_f32_dpp v52, v52, v52 row_ror:8 row_mask:0xf bank_mask:0x3
    s_nop 1
    v_add_f32_dpp v52, v53, v53 row_ror:8 row_mask:0xf bank_mask:0xc
    s_waitcnt vmcnt(4)
    buffer_load_dwordx4 v[144:147], v1, s[8:11], s7 offen offset:0 nt
    s_xor_b32 s7, s49, 0xfd000
    v_dot2_f32_bf16 v55, v124, v28, 0
    v_dot2_f32_bf16 v55, v125, v29, v55
    v_dot2_f32_bf16 v55, v126, v30, v55
    v_dot2_f32_bf16 v55, v127, v31, v55
    s_waitcnt vmcnt(4)
    buffer_load_dwordx4 v[148:151], v1, s[8:11], s7 offen offset:0 nt
    s_xor_b32 s7, s49, 0xfe000
    v_dot2_f32_bf16 v56, v128, v28, 0
    v_dot2_f32_bf16 v56, v129, v29, v56
    v_dot2_f32_bf16 v56, v130, v30, v56
    v_dot2_f32_bf16 v56, v131, v31, v56
    v_add_f32_dpp v54, v54, v54 row_ror:8 row_mask:0xf bank_mask:0x3
    s_nop 1
    v_add_f32_dpp v54, v55, v55 row_ror:8 row_mask:0xf bank_mask:0xc
    s_waitcnt vmcnt(4)
    buffer_load_dwordx4 v[152:155], v1, s[8:11], s7 offen offset:0 nt
    s_xor_b32 s7, s49, 0xff000
    v_dot2_f32_bf16 v57, v132, v28, 0
    v_dot2_f32_bf16 v57, v133, v29, v57
    v_dot2_f32_bf16 v57, v134, v30, v57
    v_dot2_f32_bf16 v57, v135, v31, v57
    v_add_f32_dpp v52, v52, v52 row_shl:4 row_mask:0xf bank_mask:0x5
    s_nop 1
    v_add_f32_dpp v52, v54, v54 row_shr:4 row_mask:0xf bank_mask:0xa
    s_waitcnt vmcnt(4)
    buffer_load_dwordx4 v[156:159], v1, s[8:11], s7 offen offset:0 nt
    s_xor_b32 s7, s49, 0x0
    v_dot2_f32_bf16 v58, v136, v28, 0
    v_dot2_f32_bf16 v58, v137, v29, v58
    v_dot2_f32_bf16 v58, v138, v30, v58
    v_dot2_f32_bf16 v58, v139, v31, v58
    v_add_f32_dpp v48, v48, v48 quad_perm:[2,3,0,1] row_mask:0xf bank_mask:0xf
    v_add_f32_dpp v52, v52, v52 quad_perm:[2,3,0,1] row_mask:0xf bank_mask:0xf
    v_cndmask_b32 v48, v48, v52, s[44:45]
    v_add_f32_dpp v56, v56, v56 row_ror:8 row_mask:0xf bank_mask:0x3
    s_nop 1
    v_add_f32_dpp v56, v57, v57 row_ror:8 row_mask:0xf bank_mask:0xc
    s_waitcnt vmcnt(4)
    buffer_load_dwordx4 v[160:163], v1, s[12:15], s7 offen offset:0 nt
    s_xor_b32 s7, s49, 0x1000
    v_dot2_f32_bf16 v59, v140, v28, 0
    v_dot2_f32_bf16 v59, v141, v29, v59
    v_dot2_f32_bf16 v59, v142, v30, v59
    v_dot2_f32_bf16 v59, v143, v31, v59
    s_waitcnt vmcnt(4)
    buffer_load_dwordx4 v[164:167], v1, s[12:15], s7 offen offset:0 nt
    s_xor_b32 s7, s49, 0x2000
    v_dot2_f32_bf16 v60, v144, v28, 0
    v_dot2_f32_bf16 v60, v145, v29, v60
    v_dot2_f32_bf16 v60, v146, v30, v60
    v_dot2_f32_bf16 v60, v147, v31, v60
    v_add_f32_dpp v58, v58, v58 row_ror:8 row_mask:0xf bank_mask:0x3
    s_nop 1
    v_add_f32_dpp v58, v59, v59 row_ror:8 row_mask:0xf bank_mask:0xc
    s_waitcnt vmcnt(4)
    buffer_load_dwordx4 v[168:171], v1, s[12:15], s7 offen offset:0 nt
    s_xor_b32 s7, s49, 0x3000
    v_dot2_f32_bf16 v61, v148, v28, 0
    v_dot2_f32_bf16 v61, v149, v29, v61
    v_dot2_f32_bf16 v61, v150, v30, v61
    v_dot2_f32_bf16 v61, v151, v31, v61
    v_add_f32_dpp v56, v56, v56 row_shl:4 row_mask:0xf bank_mask:0x5
    s_nop 1
    v_add_f32_dpp v56, v58, v58 row_shr:4 row_mask:0xf bank_mask:0xa
    s_waitcnt vmcnt(4)
    buffer_load_dwordx4 v[172:175], v1, s[12:15], s7 offen offset:0 nt
    s_xor_b32 s7, s49, 0x4000
    v_dot2_f32_bf16 v62, v152, v28, 0
    v_dot2_f32_bf16 v62, v153, v29, v62
    v_dot2_f32_bf16 v62, v154, v30, v62
    v_dot2_f32_bf16 v62, v155, v31, v62
    v_add_f32_dpp v60, v60, v60 row_ror:8 row_mask:0xf bank_mask:0x3
    s_nop 1
    v_add_f32_dpp v60, v61, v61 row_ror:8 row_mask:0xf bank_mask:0xc
    s_waitcnt vmcnt(4)
    buffer_load_dwordx4 v[176:179], v1, s[12:15], s7 offen offset:0 nt
    s_xor_b32 s7, s49, 0x5000
    v_dot2_f32_bf16 v63, v156, v28, 0
    v_dot2_f32_bf16 v63, v157, v29, v63
    v_dot2_f32_bf16 v63, v158, v30, v63
    v_dot2_f32_bf16 v63, v159, v31, v63
    buffer_load_dwordx4 v[180:183], v1, s[12:15], s7 offen offset:0 nt
    s_xor_b32 s7, s49, 0x6000
    buffer_load_dwordx4 v[184:187], v1, s[12:15], s7 offen offset:0 nt
    s_xor_b32 s7, s49, 0x7000
    buffer_load_dwordx4 v[188:191], v1, s[12:15], s7 offen offset:0 nt
    s_xor_b32 s7, s49, 0x8000
    buffer_load_dwordx4 v[192:195], v1, s[12:15], s7 offen offset:0 nt
    s_xor_b32 s7, s49, 0x9000
    v_add_f32_dpp v62, v62, v62 row_ror:8 row_mask:0xf bank_mask:0x3
    s_nop 1
    v_add_f32_dpp v62, v63, v63 row_ror:8 row_mask:0xf bank_mask:0xc
    v_add_f32_dpp v60, v60, v60 row_shl:4 row_mask:0xf bank_mask:0x5
    s_nop 1
    v_add_f32_dpp v60, v62, v62 row_shr:4 row_mask:0xf bank_mask:0xa
    v_add_f32_dpp v56, v56, v56 quad_perm:[2,3,0,1] row_mask:0xf bank_mask:0xf
    s_nop 0
    v_add_f32_dpp v60, v60, v60 quad_perm:[2,3,0,1] row_mask:0xf bank_mask:0xf
    v_cndmask_b32 v56, v56, v60, s[44:45]
    v_add_f32_dpp v48, v48, v48 quad_perm:[1,0,3,2] row_mask:0xf bank_mask:0xf
    s_nop 0
    v_add_f32_dpp v56, v56, v56 quad_perm:[1,0,3,2] row_mask:0xf bank_mask:0xf
    v_cndmask_b32 v48, v48, v56, s[46:47]
    v_cvt_pk_bf16_f32 v80, v48, v48
    v_and_b32 v80, s92, v80
    v_mul_f32 v80, 0x3db504f3, v80
    v_cvt_pk_bf16_f32 v79, v80, v80
    v_and_b32 v79, s92, v79
    v_max_f32 v81, v81, v79
    s_nop 1
    v_max_f32_dpp v81, v81, v81 row_ror:8 row_mask:0xf bank_mask:0xf
    s_nop 1
    v_max_f32_dpp v81, v81, v81 row_ror:4 row_mask:0xf bank_mask:0xf
    s_nop 1
    v_max_f32_dpp v81, v81, v81 row_ror:2 row_mask:0xf bank_mask:0xf
    s_nop 1
    v_max_f32_dpp v81, v81, v81 row_ror:1 row_mask:0xf bank_mask:0xf
    v_mov_b32 v80, v81
    s_nop 1
    v_permlane16_swap_b32 v81, v80
    v_max_f32 v81, v81, v80
    v_mov_b32 v80, v81
    s_nop 1
    v_permlane32_swap_b32 v81, v80
    v_max_f32 v81, v81, v80
    v_mul_f32 v83, s93, v81
    v_fma_f32 v64, v64, s93, -v83
    v_fma_f32 v65, v65, s93, -v83
    v_fma_f32 v66, v66, s93, -v83
    v_fma_f32 v67, v67, s93, -v83
    v_fma_f32 v68, v68, s93, -v83
    v_fma_f32 v69, v69, s93, -v83
    v_fma_f32 v70, v70, s93, -v83
    v_fma_f32 v71, v71, s93, -v83
    v_fma_f32 v72, v72, s93, -v83
    v_fma_f32 v73, v73, s93, -v83
    v_fma_f32 v74, v74, s93, -v83
    v_fma_f32 v75, v75, s93, -v83
    v_fma_f32 v76, v76, s93, -v83
    v_fma_f32 v77, v77, s93, -v83
    v_fma_f32 v78, v78, s93, -v83
    v_fma_f32 v79, v79, s93, -v83
    v_exp_f32 v64, v64
    v_exp_f32 v65, v65
    v_exp_f32 v66, v66
    v_exp_f32 v67, v67
    v_exp_f32 v68, v68
    v_exp_f32 v69, v69
    v_exp_f32 v70, v70
    v_exp_f32 v71, v71
    v_exp_f32 v72, v72
    v_exp_f32 v73, v73
    v_exp_f32 v74, v74
    v_exp_f32 v75, v75
    v_exp_f32 v76, v76
    v_exp_f32 v77, v77
    v_exp_f32 v78, v78
    v_exp_f32 v79, v79
    v_add_f32 v32, v64, v65
    v_add_f32 v33, v66, v67
    v_add_f32 v34, v68, v69
    v_add_f32 v35, v70, v71
    v_add_f32 v36, v72, v73
    v_add_f32 v37, v74, v75
    v_add_f32 v38, v76, v77
    v_add_f32 v39, v78, v79
    v_add_f32 v32, v32, v36
    v_add_f32 v33, v33, v37
    v_add_f32 v34, v34, v38
    v_add_f32 v35, v35, v39
    v_add_f32 v32, v32, v34
    v_add_f32 v33, v33, v35
    v_add_f32 v32, v32, v33
    v_mov_b32 v82, v32
    s_nop 1
    v_add_f32_dpp v82, v82, v82 row_ror:8 row_mask:0xf bank_mask:0xf
    s_nop 1
    v_add_f32_dpp v82, v82, v82 row_ror:4 row_mask:0xf bank_mask:0xf
    s_nop 1
    v_add_f32_dpp v82, v82, v82 row_ror:2 row_mask:0xf bank_mask:0xf
    s_nop 1
    v_add_f32_dpp v82, v82, v82 row_ror:1 row_mask:0xf bank_mask:0xf
    v_mov_b32 v80, v82
    s_nop 1
    v_permlane16_swap_b32 v82, v80
    v_add_f32 v82, v82, v80
    v_mov_b32 v80, v82
    s_nop 1
    v_permlane32_swap_b32 v82, v80
    v_add_f32 v82, v82, v80
    v_mov_b32 v32, v81
    v_mov_b32 v33, v82
    s_lshl_b32 s48, s5, 3
    v_mov_b32 v5, s48
    s_mov_b64 exec, 1
    ds_write_b64 v5, v[32:33] offset:4096
    s_mov_b64 exec, -1
    v_mov_b32 v5, 0
    s_waitcnt lgkmcnt(0)
    s_barrier
    ds_read_b128 v[32:35], v5 offset:4096
    ds_read_b128 v[36:39], v5 offset:4112
    s_waitcnt vmcnt(4)
    buffer_load_dwordx4 v[196:199], v1, s[12:15], s7 offen offset:0 nt
    s_xor_b32 s7, s49, 0xa000
    s_waitcnt lgkmcnt(0)
    v_max3_f32 v40, v32, v34, v36
    v_max_f32 v40, v40, v38
    v_sub_f32 v32, v32, v40
    v_sub_f32 v34, v34, v40
    v_sub_f32 v36, v36, v40
    v_sub_f32 v38, v38, v40
    v_sub_f32 v81, v81, v40
    v_mul_f32 v32, s93, v32
    v_mul_f32 v34, s93, v34
    v_mul_f32 v36, s93, v36
    v_mul_f32 v38, s93, v38
    v_mul_f32 v81, s93, v81
    v_exp_f32 v32, v32
    v_exp_f32 v34, v34
    v_exp_f32 v36, v36
    v_exp_f32 v38, v38
    v_exp_f32 v81, v81
    v_mul_f32 v82, v32, v33
    v_fma_f32 v82, v34, v35, v82
    v_fma_f32 v82, v36, v37, v82
    v_fma_f32 v82, v38, v39, v82
    v_rcp_f32 v83, v82
    s_nop 0
    v_fma_f32 v80, -v82, v83, 1.0
    v_fma_f32 v83, v80, v83, v83
    v_mul_f32 v83, v83, v81
    v_mul_f32 v64, v64, v83
    v_mul_f32 v65, v65, v83
    v_mul_f32 v66, v66, v83
    v_mul_f32 v67, v67, v83
    v_mul_f32 v68, v68, v83
    v_mul_f32 v69, v69, v83
    v_mul_f32 v70, v70, v83
    v_mul_f32 v71, v71, v83
    v_mul_f32 v72, v72, v83
    v_mul_f32 v73, v73, v83
    v_mul_f32 v74, v74, v83
    v_mul_f32 v75, v75, v83
    v_mul_f32 v76, v76, v83
    v_mul_f32 v77, v77, v83
    v_mul_f32 v78, v78, v83
    v_mul_f32 v79, v79, v83
    v_cvt_pk_bf16_f32 v64, v64, v64
    v_cvt_pk_bf16_f32 v65, v65, v65
    v_cvt_pk_bf16_f32 v66, v66, v66
    v_cvt_pk_bf16_f32 v67, v67, v67
    v_cvt_pk_bf16_f32 v68, v68, v68
    v_cvt_pk_bf16_f32 v69, v69, v69
    v_cvt_pk_bf16_f32 v70, v70, v70
    v_cvt_pk_bf16_f32 v71, v71, v71
    v_cvt_pk_bf16_f32 v72, v72, v72
    v_cvt_pk_bf16_f32 v73, v73, v73
    v_cvt_pk_bf16_f32 v74, v74, v74
    v_cvt_pk_bf16_f32 v75, v75, v75
    v_cvt_pk_bf16_f32 v76, v76, v76
    v_cvt_pk_bf16_f32 v77, v77, v77
    v_cvt_pk_bf16_f32 v78, v78, v78
    v_cvt_pk_bf16_f32 v79, v79, v79
    v_and_b32_dpp v16, v64, v6 row_newbcast:8 row_mask:0xf bank_mask:0xf
    v_and_b32_dpp v17, v64, v7 row_newbcast:8 row_mask:0xf bank_mask:0xf
    v_and_b32_dpp v18, v64, v8 row_newbcast:8 row_mask:0xf bank_mask:0xf
    v_and_b32_dpp v19, v64, v9 row_newbcast:8 row_mask:0xf bank_mask:0xf
    v_and_b32_dpp v20, v64, v6 row_newbcast:12 row_mask:0xf bank_mask:0xf
    v_and_b32_dpp v21, v64, v7 row_newbcast:12 row_mask:0xf bank_mask:0xf
    v_and_b32_dpp v22, v64, v8 row_newbcast:12 row_mask:0xf bank_mask:0xf
    v_and_b32_dpp v23, v64, v9 row_newbcast:12 row_mask:0xf bank_mask:0xf
    v_lshlrev_b32 v5, 5, v3
    v_lshl_add_u32 v5, v4, 4, v5
    s_lshl_b32 s48, s5, 9
    v_add_u32 v5, s48, v5
    s_waitcnt vmcnt(4)
    buffer_load_dwordx4 v[200:203], v1, s[12:15], s7 offen offset:0 nt
    s_xor_b32 s7, s49, 0xb000
    v_mfma_f32_16x16x32_bf16 v[12:15], v[16:19], v[160:163], 0
    v_and_b32_dpp v24, v64, v6 row_newbcast:10 row_mask:0xf bank_mask:0xf
    v_and_b32_dpp v25, v64, v7 row_newbcast:10 row_mask:0xf bank_mask:0xf
    v_and_b32_dpp v26, v64, v8 row_newbcast:10 row_mask:0xf bank_mask:0xf
    v_and_b32_dpp v27, v64, v9 row_newbcast:10 row_mask:0xf bank_mask:0xf
    v_mfma_f32_16x16x32_bf16 v[12:15], v[20:23], v[164:167], v[12:15]
    v_and_b32_dpp v16, v64, v6 row_newbcast:14 row_mask:0xf bank_mask:0xf
    v_and_b32_dpp v17, v64, v7 row_newbcast:14 row_mask:0xf bank_mask:0xf
    v_and_b32_dpp v18, v64, v8 row_newbcast:14 row_mask:0xf bank_mask:0xf
    v_and_b32_dpp v19, v64, v9 row_newbcast:14 row_mask:0xf bank_mask:0xf
    s_waitcnt vmcnt(4)
    buffer_load_dwordx4 v[204:207], v1, s[12:15], s7 offen offset:0 nt
    s_xor_b32 s7, s49, 0xc000
    v_mfma_f32_16x16x32_bf16 v[12:15], v[24:27], v[168:171], v[12:15]
    v_and_b32_dpp v20, v64, v6 row_newbcast:9 row_mask:0xf bank_mask:0xf
    v_and_b32_dpp v21, v64, v7 row_newbcast:9 row_mask:0xf bank_mask:0xf
    v_and_b32_dpp v22, v64, v8 row_newbcast:9 row_mask:0xf bank_mask:0xf
    v_and_b32_dpp v23, v64, v9 row_newbcast:9 row_mask:0xf bank_mask:0xf
    v_mfma_f32_16x16x32_bf16 v[12:15], v[16:19], v[172:175], v[12:15]
    v_and_b32_dpp v24, v64, v6 row_newbcast:13 row_mask:0xf bank_mask:0xf
    v_and_b32_dpp v25, v64, v7 row_newbcast:13 row_mask:0xf bank_mask:0xf
    v_and_b32_dpp v26, v64, v8 row_newbcast:13 row_mask:0xf bank_mask:0xf
    v_and_b32_dpp v27, v64, v9 row_newbcast:13 row_mask:0xf bank_mask:0xf
    s_waitcnt vmcnt(4)
    buffer_load_dwordx4 v[208:211], v1, s[12:15], s7 offen offset:0 nt
    s_xor_b32 s7, s49, 0xd000
    v_mfma_f32_16x16x32_bf16 v[12:15], v[20:23], v[176:179], v[12:15]
    v_and_b32_dpp v16, v64, v6 row_newbcast:11 row_mask:0xf bank_mask:0xf
    v_and_b32_dpp v17, v64, v7 row_newbcast:11 row_mask:0xf bank_mask:0xf
    v_and_b32_dpp v18, v64, v8 row_newbcast:11 row_mask:0xf bank_mask:0xf
    v_and_b32_dpp v19, v64, v9 row_newbcast:11 row_mask:0xf bank_mask:0xf
    v_mfma_f32_16x16x32_bf16 v[12:15], v[24:27], v[180:183], v[12:15]
    v_and_b32_dpp v20, v64, v6 row_newbcast:15 row_mask:0xf bank_mask:0xf
    v_and_b32_dpp v21, v64, v7 row_newbcast:15 row_mask:0xf bank_mask:0xf
    v_and_b32_dpp v22, v64, v8 row_newbcast:15 row_mask:0xf bank_mask:0xf
    v_and_b32_dpp v23, v64, v9 row_newbcast:15 row_mask:0xf bank_mask:0xf
    s_waitcnt vmcnt(4)
    buffer_load_dwordx4 v[212:215], v1, s[12:15], s7 offen offset:0 nt
    s_xor_b32 s7, s49, 0xe000
    v_mfma_f32_16x16x32_bf16 v[12:15], v[16:19], v[184:187], v[12:15]
    v_and_b32_dpp v24, v65, v6 row_newbcast:8 row_mask:0xf bank_mask:0xf
    v_and_b32_dpp v25, v65, v7 row_newbcast:8 row_mask:0xf bank_mask:0xf
    v_and_b32_dpp v26, v65, v8 row_newbcast:8 row_mask:0xf bank_mask:0xf
    v_and_b32_dpp v27, v65, v9 row_newbcast:8 row_mask:0xf bank_mask:0xf
    v_mfma_f32_16x16x32_bf16 v[12:15], v[20:23], v[188:191], v[12:15]
    v_and_b32_dpp v16, v65, v6 row_newbcast:12 row_mask:0xf bank_mask:0xf
    v_and_b32_dpp v17, v65, v7 row_newbcast:12 row_mask:0xf bank_mask:0xf
    v_and_b32_dpp v18, v65, v8 row_newbcast:12 row_mask:0xf bank_mask:0xf
    v_and_b32_dpp v19, v65, v9 row_newbcast:12 row_mask:0xf bank_mask:0xf
    s_waitcnt vmcnt(4)
    buffer_load_dwordx4 v[216:219], v1, s[12:15], s7 offen offset:0 nt
    s_xor_b32 s7, s49, 0xf000
    v_mfma_f32_16x16x32_bf16 v[12:15], v[24:27], v[192:195], v[12:15]
    v_and_b32_dpp v20, v65, v6 row_newbcast:10 row_mask:0xf bank_mask:0xf
    v_and_b32_dpp v21, v65, v7 row_newbcast:10 row_mask:0xf bank_mask:0xf
    v_and_b32_dpp v22, v65, v8 row_newbcast:10 row_mask:0xf bank_mask:0xf
    v_and_b32_dpp v23, v65, v9 row_newbcast:10 row_mask:0xf bank_mask:0xf
    v_mfma_f32_16x16x32_bf16 v[12:15], v[16:19], v[196:199], v[12:15]
    v_and_b32_dpp v24, v65, v6 row_newbcast:14 row_mask:0xf bank_mask:0xf
    v_and_b32_dpp v25, v65, v7 row_newbcast:14 row_mask:0xf bank_mask:0xf
    v_and_b32_dpp v26, v65, v8 row_newbcast:14 row_mask:0xf bank_mask:0xf
    v_and_b32_dpp v27, v65, v9 row_newbcast:14 row_mask:0xf bank_mask:0xf
    s_waitcnt vmcnt(4)
    buffer_load_dwordx4 v[220:223], v1, s[12:15], s7 offen offset:0 nt
    s_xor_b32 s7, s49, 0x10000
    v_mfma_f32_16x16x32_bf16 v[12:15], v[20:23], v[200:203], v[12:15]
    v_and_b32_dpp v16, v65, v6 row_newbcast:9 row_mask:0xf bank_mask:0xf
    v_and_b32_dpp v17, v65, v7 row_newbcast:9 row_mask:0xf bank_mask:0xf
    v_and_b32_dpp v18, v65, v8 row_newbcast:9 row_mask:0xf bank_mask:0xf
    v_and_b32_dpp v19, v65, v9 row_newbcast:9 row_mask:0xf bank_mask:0xf
    s_waitcnt vmcnt(4)
    buffer_load_dwordx4 v[224:227], v1, s[12:15], s7 offen offset:0 nt
    s_xor_b32 s7, s49, 0x11000
    v_mfma_f32_16x16x32_bf16 v[12:15], v[24:27], v[204:207], v[12:15]
    v_and_b32_dpp v20, v65, v6 row_newbcast:13 row_mask:0xf bank_mask:0xf
    v_and_b32_dpp v21, v65, v7 row_newbcast:13 row_mask:0xf bank_mask:0xf
    v_and_b32_dpp v22, v65, v8 row_newbcast:13 row_mask:0xf bank_mask:0xf
    v_and_b32_dpp v23, v65, v9 row_newbcast:13 row_mask:0xf bank_mask:0xf
    s_waitcnt vmcnt(4)
    buffer_load_dwordx4 v[228:231], v1, s[12:15], s7 offen offset:0 nt
    s_xor_b32 s7, s49, 0x12000
    v_mfma_f32_16x16x32_bf16 v[12:15], v[16:19], v[208:211], v[12:15]
    v_and_b32_dpp v24, v65, v6 row_newbcast:11 row_mask:0xf bank_mask:0xf
    v_and_b32_dpp v25, v65, v7 row_newbcast:11 row_mask:0xf bank_mask:0xf
    v_and_b32_dpp v26, v65, v8 row_newbcast:11 row_mask:0xf bank_mask:0xf
    v_and_b32_dpp v27, v65, v9 row_newbcast:11 row_mask:0xf bank_mask:0xf
    s_waitcnt vmcnt(4)
    buffer_load_dwordx4 v[232:235], v1, s[12:15], s7 offen offset:0 nt
    s_xor_b32 s7, s49, 0x13000
    v_mfma_f32_16x16x32_bf16 v[12:15], v[20:23], v[212:215], v[12:15]
    v_and_b32_dpp v16, v65, v6 row_newbcast:15 row_mask:0xf bank_mask:0xf
    v_and_b32_dpp v17, v65, v7 row_newbcast:15 row_mask:0xf bank_mask:0xf
    v_and_b32_dpp v18, v65, v8 row_newbcast:15 row_mask:0xf bank_mask:0xf
    v_and_b32_dpp v19, v65, v9 row_newbcast:15 row_mask:0xf bank_mask:0xf
    s_waitcnt vmcnt(4)
    buffer_load_dwordx4 v[236:239], v1, s[12:15], s7 offen offset:0 nt
    s_xor_b32 s7, s49, 0x14000
    v_mfma_f32_16x16x32_bf16 v[12:15], v[24:27], v[216:219], v[12:15]
    v_and_b32_dpp v20, v66, v6 row_newbcast:8 row_mask:0xf bank_mask:0xf
    v_and_b32_dpp v21, v66, v7 row_newbcast:8 row_mask:0xf bank_mask:0xf
    v_and_b32_dpp v22, v66, v8 row_newbcast:8 row_mask:0xf bank_mask:0xf
    v_and_b32_dpp v23, v66, v9 row_newbcast:8 row_mask:0xf bank_mask:0xf
    s_waitcnt vmcnt(4)
    buffer_load_dwordx4 v[240:243], v1, s[12:15], s7 offen offset:0 nt
    s_xor_b32 s7, s49, 0x15000
    v_mfma_f32_16x16x32_bf16 v[12:15], v[16:19], v[220:223], v[12:15]
    v_and_b32_dpp v24, v66, v6 row_newbcast:12 row_mask:0xf bank_mask:0xf
    v_and_b32_dpp v25, v66, v7 row_newbcast:12 row_mask:0xf bank_mask:0xf
    v_and_b32_dpp v26, v66, v8 row_newbcast:12 row_mask:0xf bank_mask:0xf
    v_and_b32_dpp v27, v66, v9 row_newbcast:12 row_mask:0xf bank_mask:0xf
    s_waitcnt vmcnt(4)
    buffer_load_dwordx4 v[244:247], v1, s[12:15], s7 offen offset:0 nt
    s_xor_b32 s7, s49, 0x16000
    v_mfma_f32_16x16x32_bf16 v[12:15], v[20:23], v[224:227], v[12:15]
    v_and_b32_dpp v16, v66, v6 row_newbcast:10 row_mask:0xf bank_mask:0xf
    v_and_b32_dpp v17, v66, v7 row_newbcast:10 row_mask:0xf bank_mask:0xf
    v_and_b32_dpp v18, v66, v8 row_newbcast:10 row_mask:0xf bank_mask:0xf
    v_and_b32_dpp v19, v66, v9 row_newbcast:10 row_mask:0xf bank_mask:0xf
    s_waitcnt vmcnt(4)
    buffer_load_dwordx4 v[248:251], v1, s[12:15], s7 offen offset:0 nt
    s_xor_b32 s7, s49, 0x17000
    v_mfma_f32_16x16x32_bf16 v[12:15], v[24:27], v[228:231], v[12:15]
    v_and_b32_dpp v20, v66, v6 row_newbcast:14 row_mask:0xf bank_mask:0xf
    v_and_b32_dpp v21, v66, v7 row_newbcast:14 row_mask:0xf bank_mask:0xf
    v_and_b32_dpp v22, v66, v8 row_newbcast:14 row_mask:0xf bank_mask:0xf
    v_and_b32_dpp v23, v66, v9 row_newbcast:14 row_mask:0xf bank_mask:0xf
    s_waitcnt vmcnt(4)
    buffer_load_dwordx4 v[252:255], v1, s[12:15], s7 offen offset:0 nt
    s_xor_b32 s7, s49, 0x18000
    v_mfma_f32_16x16x32_bf16 v[12:15], v[16:19], v[232:235], v[12:15]
    v_and_b32_dpp v24, v66, v6 row_newbcast:9 row_mask:0xf bank_mask:0xf
    v_and_b32_dpp v25, v66, v7 row_newbcast:9 row_mask:0xf bank_mask:0xf
    v_and_b32_dpp v26, v66, v8 row_newbcast:9 row_mask:0xf bank_mask:0xf
    v_and_b32_dpp v27, v66, v9 row_newbcast:9 row_mask:0xf bank_mask:0xf
    s_waitcnt vmcnt(4)
    buffer_load_dwordx4 v[96:99], v1, s[12:15], s7 offen offset:0 nt
    s_xor_b32 s7, s49, 0x19000
    v_mfma_f32_16x16x32_bf16 v[12:15], v[20:23], v[236:239], v[12:15]
    v_and_b32_dpp v16, v66, v6 row_newbcast:13 row_mask:0xf bank_mask:0xf
    v_and_b32_dpp v17, v66, v7 row_newbcast:13 row_mask:0xf bank_mask:0xf
    v_and_b32_dpp v18, v66, v8 row_newbcast:13 row_mask:0xf bank_mask:0xf
    v_and_b32_dpp v19, v66, v9 row_newbcast:13 row_mask:0xf bank_mask:0xf
    s_waitcnt vmcnt(4)
    buffer_load_dwordx4 v[100:103], v1, s[12:15], s7 offen offset:0 nt
    s_xor_b32 s7, s49, 0x1a000
    v_mfma_f32_16x16x32_bf16 v[12:15], v[24:27], v[240:243], v[12:15]
    v_and_b32_dpp v20, v66, v6 row_newbcast:11 row_mask:0xf bank_mask:0xf
    v_and_b32_dpp v21, v66, v7 row_newbcast:11 row_mask:0xf bank_mask:0xf
    v_and_b32_dpp v22, v66, v8 row_newbcast:11 row_mask:0xf bank_mask:0xf
    v_and_b32_dpp v23, v66, v9 row_newbcast:11 row_mask:0xf bank_mask:0xf
    s_waitcnt vmcnt(4)
    buffer_load_dwordx4 v[104:107], v1, s[12:15], s7 offen offset:0 nt
    s_xor_b32 s7, s49, 0x1b000
    v_mfma_f32_16x16x32_bf16 v[12:15], v[16:19], v[244:247], v[12:15]
    v_and_b32_dpp v24, v66, v6 row_newbcast:15 row_mask:0xf bank_mask:0xf
    v_and_b32_dpp v25, v66, v7 row_newbcast:15 row_mask:0xf bank_mask:0xf
    v_and_b32_dpp v26, v66, v8 row_newbcast:15 row_mask:0xf bank_mask:0xf
    v_and_b32_dpp v27, v66, v9 row_newbcast:15 row_mask:0xf bank_mask:0xf
    s_waitcnt vmcnt(4)
    buffer_load_dwordx4 v[108:111], v1, s[12:15], s7 offen offset:0 nt
    s_xor_b32 s7, s49, 0x1c000
    v_mfma_f32_16x16x32_bf16 v[12:15], v[20:23], v[248:251], v[12:15]
    v_and_b32_dpp v16, v67, v6 row_newbcast:8 row_mask:0xf bank_mask:0xf
    v_and_b32_dpp v17, v67, v7 row_newbcast:8 row_mask:0xf bank_mask:0xf
    v_and_b32_dpp v18, v67, v8 row_newbcast:8 row_mask:0xf bank_mask:0xf
    v_and_b32_dpp v19, v67, v9 row_newbcast:8 row_mask:0xf bank_mask:0xf
    s_waitcnt vmcnt(4)
    buffer_load_dwordx4 v[112:115], v1, s[12:15], s7 offen offset:0 nt
    s_xor_b32 s7, s49, 0x1d000
    v_mfma_f32_16x16x32_bf16 v[12:15], v[24:27], v[252:255], v[12:15]
    v_and_b32_dpp v20, v67, v6 row_newbcast:12 row_mask:0xf bank_mask:0xf
    v_and_b32_dpp v21, v67, v7 row_newbcast:12 row_mask:0xf bank_mask:0xf
    v_and_b32_dpp v22, v67, v8 row_newbcast:12 row_mask:0xf bank_mask:0xf
    v_and_b32_dpp v23, v67, v9 row_newbcast:12 row_mask:0xf bank_mask:0xf
    s_waitcnt vmcnt(4)
    buffer_load_dwordx4 v[116:119], v1, s[12:15], s7 offen offset:0 nt
    s_xor_b32 s7, s49, 0x1e000
    v_mfma_f32_16x16x32_bf16 v[12:15], v[16:19], v[96:99], v[12:15]
    v_and_b32_dpp v24, v67, v6 row_newbcast:10 row_mask:0xf bank_mask:0xf
    v_and_b32_dpp v25, v67, v7 row_newbcast:10 row_mask:0xf bank_mask:0xf
    v_and_b32_dpp v26, v67, v8 row_newbcast:10 row_mask:0xf bank_mask:0xf
    v_and_b32_dpp v27, v67, v9 row_newbcast:10 row_mask:0xf bank_mask:0xf
    s_waitcnt vmcnt(4)
    buffer_load_dwordx4 v[120:123], v1, s[12:15], s7 offen offset:0 nt
    s_xor_b32 s7, s49, 0x1f000
    v_mfma_f32_16x16x32_bf16 v[12:15], v[20:23], v[100:103], v[12:15]
    v_and_b32_dpp v16, v67, v6 row_newbcast:14 row_mask:0xf bank_mask:0xf
    v_and_b32_dpp v17, v67, v7 row_newbcast:14 row_mask:0xf bank_mask:0xf
    v_and_b32_dpp v18, v67, v8 row_newbcast:14 row_mask:0xf bank_mask:0xf
    v_and_b32_dpp v19, v67, v9 row_newbcast:14 row_mask:0xf bank_mask:0xf
    s_waitcnt vmcnt(4)
    buffer_load_dwordx4 v[124:127], v1, s[12:15], s7 offen offset:0 nt
    s_xor_b32 s7, s49, 0x20000
    v_mfma_f32_16x16x32_bf16 v[12:15], v[24:27], v[104:107], v[12:15]
    v_and_b32_dpp v20, v67, v6 row_newbcast:9 row_mask:0xf bank_mask:0xf
    v_and_b32_dpp v21, v67, v7 row_newbcast:9 row_mask:0xf bank_mask:0xf
    v_and_b32_dpp v22, v67, v8 row_newbcast:9 row_mask:0xf bank_mask:0xf
    v_and_b32_dpp v23, v67, v9 row_newbcast:9 row_mask:0xf bank_mask:0xf
    s_waitcnt vmcnt(4)
    buffer_load_dwordx4 v[128:131], v1, s[12:15], s7 offen offset:0 nt
    s_xor_b32 s7, s49, 0x21000
    v_mfma_f32_16x16x32_bf16 v[12:15], v[16:19], v[108:111], v[12:15]
    v_and_b32_dpp v24, v67, v6 row_newbcast:13 row_mask:0xf bank_mask:0xf
    v_and_b32_dpp v25, v67, v7 row_newbcast:13 row_mask:0xf bank_mask:0xf
    v_and_b32_dpp v26, v67, v8 row_newbcast:13 row_mask:0xf bank_mask:0xf
    v_and_b32_dpp v27, v67, v9 row_newbcast:13 row_mask:0xf bank_mask:0xf
    s_waitcnt vmcnt(4)
    buffer_load_dwordx4 v[132:135], v1, s[12:15], s7 offen offset:0 nt
    s_xor_b32 s7, s49, 0x22000
    v_mfma_f32_16x16x32_bf16 v[12:15], v[20:23], v[112:115], v[12:15]
    v_and_b32_dpp v16, v67, v6 row_newbcast:11 row_mask:0xf bank_mask:0xf
    v_and_b32_dpp v17, v67, v7 row_newbcast:11 row_mask:0xf bank_mask:0xf
    v_and_b32_dpp v18, v67, v8 row_newbcast:11 row_mask:0xf bank_mask:0xf
    v_and_b32_dpp v19, v67, v9 row_newbcast:11 row_mask:0xf bank_mask:0xf
    s_waitcnt vmcnt(4)
    buffer_load_dwordx4 v[136:139], v1, s[12:15], s7 offen offset:0 nt
    s_xor_b32 s7, s49, 0x23000
    v_mfma_f32_16x16x32_bf16 v[12:15], v[24:27], v[116:119], v[12:15]
    v_and_b32_dpp v20, v67, v6 row_newbcast:15 row_mask:0xf bank_mask:0xf
    v_and_b32_dpp v21, v67, v7 row_newbcast:15 row_mask:0xf bank_mask:0xf
    v_and_b32_dpp v22, v67, v8 row_newbcast:15 row_mask:0xf bank_mask:0xf
    v_and_b32_dpp v23, v67, v9 row_newbcast:15 row_mask:0xf bank_mask:0xf
    s_waitcnt vmcnt(4)
    buffer_load_dwordx4 v[140:143], v1, s[12:15], s7 offen offset:0 nt
    s_xor_b32 s7, s49, 0x24000
    v_mfma_f32_16x16x32_bf16 v[12:15], v[16:19], v[120:123], v[12:15]
    v_and_b32_dpp v24, v68, v6 row_newbcast:8 row_mask:0xf bank_mask:0xf
    v_and_b32_dpp v25, v68, v7 row_newbcast:8 row_mask:0xf bank_mask:0xf
    v_and_b32_dpp v26, v68, v8 row_newbcast:8 row_mask:0xf bank_mask:0xf
    v_and_b32_dpp v27, v68, v9 row_newbcast:8 row_mask:0xf bank_mask:0xf
    s_waitcnt vmcnt(4)
    buffer_load_dwordx4 v[144:147], v1, s[12:15], s7 offen offset:0 nt
    s_xor_b32 s7, s49, 0x25000
    v_mfma_f32_16x16x32_bf16 v[12:15], v[20:23], v[124:127], v[12:15]
    v_and_b32_dpp v16, v68, v6 row_newbcast:12 row_mask:0xf bank_mask:0xf
    v_and_b32_dpp v17, v68, v7 row_newbcast:12 row_mask:0xf bank_mask:0xf
    v_and_b32_dpp v18, v68, v8 row_newbcast:12 row_mask:0xf bank_mask:0xf
    v_and_b32_dpp v19, v68, v9 row_newbcast:12 row_mask:0xf bank_mask:0xf
    s_waitcnt vmcnt(4)
    buffer_load_dwordx4 v[148:151], v1, s[12:15], s7 offen offset:0 nt
    s_xor_b32 s7, s49, 0x26000
    v_mfma_f32_16x16x32_bf16 v[12:15], v[24:27], v[128:131], v[12:15]
    v_and_b32_dpp v20, v68, v6 row_newbcast:10 row_mask:0xf bank_mask:0xf
    v_and_b32_dpp v21, v68, v7 row_newbcast:10 row_mask:0xf bank_mask:0xf
    v_and_b32_dpp v22, v68, v8 row_newbcast:10 row_mask:0xf bank_mask:0xf
    v_and_b32_dpp v23, v68, v9 row_newbcast:10 row_mask:0xf bank_mask:0xf
    s_waitcnt vmcnt(4)
    buffer_load_dwordx4 v[152:155], v1, s[12:15], s7 offen offset:0 nt
    s_xor_b32 s7, s49, 0x27000
    v_mfma_f32_16x16x32_bf16 v[12:15], v[16:19], v[132:135], v[12:15]
    v_and_b32_dpp v24, v68, v6 row_newbcast:14 row_mask:0xf bank_mask:0xf
    v_and_b32_dpp v25, v68, v7 row_newbcast:14 row_mask:0xf bank_mask:0xf
    v_and_b32_dpp v26, v68, v8 row_newbcast:14 row_mask:0xf bank_mask:0xf
    v_and_b32_dpp v27, v68, v9 row_newbcast:14 row_mask:0xf bank_mask:0xf
    s_waitcnt vmcnt(4)
    buffer_load_dwordx4 v[156:159], v1, s[12:15], s7 offen offset:0 nt
    s_xor_b32 s7, s49, 0x28000
    v_mfma_f32_16x16x32_bf16 v[12:15], v[20:23], v[136:139], v[12:15]
    v_and_b32_dpp v16, v64, v6 row_newbcast:0 row_mask:0xf bank_mask:0xf
    v_and_b32_dpp v17, v64, v7 row_newbcast:0 row_mask:0xf bank_mask:0xf
    v_and_b32_dpp v18, v64, v8 row_newbcast:0 row_mask:0xf bank_mask:0xf
    v_and_b32_dpp v19, v64, v9 row_newbcast:0 row_mask:0xf bank_mask:0xf
    s_waitcnt vmcnt(4)
    buffer_load_dwordx4 v[160:163], v1, s[12:15], s7 offen offset:0 nt
    s_xor_b32 s7, s49, 0x29000
    v_mfma_f32_16x16x32_bf16 v[12:15], v[24:27], v[140:143], v[12:15]
    v_and_b32_dpp v20, v64, v6 row_newbcast:4 row_mask:0xf bank_mask:0xf
    v_and_b32_dpp v21, v64, v7 row_newbcast:4 row_mask:0xf bank_mask:0xf
    v_and_b32_dpp v22, v64, v8 row_newbcast:4 row_mask:0xf bank_mask:0xf
    v_and_b32_dpp v23, v64, v9 row_newbcast:4 row_mask:0xf bank_mask:0xf
    s_waitcnt vmcnt(4)
    buffer_load_dwordx4 v[164:167], v1, s[12:15], s7 offen offset:0 nt
    s_xor_b32 s7, s49, 0x2a000
    v_mfma_f32_16x16x32_bf16 v[12:15], v[16:19], v[144:147], v[12:15]
    v_and_b32_dpp v24, v64, v6 row_newbcast:2 row_mask:0xf bank_mask:0xf
    v_and_b32_dpp v25, v64, v7 row_newbcast:2 row_mask:0xf bank_mask:0xf
    v_and_b32_dpp v26, v64, v8 row_newbcast:2 row_mask:0xf bank_mask:0xf
    v_and_b32_dpp v27, v64, v9 row_newbcast:2 row_mask:0xf bank_mask:0xf
    s_waitcnt vmcnt(4)
    buffer_load_dwordx4 v[168:171], v1, s[12:15], s7 offen offset:0 nt
    s_xor_b32 s7, s49, 0x2b000
    v_mfma_f32_16x16x32_bf16 v[12:15], v[20:23], v[148:151], v[12:15]
    v_and_b32_dpp v16, v64, v6 row_newbcast:6 row_mask:0xf bank_mask:0xf
    v_and_b32_dpp v17, v64, v7 row_newbcast:6 row_mask:0xf bank_mask:0xf
    v_and_b32_dpp v18, v64, v8 row_newbcast:6 row_mask:0xf bank_mask:0xf
    v_and_b32_dpp v19, v64, v9 row_newbcast:6 row_mask:0xf bank_mask:0xf
    s_waitcnt vmcnt(4)
    buffer_load_dwordx4 v[172:175], v1, s[12:15], s7 offen offset:0 nt
    s_xor_b32 s7, s49, 0x2c000
    v_mfma_f32_16x16x32_bf16 v[12:15], v[24:27], v[152:155], v[12:15]
    v_and_b32_dpp v20, v64, v6 row_newbcast:1 row_mask:0xf bank_mask:0xf
    v_and_b32_dpp v21, v64, v7 row_newbcast:1 row_mask:0xf bank_mask:0xf
    v_and_b32_dpp v22, v64, v8 row_newbcast:1 row_mask:0xf bank_mask:0xf
    v_and_b32_dpp v23, v64, v9 row_newbcast:1 row_mask:0xf bank_mask:0xf
    s_waitcnt vmcnt(4)
    buffer_load_dwordx4 v[176:179], v1, s[12:15], s7 offen offset:0 nt
    s_xor_b32 s7, s49, 0x2d000
    v_mfma_f32_16x16x32_bf16 v[12:15], v[16:19], v[156:159], v[12:15]
    v_and_b32_dpp v24, v64, v6 row_newbcast:5 row_mask:0xf bank_mask:0xf
    v_and_b32_dpp v25, v64, v7 row_newbcast:5 row_mask:0xf bank_mask:0xf
    v_and_b32_dpp v26, v64, v8 row_newbcast:5 row_mask:0xf bank_mask:0xf
    v_and_b32_dpp v27, v64, v9 row_newbcast:5 row_mask:0xf bank_mask:0xf
    s_waitcnt vmcnt(4)
    buffer_load_dwordx4 v[180:183], v1, s[12:15], s7 offen offset:0 nt
    s_xor_b32 s7, s49, 0x2e000
    v_mfma_f32_16x16x32_bf16 v[12:15], v[20:23], v[160:163], v[12:15]
    v_and_b32_dpp v16, v64, v6 row_newbcast:3 row_mask:0xf bank_mask:0xf
    v_and_b32_dpp v17, v64, v7 row_newbcast:3 row_mask:0xf bank_mask:0xf
    v_and_b32_dpp v18, v64, v8 row_newbcast:3 row_mask:0xf bank_mask:0xf
    v_and_b32_dpp v19, v64, v9 row_newbcast:3 row_mask:0xf bank_mask:0xf
    s_waitcnt vmcnt(4)
    buffer_load_dwordx4 v[184:187], v1, s[12:15], s7 offen offset:0 nt
    s_xor_b32 s7, s49, 0x2f000
    v_mfma_f32_16x16x32_bf16 v[12:15], v[24:27], v[164:167], v[12:15]
    v_and_b32_dpp v20, v64, v6 row_newbcast:7 row_mask:0xf bank_mask:0xf
    v_and_b32_dpp v21, v64, v7 row_newbcast:7 row_mask:0xf bank_mask:0xf
    v_and_b32_dpp v22, v64, v8 row_newbcast:7 row_mask:0xf bank_mask:0xf
    v_and_b32_dpp v23, v64, v9 row_newbcast:7 row_mask:0xf bank_mask:0xf
    s_waitcnt vmcnt(4)
    buffer_load_dwordx4 v[188:191], v1, s[12:15], s7 offen offset:0 nt
    s_xor_b32 s7, s49, 0x30000
    v_mfma_f32_16x16x32_bf16 v[12:15], v[16:19], v[168:171], v[12:15]
    v_and_b32_dpp v24, v65, v6 row_newbcast:0 row_mask:0xf bank_mask:0xf
    v_and_b32_dpp v25, v65, v7 row_newbcast:0 row_mask:0xf bank_mask:0xf
    v_and_b32_dpp v26, v65, v8 row_newbcast:0 row_mask:0xf bank_mask:0xf
    v_and_b32_dpp v27, v65, v9 row_newbcast:0 row_mask:0xf bank_mask:0xf
    s_waitcnt vmcnt(4)
    buffer_load_dwordx4 v[192:195], v1, s[12:15], s7 offen offset:0 nt
    s_xor_b32 s7, s49, 0x31000
    v_mfma_f32_16x16x32_bf16 v[12:15], v[20:23], v[172:175], v[12:15]
    v_and_b32_dpp v16, v65, v6 row_newbcast:4 row_mask:0xf bank_mask:0xf
    v_and_b32_dpp v17, v65, v7 row_newbcast:4 row_mask:0xf bank_mask:0xf
    v_and_b32_dpp v18, v65, v8 row_newbcast:4 row_mask:0xf bank_mask:0xf
    v_and_b32_dpp v19, v65, v9 row_newbcast:4 row_mask:0xf bank_mask:0xf
    s_waitcnt vmcnt(4)
    buffer_load_dwordx4 v[196:199], v1, s[12:15], s7 offen offset:0 nt
    s_xor_b32 s7, s49, 0x32000
    v_mfma_f32_16x16x32_bf16 v[12:15], v[24:27], v[176:179], v[12:15]
    v_and_b32_dpp v20, v65, v6 row_newbcast:2 row_mask:0xf bank_mask:0xf
    v_and_b32_dpp v21, v65, v7 row_newbcast:2 row_mask:0xf bank_mask:0xf
    v_and_b32_dpp v22, v65, v8 row_newbcast:2 row_mask:0xf bank_mask:0xf
    v_and_b32_dpp v23, v65, v9 row_newbcast:2 row_mask:0xf bank_mask:0xf
    s_waitcnt vmcnt(4)
    buffer_load_dwordx4 v[200:203], v1, s[12:15], s7 offen offset:0 nt
    s_xor_b32 s7, s49, 0x33000
    v_mfma_f32_16x16x32_bf16 v[12:15], v[16:19], v[180:183], v[12:15]
    v_and_b32_dpp v24, v65, v6 row_newbcast:6 row_mask:0xf bank_mask:0xf
    v_and_b32_dpp v25, v65, v7 row_newbcast:6 row_mask:0xf bank_mask:0xf
    v_and_b32_dpp v26, v65, v8 row_newbcast:6 row_mask:0xf bank_mask:0xf
    v_and_b32_dpp v27, v65, v9 row_newbcast:6 row_mask:0xf bank_mask:0xf
    s_waitcnt vmcnt(4)
    buffer_load_dwordx4 v[204:207], v1, s[12:15], s7 offen offset:0 nt
    s_xor_b32 s7, s49, 0x34000
    v_mfma_f32_16x16x32_bf16 v[12:15], v[20:23], v[184:187], v[12:15]
    v_and_b32_dpp v16, v65, v6 row_newbcast:1 row_mask:0xf bank_mask:0xf
    v_and_b32_dpp v17, v65, v7 row_newbcast:1 row_mask:0xf bank_mask:0xf
    v_and_b32_dpp v18, v65, v8 row_newbcast:1 row_mask:0xf bank_mask:0xf
    v_and_b32_dpp v19, v65, v9 row_newbcast:1 row_mask:0xf bank_mask:0xf
    s_waitcnt vmcnt(4)
    buffer_load_dwordx4 v[208:211], v1, s[12:15], s7 offen offset:0 nt
    s_xor_b32 s7, s49, 0x35000
    v_mfma_f32_16x16x32_bf16 v[12:15], v[24:27], v[188:191], v[12:15]
    v_and_b32_dpp v20, v65, v6 row_newbcast:5 row_mask:0xf bank_mask:0xf
    v_and_b32_dpp v21, v65, v7 row_newbcast:5 row_mask:0xf bank_mask:0xf
    v_and_b32_dpp v22, v65, v8 row_newbcast:5 row_mask:0xf bank_mask:0xf
    v_and_b32_dpp v23, v65, v9 row_newbcast:5 row_mask:0xf bank_mask:0xf
    s_waitcnt vmcnt(4)
    buffer_load_dwordx4 v[212:215], v1, s[12:15], s7 offen offset:0 nt
    s_xor_b32 s7, s49, 0x36000
    v_mfma_f32_16x16x32_bf16 v[12:15], v[16:19], v[192:195], v[12:15]
    v_and_b32_dpp v24, v65, v6 row_newbcast:3 row_mask:0xf bank_mask:0xf
    v_and_b32_dpp v25, v65, v7 row_newbcast:3 row_mask:0xf bank_mask:0xf
    v_and_b32_dpp v26, v65, v8 row_newbcast:3 row_mask:0xf bank_mask:0xf
    v_and_b32_dpp v27, v65, v9 row_newbcast:3 row_mask:0xf bank_mask:0xf
    s_waitcnt vmcnt(4)
    buffer_load_dwordx4 v[216:219], v1, s[12:15], s7 offen offset:0 nt
    s_xor_b32 s7, s49, 0x37000
    v_mfma_f32_16x16x32_bf16 v[12:15], v[20:23], v[196:199], v[12:15]
    v_and_b32_dpp v16, v65, v6 row_newbcast:7 row_mask:0xf bank_mask:0xf
    v_and_b32_dpp v17, v65, v7 row_newbcast:7 row_mask:0xf bank_mask:0xf
    v_and_b32_dpp v18, v65, v8 row_newbcast:7 row_mask:0xf bank_mask:0xf
    v_and_b32_dpp v19, v65, v9 row_newbcast:7 row_mask:0xf bank_mask:0xf
    s_waitcnt vmcnt(4)
    buffer_load_dwordx4 v[220:223], v1, s[12:15], s7 offen offset:0 nt
    s_xor_b32 s7, s49, 0x38000
    v_mfma_f32_16x16x32_bf16 v[12:15], v[24:27], v[200:203], v[12:15]
    v_and_b32_dpp v20, v66, v6 row_newbcast:0 row_mask:0xf bank_mask:0xf
    v_and_b32_dpp v21, v66, v7 row_newbcast:0 row_mask:0xf bank_mask:0xf
    v_and_b32_dpp v22, v66, v8 row_newbcast:0 row_mask:0xf bank_mask:0xf
    v_and_b32_dpp v23, v66, v9 row_newbcast:0 row_mask:0xf bank_mask:0xf
    s_waitcnt vmcnt(4)
    buffer_load_dwordx4 v[224:227], v1, s[12:15], s7 offen offset:0 nt
    s_xor_b32 s7, s49, 0x39000
    v_mfma_f32_16x16x32_bf16 v[12:15], v[16:19], v[204:207], v[12:15]
    v_and_b32_dpp v24, v66, v6 row_newbcast:4 row_mask:0xf bank_mask:0xf
    v_and_b32_dpp v25, v66, v7 row_newbcast:4 row_mask:0xf bank_mask:0xf
    v_and_b32_dpp v26, v66, v8 row_newbcast:4 row_mask:0xf bank_mask:0xf
    v_and_b32_dpp v27, v66, v9 row_newbcast:4 row_mask:0xf bank_mask:0xf
    s_waitcnt vmcnt(4)
    buffer_load_dwordx4 v[228:231], v1, s[12:15], s7 offen offset:0 nt
    s_xor_b32 s7, s49, 0x3a000
    v_mfma_f32_16x16x32_bf16 v[12:15], v[20:23], v[208:211], v[12:15]
    v_and_b32_dpp v16, v66, v6 row_newbcast:2 row_mask:0xf bank_mask:0xf
    v_and_b32_dpp v17, v66, v7 row_newbcast:2 row_mask:0xf bank_mask:0xf
    v_and_b32_dpp v18, v66, v8 row_newbcast:2 row_mask:0xf bank_mask:0xf
    v_and_b32_dpp v19, v66, v9 row_newbcast:2 row_mask:0xf bank_mask:0xf
    s_waitcnt vmcnt(4)
    buffer_load_dwordx4 v[232:235], v1, s[12:15], s7 offen offset:0 nt
    s_xor_b32 s7, s49, 0x3b000
    v_mfma_f32_16x16x32_bf16 v[12:15], v[24:27], v[212:215], v[12:15]
    v_and_b32_dpp v20, v66, v6 row_newbcast:6 row_mask:0xf bank_mask:0xf
    v_and_b32_dpp v21, v66, v7 row_newbcast:6 row_mask:0xf bank_mask:0xf
    v_and_b32_dpp v22, v66, v8 row_newbcast:6 row_mask:0xf bank_mask:0xf
    v_and_b32_dpp v23, v66, v9 row_newbcast:6 row_mask:0xf bank_mask:0xf
    s_waitcnt vmcnt(4)
    buffer_load_dwordx4 v[236:239], v1, s[12:15], s7 offen offset:0 nt
    s_xor_b32 s7, s49, 0x3c000
    v_mfma_f32_16x16x32_bf16 v[12:15], v[16:19], v[216:219], v[12:15]
    v_and_b32_dpp v24, v66, v6 row_newbcast:1 row_mask:0xf bank_mask:0xf
    v_and_b32_dpp v25, v66, v7 row_newbcast:1 row_mask:0xf bank_mask:0xf
    v_and_b32_dpp v26, v66, v8 row_newbcast:1 row_mask:0xf bank_mask:0xf
    v_and_b32_dpp v27, v66, v9 row_newbcast:1 row_mask:0xf bank_mask:0xf
    s_waitcnt vmcnt(4)
    buffer_load_dwordx4 v[240:243], v1, s[12:15], s7 offen offset:0 nt
    s_xor_b32 s7, s49, 0x3d000
    v_mfma_f32_16x16x32_bf16 v[12:15], v[20:23], v[220:223], v[12:15]
    v_and_b32_dpp v16, v66, v6 row_newbcast:5 row_mask:0xf bank_mask:0xf
    v_and_b32_dpp v17, v66, v7 row_newbcast:5 row_mask:0xf bank_mask:0xf
    v_and_b32_dpp v18, v66, v8 row_newbcast:5 row_mask:0xf bank_mask:0xf
    v_and_b32_dpp v19, v66, v9 row_newbcast:5 row_mask:0xf bank_mask:0xf
    s_waitcnt vmcnt(4)
    buffer_load_dwordx4 v[244:247], v1, s[12:15], s7 offen offset:0 nt
    s_xor_b32 s7, s49, 0x3e000
    v_mfma_f32_16x16x32_bf16 v[12:15], v[24:27], v[224:227], v[12:15]
    v_and_b32_dpp v20, v66, v6 row_newbcast:3 row_mask:0xf bank_mask:0xf
    v_and_b32_dpp v21, v66, v7 row_newbcast:3 row_mask:0xf bank_mask:0xf
    v_and_b32_dpp v22, v66, v8 row_newbcast:3 row_mask:0xf bank_mask:0xf
    v_and_b32_dpp v23, v66, v9 row_newbcast:3 row_mask:0xf bank_mask:0xf
    s_waitcnt vmcnt(4)
    buffer_load_dwordx4 v[248:251], v1, s[12:15], s7 offen offset:0 nt
    s_xor_b32 s7, s49, 0x3f000
    v_mfma_f32_16x16x32_bf16 v[12:15], v[16:19], v[228:231], v[12:15]
    v_and_b32_dpp v24, v66, v6 row_newbcast:7 row_mask:0xf bank_mask:0xf
    v_and_b32_dpp v25, v66, v7 row_newbcast:7 row_mask:0xf bank_mask:0xf
    v_and_b32_dpp v26, v66, v8 row_newbcast:7 row_mask:0xf bank_mask:0xf
    v_and_b32_dpp v27, v66, v9 row_newbcast:7 row_mask:0xf bank_mask:0xf
    s_waitcnt vmcnt(4)
    buffer_load_dwordx4 v[252:255], v1, s[12:15], s7 offen offset:0 nt
    s_xor_b32 s7, s49, 0x40000
    v_mfma_f32_16x16x32_bf16 v[12:15], v[20:23], v[232:235], v[12:15]
    v_and_b32_dpp v16, v67, v6 row_newbcast:0 row_mask:0xf bank_mask:0xf
    v_and_b32_dpp v17, v67, v7 row_newbcast:0 row_mask:0xf bank_mask:0xf
    v_and_b32_dpp v18, v67, v8 row_newbcast:0 row_mask:0xf bank_mask:0xf
    v_and_b32_dpp v19, v67, v9 row_newbcast:0 row_mask:0xf bank_mask:0xf
    s_waitcnt vmcnt(4)
    buffer_load_dwordx4 v[96:99], v1, s[12:15], s7 offen offset:0 nt
    s_xor_b32 s7, s49, 0x41000
    v_mfma_f32_16x16x32_bf16 v[12:15], v[24:27], v[236:239], v[12:15]
    v_and_b32_dpp v20, v67, v6 row_newbcast:4 row_mask:0xf bank_mask:0xf
    v_and_b32_dpp v21, v67, v7 row_newbcast:4 row_mask:0xf bank_mask:0xf
    v_and_b32_dpp v22, v67, v8 row_newbcast:4 row_mask:0xf bank_mask:0xf
    v_and_b32_dpp v23, v67, v9 row_newbcast:4 row_mask:0xf bank_mask:0xf
    s_waitcnt vmcnt(4)
    buffer_load_dwordx4 v[100:103], v1, s[12:15], s7 offen offset:0 nt
    s_xor_b32 s7, s49, 0x42000
    v_mfma_f32_16x16x32_bf16 v[12:15], v[16:19], v[240:243], v[12:15]
    v_and_b32_dpp v24, v67, v6 row_newbcast:2 row_mask:0xf bank_mask:0xf
    v_and_b32_dpp v25, v67, v7 row_newbcast:2 row_mask:0xf bank_mask:0xf
    v_and_b32_dpp v26, v67, v8 row_newbcast:2 row_mask:0xf bank_mask:0xf
    v_and_b32_dpp v27, v67, v9 row_newbcast:2 row_mask:0xf bank_mask:0xf
    s_waitcnt vmcnt(4)
    buffer_load_dwordx4 v[104:107], v1, s[12:15], s7 offen offset:0 nt
    s_xor_b32 s7, s49, 0x43000
    v_mfma_f32_16x16x32_bf16 v[12:15], v[20:23], v[244:247], v[12:15]
    v_and_b32_dpp v16, v67, v6 row_newbcast:6 row_mask:0xf bank_mask:0xf
    v_and_b32_dpp v17, v67, v7 row_newbcast:6 row_mask:0xf bank_mask:0xf
    v_and_b32_dpp v18, v67, v8 row_newbcast:6 row_mask:0xf bank_mask:0xf
    v_and_b32_dpp v19, v67, v9 row_newbcast:6 row_mask:0xf bank_mask:0xf
    s_waitcnt vmcnt(4)
    buffer_load_dwordx4 v[108:111], v1, s[12:15], s7 offen offset:0 nt
    s_xor_b32 s7, s49, 0x44000
    v_mfma_f32_16x16x32_bf16 v[12:15], v[24:27], v[248:251], v[12:15]
    v_and_b32_dpp v20, v67, v6 row_newbcast:1 row_mask:0xf bank_mask:0xf
    v_and_b32_dpp v21, v67, v7 row_newbcast:1 row_mask:0xf bank_mask:0xf
    v_and_b32_dpp v22, v67, v8 row_newbcast:1 row_mask:0xf bank_mask:0xf
    v_and_b32_dpp v23, v67, v9 row_newbcast:1 row_mask:0xf bank_mask:0xf
    s_waitcnt vmcnt(4)
    buffer_load_dwordx4 v[112:115], v1, s[12:15], s7 offen offset:0 nt
    s_xor_b32 s7, s49, 0x45000
    v_mfma_f32_16x16x32_bf16 v[12:15], v[16:19], v[252:255], v[12:15]
    v_and_b32_dpp v24, v67, v6 row_newbcast:5 row_mask:0xf bank_mask:0xf
    v_and_b32_dpp v25, v67, v7 row_newbcast:5 row_mask:0xf bank_mask:0xf
    v_and_b32_dpp v26, v67, v8 row_newbcast:5 row_mask:0xf bank_mask:0xf
    v_and_b32_dpp v27, v67, v9 row_newbcast:5 row_mask:0xf bank_mask:0xf
    s_waitcnt vmcnt(4)
    buffer_load_dwordx4 v[116:119], v1, s[12:15], s7 offen offset:0 nt
    s_xor_b32 s7, s49, 0x46000
    v_mfma_f32_16x16x32_bf16 v[12:15], v[20:23], v[96:99], v[12:15]
    v_and_b32_dpp v16, v67, v6 row_newbcast:3 row_mask:0xf bank_mask:0xf
    v_and_b32_dpp v17, v67, v7 row_newbcast:3 row_mask:0xf bank_mask:0xf
    v_and_b32_dpp v18, v67, v8 row_newbcast:3 row_mask:0xf bank_mask:0xf
    v_and_b32_dpp v19, v67, v9 row_newbcast:3 row_mask:0xf bank_mask:0xf
    s_waitcnt vmcnt(4)
    buffer_load_dwordx4 v[120:123], v1, s[12:15], s7 offen offset:0 nt
    s_xor_b32 s7, s49, 0x47000
    v_mfma_f32_16x16x32_bf16 v[12:15], v[24:27], v[100:103], v[12:15]
    v_and_b32_dpp v20, v67, v6 row_newbcast:7 row_mask:0xf bank_mask:0xf
    v_and_b32_dpp v21, v67, v7 row_newbcast:7 row_mask:0xf bank_mask:0xf
    v_and_b32_dpp v22, v67, v8 row_newbcast:7 row_mask:0xf bank_mask:0xf
    v_and_b32_dpp v23, v67, v9 row_newbcast:7 row_mask:0xf bank_mask:0xf
    s_waitcnt vmcnt(4)
    buffer_load_dwordx4 v[124:127], v1, s[12:15], s7 offen offset:0 nt
    s_xor_b32 s7, s49, 0x48000
    v_mfma_f32_16x16x32_bf16 v[12:15], v[16:19], v[104:107], v[12:15]
    v_and_b32_dpp v24, v68, v6 row_newbcast:0 row_mask:0xf bank_mask:0xf
    v_and_b32_dpp v25, v68, v7 row_newbcast:0 row_mask:0xf bank_mask:0xf
    v_and_b32_dpp v26, v68, v8 row_newbcast:0 row_mask:0xf bank_mask:0xf
    v_and_b32_dpp v27, v68, v9 row_newbcast:0 row_mask:0xf bank_mask:0xf
    s_waitcnt vmcnt(4)
    buffer_load_dwordx4 v[128:131], v1, s[12:15], s7 offen offset:0 nt
    s_xor_b32 s7, s49, 0x49000
    v_mfma_f32_16x16x32_bf16 v[12:15], v[20:23], v[108:111], v[12:15]
    v_and_b32_dpp v16, v68, v6 row_newbcast:4 row_mask:0xf bank_mask:0xf
    v_and_b32_dpp v17, v68, v7 row_newbcast:4 row_mask:0xf bank_mask:0xf
    v_and_b32_dpp v18, v68, v8 row_newbcast:4 row_mask:0xf bank_mask:0xf
    v_and_b32_dpp v19, v68, v9 row_newbcast:4 row_mask:0xf bank_mask:0xf
    s_waitcnt vmcnt(4)
    buffer_load_dwordx4 v[132:135], v1, s[12:15], s7 offen offset:0 nt
    s_xor_b32 s7, s49, 0x4a000
    v_mfma_f32_16x16x32_bf16 v[12:15], v[24:27], v[112:115], v[12:15]
    v_and_b32_dpp v20, v68, v6 row_newbcast:2 row_mask:0xf bank_mask:0xf
    v_and_b32_dpp v21, v68, v7 row_newbcast:2 row_mask:0xf bank_mask:0xf
    v_and_b32_dpp v22, v68, v8 row_newbcast:2 row_mask:0xf bank_mask:0xf
    v_and_b32_dpp v23, v68, v9 row_newbcast:2 row_mask:0xf bank_mask:0xf
    s_waitcnt vmcnt(4)
    buffer_load_dwordx4 v[136:139], v1, s[12:15], s7 offen offset:0 nt
    s_xor_b32 s7, s49, 0x4b000
    v_mfma_f32_16x16x32_bf16 v[12:15], v[16:19], v[116:119], v[12:15]
    v_and_b32_dpp v24, v68, v6 row_newbcast:6 row_mask:0xf bank_mask:0xf
    v_and_b32_dpp v25, v68, v7 row_newbcast:6 row_mask:0xf bank_mask:0xf
    v_and_b32_dpp v26, v68, v8 row_newbcast:6 row_mask:0xf bank_mask:0xf
    v_and_b32_dpp v27, v68, v9 row_newbcast:6 row_mask:0xf bank_mask:0xf
    s_waitcnt vmcnt(4)
    buffer_load_dwordx4 v[140:143], v1, s[12:15], s7 offen offset:0 nt
    s_xor_b32 s7, s49, 0x4c000
    v_mfma_f32_16x16x32_bf16 v[12:15], v[20:23], v[120:123], v[12:15]
    v_and_b32_dpp v16, v68, v6 row_newbcast:1 row_mask:0xf bank_mask:0xf
    v_and_b32_dpp v17, v68, v7 row_newbcast:1 row_mask:0xf bank_mask:0xf
    v_and_b32_dpp v18, v68, v8 row_newbcast:1 row_mask:0xf bank_mask:0xf
    v_and_b32_dpp v19, v68, v9 row_newbcast:1 row_mask:0xf bank_mask:0xf
    s_waitcnt vmcnt(4)
    buffer_load_dwordx4 v[144:147], v1, s[12:15], s7 offen offset:0 nt
    s_xor_b32 s7, s49, 0x4d000
    v_mfma_f32_16x16x32_bf16 v[12:15], v[24:27], v[124:127], v[12:15]
    v_and_b32_dpp v20, v68, v6 row_newbcast:9 row_mask:0xf bank_mask:0xf
    v_and_b32_dpp v21, v68, v7 row_newbcast:9 row_mask:0xf bank_mask:0xf
    v_and_b32_dpp v22, v68, v8 row_newbcast:9 row_mask:0xf bank_mask:0xf
    v_and_b32_dpp v23, v68, v9 row_newbcast:9 row_mask:0xf bank_mask:0xf
    s_waitcnt vmcnt(4)
    buffer_load_dwordx4 v[148:151], v1, s[12:15], s7 offen offset:0 nt
    s_xor_b32 s7, s49, 0x4e000
    v_mfma_f32_16x16x32_bf16 v[12:15], v[16:19], v[128:131], v[12:15]
    v_and_b32_dpp v24, v68, v6 row_newbcast:5 row_mask:0xf bank_mask:0xf
    v_and_b32_dpp v25, v68, v7 row_newbcast:5 row_mask:0xf bank_mask:0xf
    v_and_b32_dpp v26, v68, v8 row_newbcast:5 row_mask:0xf bank_mask:0xf
    v_and_b32_dpp v27, v68, v9 row_newbcast:5 row_mask:0xf bank_mask:0xf
    s_waitcnt vmcnt(4)
    buffer_load_dwordx4 v[152:155], v1, s[12:15], s7 offen offset:0 nt
    s_xor_b32 s7, s49, 0x4f000
    v_mfma_f32_16x16x32_bf16 v[12:15], v[20:23], v[132:135], v[12:15]
    v_and_b32_dpp v16, v68, v6 row_newbcast:13 row_mask:0xf bank_mask:0xf
    v_and_b32_dpp v17, v68, v7 row_newbcast:13 row_mask:0xf bank_mask:0xf
    v_and_b32_dpp v18, v68, v8 row_newbcast:13 row_mask:0xf bank_mask:0xf
    v_and_b32_dpp v19, v68, v9 row_newbcast:13 row_mask:0xf bank_mask:0xf
    s_waitcnt vmcnt(4)
    buffer_load_dwordx4 v[156:159], v1, s[12:15], s7 offen offset:0 nt
    s_xor_b32 s7, s49, 0x50000
    v_mfma_f32_16x16x32_bf16 v[12:15], v[24:27], v[136:139], v[12:15]
    v_and_b32_dpp v20, v68, v6 row_newbcast:3 row_mask:0xf bank_mask:0xf
    v_and_b32_dpp v21, v68, v7 row_newbcast:3 row_mask:0xf bank_mask:0xf
    v_and_b32_dpp v22, v68, v8 row_newbcast:3 row_mask:0xf bank_mask:0xf
    v_and_b32_dpp v23, v68, v9 row_newbcast:3 row_mask:0xf bank_mask:0xf
    s_waitcnt vmcnt(4)
    buffer_load_dwordx4 v[160:163], v1, s[12:15], s7 offen offset:0 nt
    s_xor_b32 s7, s49, 0x51000
    v_mfma_f32_16x16x32_bf16 v[12:15], v[16:19], v[140:143], v[12:15]
    v_and_b32_dpp v24, v68, v6 row_newbcast:11 row_mask:0xf bank_mask:0xf
    v_and_b32_dpp v25, v68, v7 row_newbcast:11 row_mask:0xf bank_mask:0xf
    v_and_b32_dpp v26, v68, v8 row_newbcast:11 row_mask:0xf bank_mask:0xf
    v_and_b32_dpp v27, v68, v9 row_newbcast:11 row_mask:0xf bank_mask:0xf
    s_waitcnt vmcnt(4)
    buffer_load_dwordx4 v[164:167], v1, s[12:15], s7 offen offset:0 nt
    s_xor_b32 s7, s49, 0x52000
    v_mfma_f32_16x16x32_bf16 v[12:15], v[20:23], v[144:147], v[12:15]
    v_and_b32_dpp v16, v68, v6 row_newbcast:7 row_mask:0xf bank_mask:0xf
    v_and_b32_dpp v17, v68, v7 row_newbcast:7 row_mask:0xf bank_mask:0xf
    v_and_b32_dpp v18, v68, v8 row_newbcast:7 row_mask:0xf bank_mask:0xf
    v_and_b32_dpp v19, v68, v9 row_newbcast:7 row_mask:0xf bank_mask:0xf
    s_waitcnt vmcnt(4)
    buffer_load_dwordx4 v[168:171], v1, s[12:15], s7 offen offset:0 nt
    s_xor_b32 s7, s49, 0x53000
    v_mfma_f32_16x16x32_bf16 v[12:15], v[24:27], v[148:151], v[12:15]
    v_and_b32_dpp v20, v68, v6 row_newbcast:15 row_mask:0xf bank_mask:0xf
    v_and_b32_dpp v21, v68, v7 row_newbcast:15 row_mask:0xf bank_mask:0xf
    v_and_b32_dpp v22, v68, v8 row_newbcast:15 row_mask:0xf bank_mask:0xf
    v_and_b32_dpp v23, v68, v9 row_newbcast:15 row_mask:0xf bank_mask:0xf
    s_waitcnt vmcnt(4)
    buffer_load_dwordx4 v[172:175], v1, s[12:15], s7 offen offset:0 nt
    s_xor_b32 s7, s49, 0x54000
    v_mfma_f32_16x16x32_bf16 v[12:15], v[16:19], v[152:155], v[12:15]
    v_and_b32_dpp v24, v69, v6 row_newbcast:0 row_mask:0xf bank_mask:0xf
    v_and_b32_dpp v25, v69, v7 row_newbcast:0 row_mask:0xf bank_mask:0xf
    v_and_b32_dpp v26, v69, v8 row_newbcast:0 row_mask:0xf bank_mask:0xf
    v_and_b32_dpp v27, v69, v9 row_newbcast:0 row_mask:0xf bank_mask:0xf
    s_waitcnt vmcnt(4)
    buffer_load_dwordx4 v[176:179], v1, s[12:15], s7 offen offset:0 nt
    s_xor_b32 s7, s49, 0x55000
    v_mfma_f32_16x16x32_bf16 v[12:15], v[20:23], v[156:159], v[12:15]
    v_and_b32_dpp v16, v69, v6 row_newbcast:8 row_mask:0xf bank_mask:0xf
    v_and_b32_dpp v17, v69, v7 row_newbcast:8 row_mask:0xf bank_mask:0xf
    v_and_b32_dpp v18, v69, v8 row_newbcast:8 row_mask:0xf bank_mask:0xf
    v_and_b32_dpp v19, v69, v9 row_newbcast:8 row_mask:0xf bank_mask:0xf
    s_waitcnt vmcnt(4)
    buffer_load_dwordx4 v[180:183], v1, s[12:15], s7 offen offset:0 nt
    s_xor_b32 s7, s49, 0x56000
    v_mfma_f32_16x16x32_bf16 v[12:15], v[24:27], v[160:163], v[12:15]
    v_and_b32_dpp v20, v69, v6 row_newbcast:4 row_mask:0xf bank_mask:0xf
    v_and_b32_dpp v21, v69, v7 row_newbcast:4 row_mask:0xf bank_mask:0xf
    v_and_b32_dpp v22, v69, v8 row_newbcast:4 row_mask:0xf bank_mask:0xf
    v_and_b32_dpp v23, v69, v9 row_newbcast:4 row_mask:0xf bank_mask:0xf
    s_waitcnt vmcnt(4)
    buffer_load_dwordx4 v[184:187], v1, s[12:15], s7 offen offset:0 nt
    s_xor_b32 s7, s49, 0x57000
    v_mfma_f32_16x16x32_bf16 v[12:15], v[16:19], v[164:167], v[12:15]
    v_and_b32_dpp v24, v69, v6 row_newbcast:12 row_mask:0xf bank_mask:0xf
    v_and_b32_dpp v25, v69, v7 row_newbcast:12 row_mask:0xf bank_mask:0xf
    v_and_b32_dpp v26, v69, v8 row_newbcast:12 row_mask:0xf bank_mask:0xf
    v_and_b32_dpp v27, v69, v9 row_newbcast:12 row_mask:0xf bank_mask:0xf
    s_waitcnt vmcnt(4)
    buffer_load_dwordx4 v[188:191], v1, s[12:15], s7 offen offset:0 nt
    s_xor_b32 s7, s49, 0x58000
    v_mfma_f32_16x16x32_bf16 v[12:15], v[20:23], v[168:171], v[12:15]
    v_and_b32_dpp v16, v69, v6 row_newbcast:2 row_mask:0xf bank_mask:0xf
    v_and_b32_dpp v17, v69, v7 row_newbcast:2 row_mask:0xf bank_mask:0xf
    v_and_b32_dpp v18, v69, v8 row_newbcast:2 row_mask:0xf bank_mask:0xf
    v_and_b32_dpp v19, v69, v9 row_newbcast:2 row_mask:0xf bank_mask:0xf
    s_waitcnt vmcnt(4)
    buffer_load_dwordx4 v[192:195], v1, s[12:15], s7 offen offset:0 nt
    s_xor_b32 s7, s49, 0x59000
    v_mfma_f32_16x16x32_bf16 v[12:15], v[24:27], v[172:175], v[12:15]
    v_and_b32_dpp v20, v69, v6 row_newbcast:10 row_mask:0xf bank_mask:0xf
    v_and_b32_dpp v21, v69, v7 row_newbcast:10 row_mask:0xf bank_mask:0xf
    v_and_b32_dpp v22, v69, v8 row_newbcast:10 row_mask:0xf bank_mask:0xf
    v_and_b32_dpp v23, v69, v9 row_newbcast:10 row_mask:0xf bank_mask:0xf
    s_waitcnt vmcnt(4)
    buffer_load_dwordx4 v[196:199], v1, s[12:15], s7 offen offset:0 nt
    s_xor_b32 s7, s49, 0x5a000
    v_mfma_f32_16x16x32_bf16 v[12:15], v[16:19], v[176:179], v[12:15]
    v_and_b32_dpp v24, v69, v6 row_newbcast:6 row_mask:0xf bank_mask:0xf
    v_and_b32_dpp v25, v69, v7 row_newbcast:6 row_mask:0xf bank_mask:0xf
    v_and_b32_dpp v26, v69, v8 row_newbcast:6 row_mask:0xf bank_mask:0xf
    v_and_b32_dpp v27, v69, v9 row_newbcast:6 row_mask:0xf bank_mask:0xf
    s_waitcnt vmcnt(4)
    buffer_load_dwordx4 v[200:203], v1, s[12:15], s7 offen offset:0 nt
    s_xor_b32 s7, s49, 0x5b000
    v_mfma_f32_16x16x32_bf16 v[12:15], v[20:23], v[180:183], v[12:15]
    v_and_b32_dpp v16, v69, v6 row_newbcast:14 row_mask:0xf bank_mask:0xf
    v_and_b32_dpp v17, v69, v7 row_newbcast:14 row_mask:0xf bank_mask:0xf
    v_and_b32_dpp v18, v69, v8 row_newbcast:14 row_mask:0xf bank_mask:0xf
    v_and_b32_dpp v19, v69, v9 row_newbcast:14 row_mask:0xf bank_mask:0xf
    s_waitcnt vmcnt(4)
    buffer_load_dwordx4 v[204:207], v1, s[12:15], s7 offen offset:0 nt
    s_xor_b32 s7, s49, 0x5c000
    v_mfma_f32_16x16x32_bf16 v[12:15], v[24:27], v[184:187], v[12:15]
    v_and_b32_dpp v20, v69, v6 row_newbcast:1 row_mask:0xf bank_mask:0xf
    v_and_b32_dpp v21, v69, v7 row_newbcast:1 row_mask:0xf bank_mask:0xf
    v_and_b32_dpp v22, v69, v8 row_newbcast:1 row_mask:0xf bank_mask:0xf
    v_and_b32_dpp v23, v69, v9 row_newbcast:1 row_mask:0xf bank_mask:0xf
    s_waitcnt vmcnt(4)
    buffer_load_dwordx4 v[208:211], v1, s[12:15], s7 offen offset:0 nt
    s_xor_b32 s7, s49, 0x5d000
    v_mfma_f32_16x16x32_bf16 v[12:15], v[16:19], v[188:191], v[12:15]
    v_and_b32_dpp v24, v69, v6 row_newbcast:9 row_mask:0xf bank_mask:0xf
    v_and_b32_dpp v25, v69, v7 row_newbcast:9 row_mask:0xf bank_mask:0xf
    v_and_b32_dpp v26, v69, v8 row_newbcast:9 row_mask:0xf bank_mask:0xf
    v_and_b32_dpp v27, v69, v9 row_newbcast:9 row_mask:0xf bank_mask:0xf
    s_waitcnt vmcnt(4)
    buffer_load_dwordx4 v[212:215], v1, s[12:15], s7 offen offset:0 nt
    s_xor_b32 s7, s49, 0x5e000
    v_mfma_f32_16x16x32_bf16 v[12:15], v[20:23], v[192:195], v[12:15]
    v_and_b32_dpp v16, v69, v6 row_newbcast:5 row_mask:0xf bank_mask:0xf
    v_and_b32_dpp v17, v69, v7 row_newbcast:5 row_mask:0xf bank_mask:0xf
    v_and_b32_dpp v18, v69, v8 row_newbcast:5 row_mask:0xf bank_mask:0xf
    v_and_b32_dpp v19, v69, v9 row_newbcast:5 row_mask:0xf bank_mask:0xf
    s_waitcnt vmcnt(4)
    buffer_load_dwordx4 v[216:219], v1, s[12:15], s7 offen offset:0 nt
    s_xor_b32 s7, s49, 0x5f000
    v_mfma_f32_16x16x32_bf16 v[12:15], v[24:27], v[196:199], v[12:15]
    v_and_b32_dpp v20, v69, v6 row_newbcast:13 row_mask:0xf bank_mask:0xf
    v_and_b32_dpp v21, v69, v7 row_newbcast:13 row_mask:0xf bank_mask:0xf
    v_and_b32_dpp v22, v69, v8 row_newbcast:13 row_mask:0xf bank_mask:0xf
    v_and_b32_dpp v23, v69, v9 row_newbcast:13 row_mask:0xf bank_mask:0xf
    s_waitcnt vmcnt(4)
    buffer_load_dwordx4 v[220:223], v1, s[12:15], s7 offen offset:0 nt
    s_xor_b32 s7, s49, 0x60000
    v_mfma_f32_16x16x32_bf16 v[12:15], v[16:19], v[200:203], v[12:15]
    v_and_b32_dpp v24, v69, v6 row_newbcast:3 row_mask:0xf bank_mask:0xf
    v_and_b32_dpp v25, v69, v7 row_newbcast:3 row_mask:0xf bank_mask:0xf
    v_and_b32_dpp v26, v69, v8 row_newbcast:3 row_mask:0xf bank_mask:0xf
    v_and_b32_dpp v27, v69, v9 row_newbcast:3 row_mask:0xf bank_mask:0xf
    s_waitcnt vmcnt(4)
    buffer_load_dwordx4 v[224:227], v1, s[12:15], s7 offen offset:0 nt
    s_xor_b32 s7, s49, 0x61000
    v_mfma_f32_16x16x32_bf16 v[12:15], v[20:23], v[204:207], v[12:15]
    v_and_b32_dpp v16, v69, v6 row_newbcast:11 row_mask:0xf bank_mask:0xf
    v_and_b32_dpp v17, v69, v7 row_newbcast:11 row_mask:0xf bank_mask:0xf
    v_and_b32_dpp v18, v69, v8 row_newbcast:11 row_mask:0xf bank_mask:0xf
    v_and_b32_dpp v19, v69, v9 row_newbcast:11 row_mask:0xf bank_mask:0xf
    s_waitcnt vmcnt(4)
    buffer_load_dwordx4 v[228:231], v1, s[12:15], s7 offen offset:0 nt
    s_xor_b32 s7, s49, 0x62000
    v_mfma_f32_16x16x32_bf16 v[12:15], v[24:27], v[208:211], v[12:15]
    v_and_b32_dpp v20, v69, v6 row_newbcast:7 row_mask:0xf bank_mask:0xf
    v_and_b32_dpp v21, v69, v7 row_newbcast:7 row_mask:0xf bank_mask:0xf
    v_and_b32_dpp v22, v69, v8 row_newbcast:7 row_mask:0xf bank_mask:0xf
    v_and_b32_dpp v23, v69, v9 row_newbcast:7 row_mask:0xf bank_mask:0xf
    s_waitcnt vmcnt(4)
    buffer_load_dwordx4 v[232:235], v1, s[12:15], s7 offen offset:0 nt
    s_xor_b32 s7, s49, 0x63000
    v_mfma_f32_16x16x32_bf16 v[12:15], v[16:19], v[212:215], v[12:15]
    v_and_b32_dpp v24, v69, v6 row_newbcast:15 row_mask:0xf bank_mask:0xf
    v_and_b32_dpp v25, v69, v7 row_newbcast:15 row_mask:0xf bank_mask:0xf
    v_and_b32_dpp v26, v69, v8 row_newbcast:15 row_mask:0xf bank_mask:0xf
    v_and_b32_dpp v27, v69, v9 row_newbcast:15 row_mask:0xf bank_mask:0xf
    s_waitcnt vmcnt(4)
    buffer_load_dwordx4 v[236:239], v1, s[12:15], s7 offen offset:0 nt
    s_xor_b32 s7, s49, 0x64000
    v_mfma_f32_16x16x32_bf16 v[12:15], v[20:23], v[216:219], v[12:15]
    v_and_b32_dpp v16, v70, v6 row_newbcast:0 row_mask:0xf bank_mask:0xf
    v_and_b32_dpp v17, v70, v7 row_newbcast:0 row_mask:0xf bank_mask:0xf
    v_and_b32_dpp v18, v70, v8 row_newbcast:0 row_mask:0xf bank_mask:0xf
    v_and_b32_dpp v19, v70, v9 row_newbcast:0 row_mask:0xf bank_mask:0xf
    s_waitcnt vmcnt(4)
    buffer_load_dwordx4 v[240:243], v1, s[12:15], s7 offen offset:0 nt
    s_xor_b32 s7, s49, 0x65000
    v_mfma_f32_16x16x32_bf16 v[12:15], v[24:27], v[220:223], v[12:15]
    v_and_b32_dpp v20, v70, v6 row_newbcast:8 row_mask:0xf bank_mask:0xf
    v_and_b32_dpp v21, v70, v7 row_newbcast:8 row_mask:0xf bank_mask:0xf
    v_and_b32_dpp v22, v70, v8 row_newbcast:8 row_mask:0xf bank_mask:0xf
    v_and_b32_dpp v23, v70, v9 row_newbcast:8 row_mask:0xf bank_mask:0xf
    s_waitcnt vmcnt(4)
    buffer_load_dwordx4 v[244:247], v1, s[12:15], s7 offen offset:0 nt
    s_xor_b32 s7, s49, 0x66000
    v_mfma_f32_16x16x32_bf16 v[12:15], v[16:19], v[224:227], v[12:15]
    v_and_b32_dpp v24, v70, v6 row_newbcast:4 row_mask:0xf bank_mask:0xf
    v_and_b32_dpp v25, v70, v7 row_newbcast:4 row_mask:0xf bank_mask:0xf
    v_and_b32_dpp v26, v70, v8 row_newbcast:4 row_mask:0xf bank_mask:0xf
    v_and_b32_dpp v27, v70, v9 row_newbcast:4 row_mask:0xf bank_mask:0xf
    s_waitcnt vmcnt(4)
    buffer_load_dwordx4 v[248:251], v1, s[12:15], s7 offen offset:0 nt
    s_xor_b32 s7, s49, 0x67000
    v_mfma_f32_16x16x32_bf16 v[12:15], v[20:23], v[228:231], v[12:15]
    v_and_b32_dpp v16, v70, v6 row_newbcast:12 row_mask:0xf bank_mask:0xf
    v_and_b32_dpp v17, v70, v7 row_newbcast:12 row_mask:0xf bank_mask:0xf
    v_and_b32_dpp v18, v70, v8 row_newbcast:12 row_mask:0xf bank_mask:0xf
    v_and_b32_dpp v19, v70, v9 row_newbcast:12 row_mask:0xf bank_mask:0xf
    s_waitcnt vmcnt(4)
    buffer_load_dwordx4 v[252:255], v1, s[12:15], s7 offen offset:0 nt
    s_xor_b32 s7, s49, 0x68000
    v_mfma_f32_16x16x32_bf16 v[12:15], v[24:27], v[232:235], v[12:15]
    v_and_b32_dpp v20, v70, v6 row_newbcast:2 row_mask:0xf bank_mask:0xf
    v_and_b32_dpp v21, v70, v7 row_newbcast:2 row_mask:0xf bank_mask:0xf
    v_and_b32_dpp v22, v70, v8 row_newbcast:2 row_mask:0xf bank_mask:0xf
    v_and_b32_dpp v23, v70, v9 row_newbcast:2 row_mask:0xf bank_mask:0xf
    s_waitcnt vmcnt(4)
    buffer_load_dwordx4 v[96:99], v1, s[12:15], s7 offen offset:0 nt
    s_xor_b32 s7, s49, 0x69000
    v_mfma_f32_16x16x32_bf16 v[12:15], v[16:19], v[236:239], v[12:15]
    v_and_b32_dpp v24, v70, v6 row_newbcast:10 row_mask:0xf bank_mask:0xf
    v_and_b32_dpp v25, v70, v7 row_newbcast:10 row_mask:0xf bank_mask:0xf
    v_and_b32_dpp v26, v70, v8 row_newbcast:10 row_mask:0xf bank_mask:0xf
    v_and_b32_dpp v27, v70, v9 row_newbcast:10 row_mask:0xf bank_mask:0xf
    s_waitcnt vmcnt(4)
    buffer_load_dwordx4 v[100:103], v1, s[12:15], s7 offen offset:0 nt
    s_xor_b32 s7, s49, 0x6a000
    v_mfma_f32_16x16x32_bf16 v[12:15], v[20:23], v[240:243], v[12:15]
    v_and_b32_dpp v16, v70, v6 row_newbcast:6 row_mask:0xf bank_mask:0xf
    v_and_b32_dpp v17, v70, v7 row_newbcast:6 row_mask:0xf bank_mask:0xf
    v_and_b32_dpp v18, v70, v8 row_newbcast:6 row_mask:0xf bank_mask:0xf
    v_and_b32_dpp v19, v70, v9 row_newbcast:6 row_mask:0xf bank_mask:0xf
    s_waitcnt vmcnt(4)
    buffer_load_dwordx4 v[104:107], v1, s[12:15], s7 offen offset:0 nt
    s_xor_b32 s7, s49, 0x6b000
    v_mfma_f32_16x16x32_bf16 v[12:15], v[24:27], v[244:247], v[12:15]
    v_and_b32_dpp v20, v70, v6 row_newbcast:14 row_mask:0xf bank_mask:0xf
    v_and_b32_dpp v21, v70, v7 row_newbcast:14 row_mask:0xf bank_mask:0xf
    v_and_b32_dpp v22, v70, v8 row_newbcast:14 row_mask:0xf bank_mask:0xf
    v_and_b32_dpp v23, v70, v9 row_newbcast:14 row_mask:0xf bank_mask:0xf
    s_waitcnt vmcnt(4)
    buffer_load_dwordx4 v[108:111], v1, s[12:15], s7 offen offset:0 nt
    s_xor_b32 s7, s49, 0x6c000
    v_mfma_f32_16x16x32_bf16 v[12:15], v[16:19], v[248:251], v[12:15]
    v_and_b32_dpp v24, v70, v6 row_newbcast:1 row_mask:0xf bank_mask:0xf
    v_and_b32_dpp v25, v70, v7 row_newbcast:1 row_mask:0xf bank_mask:0xf
    v_and_b32_dpp v26, v70, v8 row_newbcast:1 row_mask:0xf bank_mask:0xf
    v_and_b32_dpp v27, v70, v9 row_newbcast:1 row_mask:0xf bank_mask:0xf
    s_waitcnt vmcnt(4)
    buffer_load_dwordx4 v[112:115], v1, s[12:15], s7 offen offset:0 nt
    s_xor_b32 s7, s49, 0x6d000
    v_mfma_f32_16x16x32_bf16 v[12:15], v[20:23], v[252:255], v[12:15]
    v_and_b32_dpp v16, v70, v6 row_newbcast:9 row_mask:0xf bank_mask:0xf
    v_and_b32_dpp v17, v70, v7 row_newbcast:9 row_mask:0xf bank_mask:0xf
    v_and_b32_dpp v18, v70, v8 row_newbcast:9 row_mask:0xf bank_mask:0xf
    v_and_b32_dpp v19, v70, v9 row_newbcast:9 row_mask:0xf bank_mask:0xf
    s_waitcnt vmcnt(4)
    buffer_load_dwordx4 v[116:119], v1, s[12:15], s7 offen offset:0 nt
    s_xor_b32 s7, s49, 0x6e000
    v_mfma_f32_16x16x32_bf16 v[12:15], v[24:27], v[96:99], v[12:15]
    v_and_b32_dpp v20, v70, v6 row_newbcast:5 row_mask:0xf bank_mask:0xf
    v_and_b32_dpp v21, v70, v7 row_newbcast:5 row_mask:0xf bank_mask:0xf
    v_and_b32_dpp v22, v70, v8 row_newbcast:5 row_mask:0xf bank_mask:0xf
    v_and_b32_dpp v23, v70, v9 row_newbcast:5 row_mask:0xf bank_mask:0xf
    s_waitcnt vmcnt(4)
    buffer_load_dwordx4 v[120:123], v1, s[12:15], s7 offen offset:0 nt
    s_xor_b32 s7, s49, 0x6f000
    v_mfma_f32_16x16x32_bf16 v[12:15], v[16:19], v[100:103], v[12:15]
    v_and_b32_dpp v24, v70, v6 row_newbcast:13 row_mask:0xf bank_mask:0xf
    v_and_b32_dpp v25, v70, v7 row_newbcast:13 row_mask:0xf bank_mask:0xf
    v_and_b32_dpp v26, v70, v8 row_newbcast:13 row_mask:0xf bank_mask:0xf
    v_and_b32_dpp v27, v70, v9 row_newbcast:13 row_mask:0xf bank_mask:0xf
    s_waitcnt vmcnt(4)
    buffer_load_dwordx4 v[124:127], v1, s[12:15], s7 offen offset:0 nt
    s_xor_b32 s7, s49, 0x70000
    v_mfma_f32_16x16x32_bf16 v[12:15], v[20:23], v[104:107], v[12:15]
    v_and_b32_dpp v16, v70, v6 row_newbcast:3 row_mask:0xf bank_mask:0xf
    v_and_b32_dpp v17, v70, v7 row_newbcast:3 row_mask:0xf bank_mask:0xf
    v_and_b32_dpp v18, v70, v8 row_newbcast:3 row_mask:0xf bank_mask:0xf
    v_and_b32_dpp v19, v70, v9 row_newbcast:3 row_mask:0xf bank_mask:0xf
    s_waitcnt vmcnt(4)
    buffer_load_dwordx4 v[128:131], v1, s[12:15], s7 offen offset:0 nt
    s_xor_b32 s7, s49, 0x71000
    v_mfma_f32_16x16x32_bf16 v[12:15], v[24:27], v[108:111], v[12:15]
    v_and_b32_dpp v20, v70, v6 row_newbcast:11 row_mask:0xf bank_mask:0xf
    v_and_b32_dpp v21, v70, v7 row_newbcast:11 row_mask:0xf bank_mask:0xf
    v_and_b32_dpp v22, v70, v8 row_newbcast:11 row_mask:0xf bank_mask:0xf
    v_and_b32_dpp v23, v70, v9 row_newbcast:11 row_mask:0xf bank_mask:0xf
    s_waitcnt vmcnt(4)
    buffer_load_dwordx4 v[132:135], v1, s[12:15], s7 offen offset:0 nt
    s_xor_b32 s7, s49, 0x72000
    v_mfma_f32_16x16x32_bf16 v[12:15], v[16:19], v[112:115], v[12:15]
    v_and_b32_dpp v24, v70, v6 row_newbcast:7 row_mask:0xf bank_mask:0xf
    v_and_b32_dpp v25, v70, v7 row_newbcast:7 row_mask:0xf bank_mask:0xf
    v_and_b32_dpp v26, v70, v8 row_newbcast:7 row_mask:0xf bank_mask:0xf
    v_and_b32_dpp v27, v70, v9 row_newbcast:7 row_mask:0xf bank_mask:0xf
    s_waitcnt vmcnt(4)
    buffer_load_dwordx4 v[136:139], v1, s[12:15], s7 offen offset:0 nt
    s_xor_b32 s7, s49, 0x73000
    v_mfma_f32_16x16x32_bf16 v[12:15], v[20:23], v[116:119], v[12:15]
    v_and_b32_dpp v16, v70, v6 row_newbcast:15 row_mask:0xf bank_mask:0xf
    v_and_b32_dpp v17, v70, v7 row_newbcast:15 row_mask:0xf bank_mask:0xf
    v_and_b32_dpp v18, v70, v8 row_newbcast:15 row_mask:0xf bank_mask:0xf
    v_and_b32_dpp v19, v70, v9 row_newbcast:15 row_mask:0xf bank_mask:0xf
    s_waitcnt vmcnt(4)
    buffer_load_dwordx4 v[140:143], v1, s[12:15], s7 offen offset:0 nt
    s_xor_b32 s7, s49, 0x74000
    v_mfma_f32_16x16x32_bf16 v[12:15], v[24:27], v[120:123], v[12:15]
    v_and_b32_dpp v20, v71, v6 row_newbcast:0 row_mask:0xf bank_mask:0xf
    v_and_b32_dpp v21, v71, v7 row_newbcast:0 row_mask:0xf bank_mask:0xf
    v_and_b32_dpp v22, v71, v8 row_newbcast:0 row_mask:0xf bank_mask:0xf
    v_and_b32_dpp v23, v71, v9 row_newbcast:0 row_mask:0xf bank_mask:0xf
    s_waitcnt vmcnt(4)
    buffer_load_dwordx4 v[144:147], v1, s[12:15], s7 offen offset:0 nt
    s_xor_b32 s7, s49, 0x75000
    v_mfma_f32_16x16x32_bf16 v[12:15], v[16:19], v[124:127], v[12:15]
    v_and_b32_dpp v24, v71, v6 row_newbcast:8 row_mask:0xf bank_mask:0xf
    v_and_b32_dpp v25, v71, v7 row_newbcast:8 row_mask:0xf bank_mask:0xf
    v_and_b32_dpp v26, v71, v8 row_newbcast:8 row_mask:0xf bank_mask:0xf
    v_and_b32_dpp v27, v71, v9 row_newbcast:8 row_mask:0xf bank_mask:0xf
    s_waitcnt vmcnt(4)
    buffer_load_dwordx4 v[148:151], v1, s[12:15], s7 offen offset:0 nt
    s_xor_b32 s7, s49, 0x76000
    v_mfma_f32_16x16x32_bf16 v[12:15], v[20:23], v[128:131], v[12:15]
    v_and_b32_dpp v16, v71, v6 row_newbcast:4 row_mask:0xf bank_mask:0xf
    v_and_b32_dpp v17, v71, v7 row_newbcast:4 row_mask:0xf bank_mask:0xf
    v_and_b32_dpp v18, v71, v8 row_newbcast:4 row_mask:0xf bank_mask:0xf
    v_and_b32_dpp v19, v71, v9 row_newbcast:4 row_mask:0xf bank_mask:0xf
    s_waitcnt vmcnt(4)
    buffer_load_dwordx4 v[152:155], v1, s[12:15], s7 offen offset:0 nt
    s_xor_b32 s7, s49, 0x77000
    v_mfma_f32_16x16x32_bf16 v[12:15], v[24:27], v[132:135], v[12:15]
    v_and_b32_dpp v20, v71, v6 row_newbcast:12 row_mask:0xf bank_mask:0xf
    v_and_b32_dpp v21, v71, v7 row_newbcast:12 row_mask:0xf bank_mask:0xf
    v_and_b32_dpp v22, v71, v8 row_newbcast:12 row_mask:0xf bank_mask:0xf
    v_and_b32_dpp v23, v71, v9 row_newbcast:12 row_mask:0xf bank_mask:0xf
    s_waitcnt vmcnt(4)
    buffer_load_dwordx4 v[156:159], v1, s[12:15], s7 offen offset:0 nt
    s_xor_b32 s7, s49, 0x78000
    v_mfma_f32_16x16x32_bf16 v[12:15], v[16:19], v[136:139], v[12:15]
    v_and_b32_dpp v24, v71, v6 row_newbcast:2 row_mask:0xf bank_mask:0xf
    v_and_b32_dpp v25, v71, v7 row_newbcast:2 row_mask:0xf bank_mask:0xf
    v_and_b32_dpp v26, v71, v8 row_newbcast:2 row_mask:0xf bank_mask:0xf
    v_and_b32_dpp v27, v71, v9 row_newbcast:2 row_mask:0xf bank_mask:0xf
    s_waitcnt vmcnt(4)
    buffer_load_dwordx4 v[160:163], v1, s[12:15], s7 offen offset:0 nt
    s_xor_b32 s7, s49, 0x79000
    v_mfma_f32_16x16x32_bf16 v[12:15], v[20:23], v[140:143], v[12:15]
    v_and_b32_dpp v16, v71, v6 row_newbcast:10 row_mask:0xf bank_mask:0xf
    v_and_b32_dpp v17, v71, v7 row_newbcast:10 row_mask:0xf bank_mask:0xf
    v_and_b32_dpp v18, v71, v8 row_newbcast:10 row_mask:0xf bank_mask:0xf
    v_and_b32_dpp v19, v71, v9 row_newbcast:10 row_mask:0xf bank_mask:0xf
    s_waitcnt vmcnt(4)
    buffer_load_dwordx4 v[164:167], v1, s[12:15], s7 offen offset:0 nt
    s_xor_b32 s7, s49, 0x7a000
    v_mfma_f32_16x16x32_bf16 v[12:15], v[24:27], v[144:147], v[12:15]
    v_and_b32_dpp v20, v71, v6 row_newbcast:6 row_mask:0xf bank_mask:0xf
    v_and_b32_dpp v21, v71, v7 row_newbcast:6 row_mask:0xf bank_mask:0xf
    v_and_b32_dpp v22, v71, v8 row_newbcast:6 row_mask:0xf bank_mask:0xf
    v_and_b32_dpp v23, v71, v9 row_newbcast:6 row_mask:0xf bank_mask:0xf
    s_waitcnt vmcnt(4)
    buffer_load_dwordx4 v[168:171], v1, s[12:15], s7 offen offset:0 nt
    s_xor_b32 s7, s49, 0x7b000
    v_mfma_f32_16x16x32_bf16 v[12:15], v[16:19], v[148:151], v[12:15]
    v_and_b32_dpp v24, v71, v6 row_newbcast:14 row_mask:0xf bank_mask:0xf
    v_and_b32_dpp v25, v71, v7 row_newbcast:14 row_mask:0xf bank_mask:0xf
    v_and_b32_dpp v26, v71, v8 row_newbcast:14 row_mask:0xf bank_mask:0xf
    v_and_b32_dpp v27, v71, v9 row_newbcast:14 row_mask:0xf bank_mask:0xf
    s_waitcnt vmcnt(4)
    buffer_load_dwordx4 v[172:175], v1, s[12:15], s7 offen offset:0 nt
    s_xor_b32 s7, s49, 0x7c000
    v_mfma_f32_16x16x32_bf16 v[12:15], v[20:23], v[152:155], v[12:15]
    v_and_b32_dpp v16, v71, v6 row_newbcast:1 row_mask:0xf bank_mask:0xf
    v_and_b32_dpp v17, v71, v7 row_newbcast:1 row_mask:0xf bank_mask:0xf
    v_and_b32_dpp v18, v71, v8 row_newbcast:1 row_mask:0xf bank_mask:0xf
    v_and_b32_dpp v19, v71, v9 row_newbcast:1 row_mask:0xf bank_mask:0xf
    s_waitcnt vmcnt(4)
    buffer_load_dwordx4 v[176:179], v1, s[12:15], s7 offen offset:0 nt
    s_xor_b32 s7, s49, 0x7d000
    v_mfma_f32_16x16x32_bf16 v[12:15], v[24:27], v[156:159], v[12:15]
    v_and_b32_dpp v20, v71, v6 row_newbcast:9 row_mask:0xf bank_mask:0xf
    v_and_b32_dpp v21, v71, v7 row_newbcast:9 row_mask:0xf bank_mask:0xf
    v_and_b32_dpp v22, v71, v8 row_newbcast:9 row_mask:0xf bank_mask:0xf
    v_and_b32_dpp v23, v71, v9 row_newbcast:9 row_mask:0xf bank_mask:0xf
    s_waitcnt vmcnt(4)
    buffer_load_dwordx4 v[180:183], v1, s[12:15], s7 offen offset:0 nt
    s_xor_b32 s7, s49, 0x7e000
    v_mfma_f32_16x16x32_bf16 v[12:15], v[16:19], v[160:163], v[12:15]
    v_and_b32_dpp v24, v71, v6 row_newbcast:5 row_mask:0xf bank_mask:0xf
    v_and_b32_dpp v25, v71, v7 row_newbcast:5 row_mask:0xf bank_mask:0xf
    v_and_b32_dpp v26, v71, v8 row_newbcast:5 row_mask:0xf bank_mask:0xf
    v_and_b32_dpp v27, v71, v9 row_newbcast:5 row_mask:0xf bank_mask:0xf
    s_waitcnt vmcnt(4)
    buffer_load_dwordx4 v[184:187], v1, s[12:15], s7 offen offset:0 nt
    s_xor_b32 s7, s49, 0x7f000
    v_mfma_f32_16x16x32_bf16 v[12:15], v[20:23], v[164:167], v[12:15]
    v_and_b32_dpp v16, v71, v6 row_newbcast:13 row_mask:0xf bank_mask:0xf
    v_and_b32_dpp v17, v71, v7 row_newbcast:13 row_mask:0xf bank_mask:0xf
    v_and_b32_dpp v18, v71, v8 row_newbcast:13 row_mask:0xf bank_mask:0xf
    v_and_b32_dpp v19, v71, v9 row_newbcast:13 row_mask:0xf bank_mask:0xf
    s_waitcnt vmcnt(4)
    buffer_load_dwordx4 v[188:191], v1, s[12:15], s7 offen offset:0 nt
    s_xor_b32 s7, s49, 0x80000
    v_mfma_f32_16x16x32_bf16 v[12:15], v[24:27], v[168:171], v[12:15]
    v_and_b32_dpp v20, v71, v6 row_newbcast:3 row_mask:0xf bank_mask:0xf
    v_and_b32_dpp v21, v71, v7 row_newbcast:3 row_mask:0xf bank_mask:0xf
    v_and_b32_dpp v22, v71, v8 row_newbcast:3 row_mask:0xf bank_mask:0xf
    v_and_b32_dpp v23, v71, v9 row_newbcast:3 row_mask:0xf bank_mask:0xf
    s_waitcnt vmcnt(4)
    buffer_load_dwordx4 v[192:195], v1, s[12:15], s7 offen offset:0 nt
    s_xor_b32 s7, s49, 0x81000
    v_mfma_f32_16x16x32_bf16 v[12:15], v[16:19], v[172:175], v[12:15]
    v_and_b32_dpp v24, v71, v6 row_newbcast:11 row_mask:0xf bank_mask:0xf
    v_and_b32_dpp v25, v71, v7 row_newbcast:11 row_mask:0xf bank_mask:0xf
    v_and_b32_dpp v26, v71, v8 row_newbcast:11 row_mask:0xf bank_mask:0xf
    v_and_b32_dpp v27, v71, v9 row_newbcast:11 row_mask:0xf bank_mask:0xf
    s_waitcnt vmcnt(4)
    buffer_load_dwordx4 v[196:199], v1, s[12:15], s7 offen offset:0 nt
    s_xor_b32 s7, s49, 0x82000
    v_mfma_f32_16x16x32_bf16 v[12:15], v[20:23], v[176:179], v[12:15]
    v_and_b32_dpp v16, v71, v6 row_newbcast:7 row_mask:0xf bank_mask:0xf
    v_and_b32_dpp v17, v71, v7 row_newbcast:7 row_mask:0xf bank_mask:0xf
    v_and_b32_dpp v18, v71, v8 row_newbcast:7 row_mask:0xf bank_mask:0xf
    v_and_b32_dpp v19, v71, v9 row_newbcast:7 row_mask:0xf bank_mask:0xf
    s_waitcnt vmcnt(4)
    buffer_load_dwordx4 v[200:203], v1, s[12:15], s7 offen offset:0 nt
    s_xor_b32 s7, s49, 0x83000
    v_mfma_f32_16x16x32_bf16 v[12:15], v[24:27], v[180:183], v[12:15]
    v_and_b32_dpp v20, v71, v6 row_newbcast:15 row_mask:0xf bank_mask:0xf
    v_and_b32_dpp v21, v71, v7 row_newbcast:15 row_mask:0xf bank_mask:0xf
    v_and_b32_dpp v22, v71, v8 row_newbcast:15 row_mask:0xf bank_mask:0xf
    v_and_b32_dpp v23, v71, v9 row_newbcast:15 row_mask:0xf bank_mask:0xf
    s_waitcnt vmcnt(4)
    buffer_load_dwordx4 v[204:207], v1, s[12:15], s7 offen offset:0 nt
    s_xor_b32 s7, s49, 0x84000
    v_mfma_f32_16x16x32_bf16 v[12:15], v[16:19], v[184:187], v[12:15]
    v_and_b32_dpp v24, v72, v6 row_newbcast:0 row_mask:0xf bank_mask:0xf
    v_and_b32_dpp v25, v72, v7 row_newbcast:0 row_mask:0xf bank_mask:0xf
    v_and_b32_dpp v26, v72, v8 row_newbcast:0 row_mask:0xf bank_mask:0xf
    v_and_b32_dpp v27, v72, v9 row_newbcast:0 row_mask:0xf bank_mask:0xf
    s_waitcnt vmcnt(4)
    buffer_load_dwordx4 v[208:211], v1, s[12:15], s7 offen offset:0 nt
    s_xor_b32 s7, s49, 0x85000
    v_mfma_f32_16x16x32_bf16 v[12:15], v[20:23], v[188:191], v[12:15]
    v_and_b32_dpp v16, v72, v6 row_newbcast:8 row_mask:0xf bank_mask:0xf
    v_and_b32_dpp v17, v72, v7 row_newbcast:8 row_mask:0xf bank_mask:0xf
    v_and_b32_dpp v18, v72, v8 row_newbcast:8 row_mask:0xf bank_mask:0xf
    v_and_b32_dpp v19, v72, v9 row_newbcast:8 row_mask:0xf bank_mask:0xf
    s_waitcnt vmcnt(4)
    buffer_load_dwordx4 v[212:215], v1, s[12:15], s7 offen offset:0 nt
    s_xor_b32 s7, s49, 0x86000
    v_mfma_f32_16x16x32_bf16 v[12:15], v[24:27], v[192:195], v[12:15]
    v_and_b32_dpp v20, v72, v6 row_newbcast:4 row_mask:0xf bank_mask:0xf
    v_and_b32_dpp v21, v72, v7 row_newbcast:4 row_mask:0xf bank_mask:0xf
    v_and_b32_dpp v22, v72, v8 row_newbcast:4 row_mask:0xf bank_mask:0xf
    v_and_b32_dpp v23, v72, v9 row_newbcast:4 row_mask:0xf bank_mask:0xf
    s_waitcnt vmcnt(4)
    buffer_load_dwordx4 v[216:219], v1, s[12:15], s7 offen offset:0 nt
    s_xor_b32 s7, s49, 0x87000
    v_mfma_f32_16x16x32_bf16 v[12:15], v[16:19], v[196:199], v[12:15]
    v_and_b32_dpp v24, v72, v6 row_newbcast:12 row_mask:0xf bank_mask:0xf
    v_and_b32_dpp v25, v72, v7 row_newbcast:12 row_mask:0xf bank_mask:0xf
    v_and_b32_dpp v26, v72, v8 row_newbcast:12 row_mask:0xf bank_mask:0xf
    v_and_b32_dpp v27, v72, v9 row_newbcast:12 row_mask:0xf bank_mask:0xf
    s_waitcnt vmcnt(4)
    buffer_load_dwordx4 v[220:223], v1, s[12:15], s7 offen offset:0 nt
    s_xor_b32 s7, s49, 0x88000
    v_mfma_f32_16x16x32_bf16 v[12:15], v[20:23], v[200:203], v[12:15]
    v_and_b32_dpp v16, v72, v6 row_newbcast:2 row_mask:0xf bank_mask:0xf
    v_and_b32_dpp v17, v72, v7 row_newbcast:2 row_mask:0xf bank_mask:0xf
    v_and_b32_dpp v18, v72, v8 row_newbcast:2 row_mask:0xf bank_mask:0xf
    v_and_b32_dpp v19, v72, v9 row_newbcast:2 row_mask:0xf bank_mask:0xf
    s_waitcnt vmcnt(4)
    buffer_load_dwordx4 v[224:227], v1, s[12:15], s7 offen offset:0 nt
    s_xor_b32 s7, s49, 0x89000
    v_mfma_f32_16x16x32_bf16 v[12:15], v[24:27], v[204:207], v[12:15]
    v_and_b32_dpp v20, v72, v6 row_newbcast:10 row_mask:0xf bank_mask:0xf
    v_and_b32_dpp v21, v72, v7 row_newbcast:10 row_mask:0xf bank_mask:0xf
    v_and_b32_dpp v22, v72, v8 row_newbcast:10 row_mask:0xf bank_mask:0xf
    v_and_b32_dpp v23, v72, v9 row_newbcast:10 row_mask:0xf bank_mask:0xf
    s_waitcnt vmcnt(4)
    buffer_load_dwordx4 v[228:231], v1, s[12:15], s7 offen offset:0 nt
    s_xor_b32 s7, s49, 0x8a000
    v_mfma_f32_16x16x32_bf16 v[12:15], v[16:19], v[208:211], v[12:15]
    v_and_b32_dpp v24, v72, v6 row_newbcast:6 row_mask:0xf bank_mask:0xf
    v_and_b32_dpp v25, v72, v7 row_newbcast:6 row_mask:0xf bank_mask:0xf
    v_and_b32_dpp v26, v72, v8 row_newbcast:6 row_mask:0xf bank_mask:0xf
    v_and_b32_dpp v27, v72, v9 row_newbcast:6 row_mask:0xf bank_mask:0xf
    s_waitcnt vmcnt(4)
    buffer_load_dwordx4 v[232:235], v1, s[12:15], s7 offen offset:0 nt
    s_xor_b32 s7, s49, 0x8b000
    v_mfma_f32_16x16x32_bf16 v[12:15], v[20:23], v[212:215], v[12:15]
    v_and_b32_dpp v16, v72, v6 row_newbcast:14 row_mask:0xf bank_mask:0xf
    v_and_b32_dpp v17, v72, v7 row_newbcast:14 row_mask:0xf bank_mask:0xf
    v_and_b32_dpp v18, v72, v8 row_newbcast:14 row_mask:0xf bank_mask:0xf
    v_and_b32_dpp v19, v72, v9 row_newbcast:14 row_mask:0xf bank_mask:0xf
    s_waitcnt vmcnt(4)
    buffer_load_dwordx4 v[236:239], v1, s[12:15], s7 offen offset:0 nt
    s_xor_b32 s7, s49, 0x8c000
    v_mfma_f32_16x16x32_bf16 v[12:15], v[24:27], v[216:219], v[12:15]
    v_and_b32_dpp v20, v72, v6 row_newbcast:1 row_mask:0xf bank_mask:0xf
    v_and_b32_dpp v21, v72, v7 row_newbcast:1 row_mask:0xf bank_mask:0xf
    v_and_b32_dpp v22, v72, v8 row_newbcast:1 row_mask:0xf bank_mask:0xf
    v_and_b32_dpp v23, v72, v9 row_newbcast:1 row_mask:0xf bank_mask:0xf
    s_waitcnt vmcnt(4)
    buffer_load_dwordx4 v[240:243], v1, s[12:15], s7 offen offset:0 nt
    s_xor_b32 s7, s49, 0x8d000
    v_mfma_f32_16x16x32_bf16 v[12:15], v[16:19], v[220:223], v[12:15]
    v_and_b32_dpp v24, v72, v6 row_newbcast:9 row_mask:0xf bank_mask:0xf
    v_and_b32_dpp v25, v72, v7 row_newbcast:9 row_mask:0xf bank_mask:0xf
    v_and_b32_dpp v26, v72, v8 row_newbcast:9 row_mask:0xf bank_mask:0xf
    v_and_b32_dpp v27, v72, v9 row_newbcast:9 row_mask:0xf bank_mask:0xf
    s_waitcnt vmcnt(4)
    buffer_load_dwordx4 v[244:247], v1, s[12:15], s7 offen offset:0 nt
    s_xor_b32 s7, s49, 0x8e000
    v_mfma_f32_16x16x32_bf16 v[12:15], v[20:23], v[224:227], v[12:15]
    v_and_b32_dpp v16, v72, v6 row_newbcast:5 row_mask:0xf bank_mask:0xf
    v_and_b32_dpp v17, v72, v7 row_newbcast:5 row_mask:0xf bank_mask:0xf
    v_and_b32_dpp v18, v72, v8 row_newbcast:5 row_mask:0xf bank_mask:0xf
    v_and_b32_dpp v19, v72, v9 row_newbcast:5 row_mask:0xf bank_mask:0xf
    s_waitcnt vmcnt(4)
    buffer_load_dwordx4 v[248:251], v1, s[12:15], s7 offen offset:0 nt
    s_xor_b32 s7, s49, 0x8f000
    v_mfma_f32_16x16x32_bf16 v[12:15], v[24:27], v[228:231], v[12:15]
    v_and_b32_dpp v20, v72, v6 row_newbcast:13 row_mask:0xf bank_mask:0xf
    v_and_b32_dpp v21, v72, v7 row_newbcast:13 row_mask:0xf bank_mask:0xf
    v_and_b32_dpp v22, v72, v8 row_newbcast:13 row_mask:0xf bank_mask:0xf
    v_and_b32_dpp v23, v72, v9 row_newbcast:13 row_mask:0xf bank_mask:0xf
    s_waitcnt vmcnt(4)
    buffer_load_dwordx4 v[252:255], v1, s[12:15], s7 offen offset:0 nt
    s_xor_b32 s7, s49, 0x90000
    v_mfma_f32_16x16x32_bf16 v[12:15], v[16:19], v[232:235], v[12:15]
    v_and_b32_dpp v24, v72, v6 row_newbcast:3 row_mask:0xf bank_mask:0xf
    v_and_b32_dpp v25, v72, v7 row_newbcast:3 row_mask:0xf bank_mask:0xf
    v_and_b32_dpp v26, v72, v8 row_newbcast:3 row_mask:0xf bank_mask:0xf
    v_and_b32_dpp v27, v72, v9 row_newbcast:3 row_mask:0xf bank_mask:0xf
    s_waitcnt vmcnt(4)
    buffer_load_dwordx4 v[96:99], v1, s[12:15], s7 offen offset:0 nt
    s_xor_b32 s7, s49, 0x91000
    v_mfma_f32_16x16x32_bf16 v[12:15], v[20:23], v[236:239], v[12:15]
    v_and_b32_dpp v16, v72, v6 row_newbcast:11 row_mask:0xf bank_mask:0xf
    v_and_b32_dpp v17, v72, v7 row_newbcast:11 row_mask:0xf bank_mask:0xf
    v_and_b32_dpp v18, v72, v8 row_newbcast:11 row_mask:0xf bank_mask:0xf
    v_and_b32_dpp v19, v72, v9 row_newbcast:11 row_mask:0xf bank_mask:0xf
    s_waitcnt vmcnt(4)
    buffer_load_dwordx4 v[100:103], v1, s[12:15], s7 offen offset:0 nt
    s_xor_b32 s7, s49, 0x92000
    v_mfma_f32_16x16x32_bf16 v[12:15], v[24:27], v[240:243], v[12:15]
    v_and_b32_dpp v20, v72, v6 row_newbcast:7 row_mask:0xf bank_mask:0xf
    v_and_b32_dpp v21, v72, v7 row_newbcast:7 row_mask:0xf bank_mask:0xf
    v_and_b32_dpp v22, v72, v8 row_newbcast:7 row_mask:0xf bank_mask:0xf
    v_and_b32_dpp v23, v72, v9 row_newbcast:7 row_mask:0xf bank_mask:0xf
    s_waitcnt vmcnt(4)
    buffer_load_dwordx4 v[104:107], v1, s[12:15], s7 offen offset:0 nt
    s_xor_b32 s7, s49, 0x93000
    v_mfma_f32_16x16x32_bf16 v[12:15], v[16:19], v[244:247], v[12:15]
    v_and_b32_dpp v24, v72, v6 row_newbcast:15 row_mask:0xf bank_mask:0xf
    v_and_b32_dpp v25, v72, v7 row_newbcast:15 row_mask:0xf bank_mask:0xf
    v_and_b32_dpp v26, v72, v8 row_newbcast:15 row_mask:0xf bank_mask:0xf
    v_and_b32_dpp v27, v72, v9 row_newbcast:15 row_mask:0xf bank_mask:0xf
    s_waitcnt vmcnt(4)
    buffer_load_dwordx4 v[108:111], v1, s[12:15], s7 offen offset:0 nt
    s_xor_b32 s7, s49, 0x94000
    v_mfma_f32_16x16x32_bf16 v[12:15], v[20:23], v[248:251], v[12:15]
    v_and_b32_dpp v16, v73, v6 row_newbcast:0 row_mask:0xf bank_mask:0xf
    v_and_b32_dpp v17, v73, v7 row_newbcast:0 row_mask:0xf bank_mask:0xf
    v_and_b32_dpp v18, v73, v8 row_newbcast:0 row_mask:0xf bank_mask:0xf
    v_and_b32_dpp v19, v73, v9 row_newbcast:0 row_mask:0xf bank_mask:0xf
    s_waitcnt vmcnt(4)
    buffer_load_dwordx4 v[112:115], v1, s[12:15], s7 offen offset:0 nt
    s_xor_b32 s7, s49, 0x95000
    v_mfma_f32_16x16x32_bf16 v[12:15], v[24:27], v[252:255], v[12:15]
    v_and_b32_dpp v20, v73, v6 row_newbcast:8 row_mask:0xf bank_mask:0xf
    v_and_b32_dpp v21, v73, v7 row_newbcast:8 row_mask:0xf bank_mask:0xf
    v_and_b32_dpp v22, v73, v8 row_newbcast:8 row_mask:0xf bank_mask:0xf
    v_and_b32_dpp v23, v73, v9 row_newbcast:8 row_mask:0xf bank_mask:0xf
    s_waitcnt vmcnt(4)
    buffer_load_dwordx4 v[116:119], v1, s[12:15], s7 offen offset:0 nt
    s_xor_b32 s7, s49, 0x96000
    v_mfma_f32_16x16x32_bf16 v[12:15], v[16:19], v[96:99], v[12:15]
    v_and_b32_dpp v24, v73, v6 row_newbcast:4 row_mask:0xf bank_mask:0xf
    v_and_b32_dpp v25, v73, v7 row_newbcast:4 row_mask:0xf bank_mask:0xf
    v_and_b32_dpp v26, v73, v8 row_newbcast:4 row_mask:0xf bank_mask:0xf
    v_and_b32_dpp v27, v73, v9 row_newbcast:4 row_mask:0xf bank_mask:0xf
    s_waitcnt vmcnt(4)
    buffer_load_dwordx4 v[120:123], v1, s[12:15], s7 offen offset:0 nt
    s_xor_b32 s7, s49, 0x97000
    v_mfma_f32_16x16x32_bf16 v[12:15], v[20:23], v[100:103], v[12:15]
    v_and_b32_dpp v16, v73, v6 row_newbcast:12 row_mask:0xf bank_mask:0xf
    v_and_b32_dpp v17, v73, v7 row_newbcast:12 row_mask:0xf bank_mask:0xf
    v_and_b32_dpp v18, v73, v8 row_newbcast:12 row_mask:0xf bank_mask:0xf
    v_and_b32_dpp v19, v73, v9 row_newbcast:12 row_mask:0xf bank_mask:0xf
    s_waitcnt vmcnt(4)
    buffer_load_dwordx4 v[124:127], v1, s[12:15], s7 offen offset:0 nt
    s_xor_b32 s7, s49, 0x98000
    v_mfma_f32_16x16x32_bf16 v[12:15], v[24:27], v[104:107], v[12:15]
    v_and_b32_dpp v20, v73, v6 row_newbcast:2 row_mask:0xf bank_mask:0xf
    v_and_b32_dpp v21, v73, v7 row_newbcast:2 row_mask:0xf bank_mask:0xf
    v_and_b32_dpp v22, v73, v8 row_newbcast:2 row_mask:0xf bank_mask:0xf
    v_and_b32_dpp v23, v73, v9 row_newbcast:2 row_mask:0xf bank_mask:0xf
    s_waitcnt vmcnt(4)
    buffer_load_dwordx4 v[128:131], v1, s[12:15], s7 offen offset:0 nt
    s_xor_b32 s7, s49, 0x99000
    v_mfma_f32_16x16x32_bf16 v[12:15], v[16:19], v[108:111], v[12:15]
    v_and_b32_dpp v24, v73, v6 row_newbcast:10 row_mask:0xf bank_mask:0xf
    v_and_b32_dpp v25, v73, v7 row_newbcast:10 row_mask:0xf bank_mask:0xf
    v_and_b32_dpp v26, v73, v8 row_newbcast:10 row_mask:0xf bank_mask:0xf
    v_and_b32_dpp v27, v73, v9 row_newbcast:10 row_mask:0xf bank_mask:0xf
    s_waitcnt vmcnt(4)
    buffer_load_dwordx4 v[132:135], v1, s[12:15], s7 offen offset:0 nt
    s_xor_b32 s7, s49, 0x9a000
    v_mfma_f32_16x16x32_bf16 v[12:15], v[20:23], v[112:115], v[12:15]
    v_and_b32_dpp v16, v73, v6 row_newbcast:6 row_mask:0xf bank_mask:0xf
    v_and_b32_dpp v17, v73, v7 row_newbcast:6 row_mask:0xf bank_mask:0xf
    v_and_b32_dpp v18, v73, v8 row_newbcast:6 row_mask:0xf bank_mask:0xf
    v_and_b32_dpp v19, v73, v9 row_newbcast:6 row_mask:0xf bank_mask:0xf
    s_waitcnt vmcnt(4)
    buffer_load_dwordx4 v[136:139], v1, s[12:15], s7 offen offset:0 nt
    s_xor_b32 s7, s49, 0x9b000
    v_mfma_f32_16x16x32_bf16 v[12:15], v[24:27], v[116:119], v[12:15]
    v_and_b32_dpp v20, v73, v6 row_newbcast:14 row_mask:0xf bank_mask:0xf
    v_and_b32_dpp v21, v73, v7 row_newbcast:14 row_mask:0xf bank_mask:0xf
    v_and_b32_dpp v22, v73, v8 row_newbcast:14 row_mask:0xf bank_mask:0xf
    v_and_b32_dpp v23, v73, v9 row_newbcast:14 row_mask:0xf bank_mask:0xf
    s_waitcnt vmcnt(4)
    buffer_load_dwordx4 v[140:143], v1, s[12:15], s7 offen offset:0 nt
    s_xor_b32 s7, s49, 0x9c000
    v_mfma_f32_16x16x32_bf16 v[12:15], v[16:19], v[120:123], v[12:15]
    v_and_b32_dpp v24, v73, v6 row_newbcast:1 row_mask:0xf bank_mask:0xf
    v_and_b32_dpp v25, v73, v7 row_newbcast:1 row_mask:0xf bank_mask:0xf
    v_and_b32_dpp v26, v73, v8 row_newbcast:1 row_mask:0xf bank_mask:0xf
    v_and_b32_dpp v27, v73, v9 row_newbcast:1 row_mask:0xf bank_mask:0xf
    s_waitcnt vmcnt(4)
    buffer_load_dwordx4 v[144:147], v1, s[12:15], s7 offen offset:0 nt
    s_xor_b32 s7, s49, 0x9d000
    v_mfma_f32_16x16x32_bf16 v[12:15], v[20:23], v[124:127], v[12:15]
    v_and_b32_dpp v16, v73, v6 row_newbcast:9 row_mask:0xf bank_mask:0xf
    v_and_b32_dpp v17, v73, v7 row_newbcast:9 row_mask:0xf bank_mask:0xf
    v_and_b32_dpp v18, v73, v8 row_newbcast:9 row_mask:0xf bank_mask:0xf
    v_and_b32_dpp v19, v73, v9 row_newbcast:9 row_mask:0xf bank_mask:0xf
    s_waitcnt vmcnt(4)
    buffer_load_dwordx4 v[148:151], v1, s[12:15], s7 offen offset:0 nt
    s_xor_b32 s7, s49, 0x9e000
    v_mfma_f32_16x16x32_bf16 v[12:15], v[24:27], v[128:131], v[12:15]
    v_and_b32_dpp v20, v73, v6 row_newbcast:5 row_mask:0xf bank_mask:0xf
    v_and_b32_dpp v21, v73, v7 row_newbcast:5 row_mask:0xf bank_mask:0xf
    v_and_b32_dpp v22, v73, v8 row_newbcast:5 row_mask:0xf bank_mask:0xf
    v_and_b32_dpp v23, v73, v9 row_newbcast:5 row_mask:0xf bank_mask:0xf
    s_waitcnt vmcnt(4)
    buffer_load_dwordx4 v[152:155], v1, s[12:15], s7 offen offset:0 nt
    s_xor_b32 s7, s49, 0x9f000
    v_mfma_f32_16x16x32_bf16 v[12:15], v[16:19], v[132:135], v[12:15]
    v_and_b32_dpp v24, v73, v6 row_newbcast:13 row_mask:0xf bank_mask:0xf
    v_and_b32_dpp v25, v73, v7 row_newbcast:13 row_mask:0xf bank_mask:0xf
    v_and_b32_dpp v26, v73, v8 row_newbcast:13 row_mask:0xf bank_mask:0xf
    v_and_b32_dpp v27, v73, v9 row_newbcast:13 row_mask:0xf bank_mask:0xf
    s_waitcnt vmcnt(4)
    buffer_load_dwordx4 v[156:159], v1, s[12:15], s7 offen offset:0 nt
    s_xor_b32 s7, s49, 0xa0000
    v_mfma_f32_16x16x32_bf16 v[12:15], v[20:23], v[136:139], v[12:15]
    v_and_b32_dpp v16, v73, v6 row_newbcast:3 row_mask:0xf bank_mask:0xf
    v_and_b32_dpp v17, v73, v7 row_newbcast:3 row_mask:0xf bank_mask:0xf
    v_and_b32_dpp v18, v73, v8 row_newbcast:3 row_mask:0xf bank_mask:0xf
    v_and_b32_dpp v19, v73, v9 row_newbcast:3 row_mask:0xf bank_mask:0xf
    s_waitcnt vmcnt(4)
    buffer_load_dwordx4 v[160:163], v1, s[12:15], s7 offen offset:0 nt
    s_xor_b32 s7, s49, 0xa1000
    v_mfma_f32_16x16x32_bf16 v[12:15], v[24:27], v[140:143], v[12:15]
    v_and_b32_dpp v20, v73, v6 row_newbcast:11 row_mask:0xf bank_mask:0xf
    v_and_b32_dpp v21, v73, v7 row_newbcast:11 row_mask:0xf bank_mask:0xf
    v_and_b32_dpp v22, v73, v8 row_newbcast:11 row_mask:0xf bank_mask:0xf
    v_and_b32_dpp v23, v73, v9 row_newbcast:11 row_mask:0xf bank_mask:0xf
    s_waitcnt vmcnt(4)
    buffer_load_dwordx4 v[164:167], v1, s[12:15], s7 offen offset:0 nt
    s_xor_b32 s7, s49, 0xa2000
    v_mfma_f32_16x16x32_bf16 v[12:15], v[16:19], v[144:147], v[12:15]
    v_and_b32_dpp v24, v73, v6 row_newbcast:7 row_mask:0xf bank_mask:0xf
    v_and_b32_dpp v25, v73, v7 row_newbcast:7 row_mask:0xf bank_mask:0xf
    v_and_b32_dpp v26, v73, v8 row_newbcast:7 row_mask:0xf bank_mask:0xf
    v_and_b32_dpp v27, v73, v9 row_newbcast:7 row_mask:0xf bank_mask:0xf
    s_waitcnt vmcnt(4)
    buffer_load_dwordx4 v[168:171], v1, s[12:15], s7 offen offset:0 nt
    s_xor_b32 s7, s49, 0xa3000
    v_mfma_f32_16x16x32_bf16 v[12:15], v[20:23], v[148:151], v[12:15]
    v_and_b32_dpp v16, v73, v6 row_newbcast:15 row_mask:0xf bank_mask:0xf
    v_and_b32_dpp v17, v73, v7 row_newbcast:15 row_mask:0xf bank_mask:0xf
    v_and_b32_dpp v18, v73, v8 row_newbcast:15 row_mask:0xf bank_mask:0xf
    v_and_b32_dpp v19, v73, v9 row_newbcast:15 row_mask:0xf bank_mask:0xf
    s_waitcnt vmcnt(4)
    buffer_load_dwordx4 v[172:175], v1, s[12:15], s7 offen offset:0 nt
    s_xor_b32 s7, s49, 0xa4000
    v_mfma_f32_16x16x32_bf16 v[12:15], v[24:27], v[152:155], v[12:15]
    v_and_b32_dpp v20, v74, v6 row_newbcast:0 row_mask:0xf bank_mask:0xf
    v_and_b32_dpp v21, v74, v7 row_newbcast:0 row_mask:0xf bank_mask:0xf
    v_and_b32_dpp v22, v74, v8 row_newbcast:0 row_mask:0xf bank_mask:0xf
    v_and_b32_dpp v23, v74, v9 row_newbcast:0 row_mask:0xf bank_mask:0xf
    s_waitcnt vmcnt(4)
    buffer_load_dwordx4 v[176:179], v1, s[12:15], s7 offen offset:0 nt
    s_xor_b32 s7, s49, 0xa5000
    v_mfma_f32_16x16x32_bf16 v[12:15], v[16:19], v[156:159], v[12:15]
    v_and_b32_dpp v24, v74, v6 row_newbcast:8 row_mask:0xf bank_mask:0xf
    v_and_b32_dpp v25, v74, v7 row_newbcast:8 row_mask:0xf bank_mask:0xf
    v_and_b32_dpp v26, v74, v8 row_newbcast:8 row_mask:0xf bank_mask:0xf
    v_and_b32_dpp v27, v74, v9 row_newbcast:8 row_mask:0xf bank_mask:0xf
    s_waitcnt vmcnt(4)
    buffer_load_dwordx4 v[180:183], v1, s[12:15], s7 offen offset:0 nt
    s_xor_b32 s7, s49, 0xa6000
    v_mfma_f32_16x16x32_bf16 v[12:15], v[20:23], v[160:163], v[12:15]
    v_and_b32_dpp v16, v74, v6 row_newbcast:4 row_mask:0xf bank_mask:0xf
    v_and_b32_dpp v17, v74, v7 row_newbcast:4 row_mask:0xf bank_mask:0xf
    v_and_b32_dpp v18, v74, v8 row_newbcast:4 row_mask:0xf bank_mask:0xf
    v_and_b32_dpp v19, v74, v9 row_newbcast:4 row_mask:0xf bank_mask:0xf
    s_waitcnt vmcnt(4)
    buffer_load_dwordx4 v[184:187], v1, s[12:15], s7 offen offset:0 nt
    s_xor_b32 s7, s49, 0xa7000
    v_mfma_f32_16x16x32_bf16 v[12:15], v[24:27], v[164:167], v[12:15]
    v_and_b32_dpp v20, v74, v6 row_newbcast:12 row_mask:0xf bank_mask:0xf
    v_and_b32_dpp v21, v74, v7 row_newbcast:12 row_mask:0xf bank_mask:0xf
    v_and_b32_dpp v22, v74, v8 row_newbcast:12 row_mask:0xf bank_mask:0xf
    v_and_b32_dpp v23, v74, v9 row_newbcast:12 row_mask:0xf bank_mask:0xf
    s_waitcnt vmcnt(4)
    buffer_load_dwordx4 v[188:191], v1, s[12:15], s7 offen offset:0 nt
    s_xor_b32 s7, s49, 0xa8000
    v_mfma_f32_16x16x32_bf16 v[12:15], v[16:19], v[168:171], v[12:15]
    v_and_b32_dpp v24, v74, v6 row_newbcast:2 row_mask:0xf bank_mask:0xf
    v_and_b32_dpp v25, v74, v7 row_newbcast:2 row_mask:0xf bank_mask:0xf
    v_and_b32_dpp v26, v74, v8 row_newbcast:2 row_mask:0xf bank_mask:0xf
    v_and_b32_dpp v27, v74, v9 row_newbcast:2 row_mask:0xf bank_mask:0xf
    s_waitcnt vmcnt(4)
    buffer_load_dwordx4 v[192:195], v1, s[12:15], s7 offen offset:0 nt
    s_xor_b32 s7, s49, 0xa9000
    v_mfma_f32_16x16x32_bf16 v[12:15], v[20:23], v[172:175], v[12:15]
    v_and_b32_dpp v16, v74, v6 row_newbcast:10 row_mask:0xf bank_mask:0xf
    v_and_b32_dpp v17, v74, v7 row_newbcast:10 row_mask:0xf bank_mask:0xf
    v_and_b32_dpp v18, v74, v8 row_newbcast:10 row_mask:0xf bank_mask:0xf
    v_and_b32_dpp v19, v74, v9 row_newbcast:10 row_mask:0xf bank_mask:0xf
    s_waitcnt vmcnt(4)
    buffer_load_dwordx4 v[196:199], v1, s[12:15], s7 offen offset:0 nt
    s_xor_b32 s7, s49, 0xaa000
    v_mfma_f32_16x16x32_bf16 v[12:15], v[24:27], v[176:179], v[12:15]
    v_and_b32_dpp v20, v74, v6 row_newbcast:6 row_mask:0xf bank_mask:0xf
    v_and_b32_dpp v21, v74, v7 row_newbcast:6 row_mask:0xf bank_mask:0xf
    v_and_b32_dpp v22, v74, v8 row_newbcast:6 row_mask:0xf bank_mask:0xf
    v_and_b32_dpp v23, v74, v9 row_newbcast:6 row_mask:0xf bank_mask:0xf
    s_waitcnt vmcnt(4)
    buffer_load_dwordx4 v[200:203], v1, s[12:15], s7 offen offset:0 nt
    s_xor_b32 s7, s49, 0xab000
    v_mfma_f32_16x16x32_bf16 v[12:15], v[16:19], v[180:183], v[12:15]
    v_and_b32_dpp v24, v74, v6 row_newbcast:14 row_mask:0xf bank_mask:0xf
    v_and_b32_dpp v25, v74, v7 row_newbcast:14 row_mask:0xf bank_mask:0xf
    v_and_b32_dpp v26, v74, v8 row_newbcast:14 row_mask:0xf bank_mask:0xf
    v_and_b32_dpp v27, v74, v9 row_newbcast:14 row_mask:0xf bank_mask:0xf
    s_waitcnt vmcnt(4)
    buffer_load_dwordx4 v[204:207], v1, s[12:15], s7 offen offset:0 nt
    s_xor_b32 s7, s49, 0xac000
    v_mfma_f32_16x16x32_bf16 v[12:15], v[20:23], v[184:187], v[12:15]
    v_and_b32_dpp v16, v74, v6 row_newbcast:1 row_mask:0xf bank_mask:0xf
    v_and_b32_dpp v17, v74, v7 row_newbcast:1 row_mask:0xf bank_mask:0xf
    v_and_b32_dpp v18, v74, v8 row_newbcast:1 row_mask:0xf bank_mask:0xf
    v_and_b32_dpp v19, v74, v9 row_newbcast:1 row_mask:0xf bank_mask:0xf
    s_waitcnt vmcnt(4)
    buffer_load_dwordx4 v[208:211], v1, s[12:15], s7 offen offset:0 nt
    s_xor_b32 s7, s49, 0xad000
    v_mfma_f32_16x16x32_bf16 v[12:15], v[24:27], v[188:191], v[12:15]
    v_and_b32_dpp v20, v74, v6 row_newbcast:9 row_mask:0xf bank_mask:0xf
    v_and_b32_dpp v21, v74, v7 row_newbcast:9 row_mask:0xf bank_mask:0xf
    v_and_b32_dpp v22, v74, v8 row_newbcast:9 row_mask:0xf bank_mask:0xf
    v_and_b32_dpp v23, v74, v9 row_newbcast:9 row_mask:0xf bank_mask:0xf
    s_waitcnt vmcnt(4)
    buffer_load_dwordx4 v[212:215], v1, s[12:15], s7 offen offset:0 nt
    s_xor_b32 s7, s49, 0xae000
    v_mfma_f32_16x16x32_bf16 v[12:15], v[16:19], v[192:195], v[12:15]
    v_and_b32_dpp v24, v74, v6 row_newbcast:5 row_mask:0xf bank_mask:0xf
    v_and_b32_dpp v25, v74, v7 row_newbcast:5 row_mask:0xf bank_mask:0xf
    v_and_b32_dpp v26, v74, v8 row_newbcast:5 row_mask:0xf bank_mask:0xf
    v_and_b32_dpp v27, v74, v9 row_newbcast:5 row_mask:0xf bank_mask:0xf
    s_waitcnt vmcnt(4)
    buffer_load_dwordx4 v[216:219], v1, s[12:15], s7 offen offset:0 nt
    s_xor_b32 s7, s49, 0xaf000
    v_mfma_f32_16x16x32_bf16 v[12:15], v[20:23], v[196:199], v[12:15]
    v_and_b32_dpp v16, v74, v6 row_newbcast:13 row_mask:0xf bank_mask:0xf
    v_and_b32_dpp v17, v74, v7 row_newbcast:13 row_mask:0xf bank_mask:0xf
    v_and_b32_dpp v18, v74, v8 row_newbcast:13 row_mask:0xf bank_mask:0xf
    v_and_b32_dpp v19, v74, v9 row_newbcast:13 row_mask:0xf bank_mask:0xf
    s_waitcnt vmcnt(4)
    buffer_load_dwordx4 v[220:223], v1, s[12:15], s7 offen offset:0 nt
    s_xor_b32 s7, s49, 0xb0000
    v_mfma_f32_16x16x32_bf16 v[12:15], v[24:27], v[200:203], v[12:15]
    v_and_b32_dpp v20, v74, v6 row_newbcast:3 row_mask:0xf bank_mask:0xf
    v_and_b32_dpp v21, v74, v7 row_newbcast:3 row_mask:0xf bank_mask:0xf
    v_and_b32_dpp v22, v74, v8 row_newbcast:3 row_mask:0xf bank_mask:0xf
    v_and_b32_dpp v23, v74, v9 row_newbcast:3 row_mask:0xf bank_mask:0xf
    s_waitcnt vmcnt(4)
    buffer_load_dwordx4 v[224:227], v1, s[12:15], s7 offen offset:0 nt
    s_xor_b32 s7, s49, 0xb1000
    v_mfma_f32_16x16x32_bf16 v[12:15], v[16:19], v[204:207], v[12:15]
    v_and_b32_dpp v24, v74, v6 row_newbcast:11 row_mask:0xf bank_mask:0xf
    v_and_b32_dpp v25, v74, v7 row_newbcast:11 row_mask:0xf bank_mask:0xf
    v_and_b32_dpp v26, v74, v8 row_newbcast:11 row_mask:0xf bank_mask:0xf
    v_and_b32_dpp v27, v74, v9 row_newbcast:11 row_mask:0xf bank_mask:0xf
    s_waitcnt vmcnt(4)
    buffer_load_dwordx4 v[228:231], v1, s[12:15], s7 offen offset:0 nt
    s_xor_b32 s7, s49, 0xb2000
    v_mfma_f32_16x16x32_bf16 v[12:15], v[20:23], v[208:211], v[12:15]
    v_and_b32_dpp v16, v74, v6 row_newbcast:7 row_mask:0xf bank_mask:0xf
    v_and_b32_dpp v17, v74, v7 row_newbcast:7 row_mask:0xf bank_mask:0xf
    v_and_b32_dpp v18, v74, v8 row_newbcast:7 row_mask:0xf bank_mask:0xf
    v_and_b32_dpp v19, v74, v9 row_newbcast:7 row_mask:0xf bank_mask:0xf
    s_waitcnt vmcnt(4)
    buffer_load_dwordx4 v[232:235], v1, s[12:15], s7 offen offset:0 nt
    s_xor_b32 s7, s49, 0xb3000
    v_mfma_f32_16x16x32_bf16 v[12:15], v[24:27], v[212:215], v[12:15]
    v_and_b32_dpp v20, v74, v6 row_newbcast:15 row_mask:0xf bank_mask:0xf
    v_and_b32_dpp v21, v74, v7 row_newbcast:15 row_mask:0xf bank_mask:0xf
    v_and_b32_dpp v22, v74, v8 row_newbcast:15 row_mask:0xf bank_mask:0xf
    v_and_b32_dpp v23, v74, v9 row_newbcast:15 row_mask:0xf bank_mask:0xf
    s_waitcnt vmcnt(4)
    buffer_load_dwordx4 v[236:239], v1, s[12:15], s7 offen offset:0 nt
    s_xor_b32 s7, s49, 0xb4000
    v_mfma_f32_16x16x32_bf16 v[12:15], v[16:19], v[216:219], v[12:15]
    v_and_b32_dpp v24, v75, v6 row_newbcast:0 row_mask:0xf bank_mask:0xf
    v_and_b32_dpp v25, v75, v7 row_newbcast:0 row_mask:0xf bank_mask:0xf
    v_and_b32_dpp v26, v75, v8 row_newbcast:0 row_mask:0xf bank_mask:0xf
    v_and_b32_dpp v27, v75, v9 row_newbcast:0 row_mask:0xf bank_mask:0xf
    s_waitcnt vmcnt(4)
    buffer_load_dwordx4 v[240:243], v1, s[12:15], s7 offen offset:0 nt
    s_xor_b32 s7, s49, 0xb5000
    v_mfma_f32_16x16x32_bf16 v[12:15], v[20:23], v[220:223], v[12:15]
    v_and_b32_dpp v16, v75, v6 row_newbcast:8 row_mask:0xf bank_mask:0xf
    v_and_b32_dpp v17, v75, v7 row_newbcast:8 row_mask:0xf bank_mask:0xf
    v_and_b32_dpp v18, v75, v8 row_newbcast:8 row_mask:0xf bank_mask:0xf
    v_and_b32_dpp v19, v75, v9 row_newbcast:8 row_mask:0xf bank_mask:0xf
    s_waitcnt vmcnt(4)
    buffer_load_dwordx4 v[244:247], v1, s[12:15], s7 offen offset:0 nt
    s_xor_b32 s7, s49, 0xb6000
    v_mfma_f32_16x16x32_bf16 v[12:15], v[24:27], v[224:227], v[12:15]
    v_and_b32_dpp v20, v75, v6 row_newbcast:4 row_mask:0xf bank_mask:0xf
    v_and_b32_dpp v21, v75, v7 row_newbcast:4 row_mask:0xf bank_mask:0xf
    v_and_b32_dpp v22, v75, v8 row_newbcast:4 row_mask:0xf bank_mask:0xf
    v_and_b32_dpp v23, v75, v9 row_newbcast:4 row_mask:0xf bank_mask:0xf
    s_waitcnt vmcnt(4)
    buffer_load_dwordx4 v[248:251], v1, s[12:15], s7 offen offset:0 nt
    s_xor_b32 s7, s49, 0xb7000
    v_mfma_f32_16x16x32_bf16 v[12:15], v[16:19], v[228:231], v[12:15]
    v_and_b32_dpp v24, v75, v6 row_newbcast:12 row_mask:0xf bank_mask:0xf
    v_and_b32_dpp v25, v75, v7 row_newbcast:12 row_mask:0xf bank_mask:0xf
    v_and_b32_dpp v26, v75, v8 row_newbcast:12 row_mask:0xf bank_mask:0xf
    v_and_b32_dpp v27, v75, v9 row_newbcast:12 row_mask:0xf bank_mask:0xf
    s_waitcnt vmcnt(4)
    buffer_load_dwordx4 v[252:255], v1, s[12:15], s7 offen offset:0 nt
    s_xor_b32 s7, s49, 0xb8000
    v_mfma_f32_16x16x32_bf16 v[12:15], v[20:23], v[232:235], v[12:15]
    v_and_b32_dpp v16, v75, v6 row_newbcast:2 row_mask:0xf bank_mask:0xf
    v_and_b32_dpp v17, v75, v7 row_newbcast:2 row_mask:0xf bank_mask:0xf
    v_and_b32_dpp v18, v75, v8 row_newbcast:2 row_mask:0xf bank_mask:0xf
    v_and_b32_dpp v19, v75, v9 row_newbcast:2 row_mask:0xf bank_mask:0xf
    s_waitcnt vmcnt(4)
    buffer_load_dwordx4 v[96:99], v1, s[12:15], s7 offen offset:0 nt
    s_xor_b32 s7, s49, 0xb9000
    v_mfma_f32_16x16x32_bf16 v[12:15], v[24:27], v[236:239], v[12:15]
    v_and_b32_dpp v20, v75, v6 row_newbcast:10 row_mask:0xf bank_mask:0xf
    v_and_b32_dpp v21, v75, v7 row_newbcast:10 row_mask:0xf bank_mask:0xf
    v_and_b32_dpp v22, v75, v8 row_newbcast:10 row_mask:0xf bank_mask:0xf
    v_and_b32_dpp v23, v75, v9 row_newbcast:10 row_mask:0xf bank_mask:0xf
    s_waitcnt vmcnt(4)
    buffer_load_dwordx4 v[100:103], v1, s[12:15], s7 offen offset:0 nt
    s_xor_b32 s7, s49, 0xba000
    v_mfma_f32_16x16x32_bf16 v[12:15], v[16:19], v[240:243], v[12:15]
    v_and_b32_dpp v24, v75, v6 row_newbcast:6 row_mask:0xf bank_mask:0xf
    v_and_b32_dpp v25, v75, v7 row_newbcast:6 row_mask:0xf bank_mask:0xf
    v_and_b32_dpp v26, v75, v8 row_newbcast:6 row_mask:0xf bank_mask:0xf
    v_and_b32_dpp v27, v75, v9 row_newbcast:6 row_mask:0xf bank_mask:0xf
    s_waitcnt vmcnt(4)
    buffer_load_dwordx4 v[104:107], v1, s[12:15], s7 offen offset:0 nt
    s_xor_b32 s7, s49, 0xbb000
    v_mfma_f32_16x16x32_bf16 v[12:15], v[20:23], v[244:247], v[12:15]
    v_and_b32_dpp v16, v75, v6 row_newbcast:14 row_mask:0xf bank_mask:0xf
    v_and_b32_dpp v17, v75, v7 row_newbcast:14 row_mask:0xf bank_mask:0xf
    v_and_b32_dpp v18, v75, v8 row_newbcast:14 row_mask:0xf bank_mask:0xf
    v_and_b32_dpp v19, v75, v9 row_newbcast:14 row_mask:0xf bank_mask:0xf
    s_waitcnt vmcnt(4)
    buffer_load_dwordx4 v[108:111], v1, s[12:15], s7 offen offset:0 nt
    s_xor_b32 s7, s49, 0xbc000
    v_mfma_f32_16x16x32_bf16 v[12:15], v[24:27], v[248:251], v[12:15]
    v_and_b32_dpp v20, v75, v6 row_newbcast:1 row_mask:0xf bank_mask:0xf
    v_and_b32_dpp v21, v75, v7 row_newbcast:1 row_mask:0xf bank_mask:0xf
    v_and_b32_dpp v22, v75, v8 row_newbcast:1 row_mask:0xf bank_mask:0xf
    v_and_b32_dpp v23, v75, v9 row_newbcast:1 row_mask:0xf bank_mask:0xf
    s_waitcnt vmcnt(4)
    buffer_load_dwordx4 v[112:115], v1, s[12:15], s7 offen offset:0 nt
    s_xor_b32 s7, s49, 0xbd000
    v_mfma_f32_16x16x32_bf16 v[12:15], v[16:19], v[252:255], v[12:15]
    v_and_b32_dpp v24, v75, v6 row_newbcast:9 row_mask:0xf bank_mask:0xf
    v_and_b32_dpp v25, v75, v7 row_newbcast:9 row_mask:0xf bank_mask:0xf
    v_and_b32_dpp v26, v75, v8 row_newbcast:9 row_mask:0xf bank_mask:0xf
    v_and_b32_dpp v27, v75, v9 row_newbcast:9 row_mask:0xf bank_mask:0xf
    s_waitcnt vmcnt(4)
    buffer_load_dwordx4 v[116:119], v1, s[12:15], s7 offen offset:0 nt
    s_xor_b32 s7, s49, 0xbe000
    v_mfma_f32_16x16x32_bf16 v[12:15], v[20:23], v[96:99], v[12:15]
    v_and_b32_dpp v16, v75, v6 row_newbcast:5 row_mask:0xf bank_mask:0xf
    v_and_b32_dpp v17, v75, v7 row_newbcast:5 row_mask:0xf bank_mask:0xf
    v_and_b32_dpp v18, v75, v8 row_newbcast:5 row_mask:0xf bank_mask:0xf
    v_and_b32_dpp v19, v75, v9 row_newbcast:5 row_mask:0xf bank_mask:0xf
    s_waitcnt vmcnt(4)
    buffer_load_dwordx4 v[120:123], v1, s[12:15], s7 offen offset:0 nt
    s_xor_b32 s7, s49, 0xbf000
    v_mfma_f32_16x16x32_bf16 v[12:15], v[24:27], v[100:103], v[12:15]
    v_and_b32_dpp v20, v75, v6 row_newbcast:13 row_mask:0xf bank_mask:0xf
    v_and_b32_dpp v21, v75, v7 row_newbcast:13 row_mask:0xf bank_mask:0xf
    v_and_b32_dpp v22, v75, v8 row_newbcast:13 row_mask:0xf bank_mask:0xf
    v_and_b32_dpp v23, v75, v9 row_newbcast:13 row_mask:0xf bank_mask:0xf
    s_waitcnt vmcnt(4)
    buffer_load_dwordx4 v[124:127], v1, s[12:15], s7 offen offset:0 nt
    s_xor_b32 s7, s49, 0xc0000
    v_mfma_f32_16x16x32_bf16 v[12:15], v[16:19], v[104:107], v[12:15]
    v_and_b32_dpp v24, v75, v6 row_newbcast:3 row_mask:0xf bank_mask:0xf
    v_and_b32_dpp v25, v75, v7 row_newbcast:3 row_mask:0xf bank_mask:0xf
    v_and_b32_dpp v26, v75, v8 row_newbcast:3 row_mask:0xf bank_mask:0xf
    v_and_b32_dpp v27, v75, v9 row_newbcast:3 row_mask:0xf bank_mask:0xf
    s_waitcnt vmcnt(4)
    buffer_load_dwordx4 v[128:131], v1, s[12:15], s7 offen offset:0 nt
    s_xor_b32 s7, s49, 0xc1000
    v_mfma_f32_16x16x32_bf16 v[12:15], v[20:23], v[108:111], v[12:15]
    v_and_b32_dpp v16, v75, v6 row_newbcast:11 row_mask:0xf bank_mask:0xf
    v_and_b32_dpp v17, v75, v7 row_newbcast:11 row_mask:0xf bank_mask:0xf
    v_and_b32_dpp v18, v75, v8 row_newbcast:11 row_mask:0xf bank_mask:0xf
    v_and_b32_dpp v19, v75, v9 row_newbcast:11 row_mask:0xf bank_mask:0xf
    s_waitcnt vmcnt(4)
    buffer_load_dwordx4 v[132:135], v1, s[12:15], s7 offen offset:0 nt
    s_xor_b32 s7, s49, 0xc2000
    v_mfma_f32_16x16x32_bf16 v[12:15], v[24:27], v[112:115], v[12:15]
    v_and_b32_dpp v20, v75, v6 row_newbcast:7 row_mask:0xf bank_mask:0xf
    v_and_b32_dpp v21, v75, v7 row_newbcast:7 row_mask:0xf bank_mask:0xf
    v_and_b32_dpp v22, v75, v8 row_newbcast:7 row_mask:0xf bank_mask:0xf
    v_and_b32_dpp v23, v75, v9 row_newbcast:7 row_mask:0xf bank_mask:0xf
    s_waitcnt vmcnt(4)
    buffer_load_dwordx4 v[136:139], v1, s[12:15], s7 offen offset:0 nt
    s_xor_b32 s7, s49, 0xc3000
    v_mfma_f32_16x16x32_bf16 v[12:15], v[16:19], v[116:119], v[12:15]
    v_and_b32_dpp v24, v75, v6 row_newbcast:15 row_mask:0xf bank_mask:0xf
    v_and_b32_dpp v25, v75, v7 row_newbcast:15 row_mask:0xf bank_mask:0xf
    v_and_b32_dpp v26, v75, v8 row_newbcast:15 row_mask:0xf bank_mask:0xf
    v_and_b32_dpp v27, v75, v9 row_newbcast:15 row_mask:0xf bank_mask:0xf
    s_waitcnt vmcnt(4)
    buffer_load_dwordx4 v[140:143], v1, s[12:15], s7 offen offset:0 nt
    s_xor_b32 s7, s49, 0xc4000
    v_mfma_f32_16x16x32_bf16 v[12:15], v[20:23], v[120:123], v[12:15]
    v_and_b32_dpp v16, v76, v6 row_newbcast:0 row_mask:0xf bank_mask:0xf
    v_and_b32_dpp v17, v76, v7 row_newbcast:0 row_mask:0xf bank_mask:0xf
    v_and_b32_dpp v18, v76, v8 row_newbcast:0 row_mask:0xf bank_mask:0xf
    v_and_b32_dpp v19, v76, v9 row_newbcast:0 row_mask:0xf bank_mask:0xf
    s_waitcnt vmcnt(4)
    buffer_load_dwordx4 v[144:147], v1, s[12:15], s7 offen offset:0 nt
    s_xor_b32 s7, s49, 0xc5000
    v_mfma_f32_16x16x32_bf16 v[12:15], v[24:27], v[124:127], v[12:15]
    v_and_b32_dpp v20, v76, v6 row_newbcast:8 row_mask:0xf bank_mask:0xf
    v_and_b32_dpp v21, v76, v7 row_newbcast:8 row_mask:0xf bank_mask:0xf
    v_and_b32_dpp v22, v76, v8 row_newbcast:8 row_mask:0xf bank_mask:0xf
    v_and_b32_dpp v23, v76, v9 row_newbcast:8 row_mask:0xf bank_mask:0xf
    s_waitcnt vmcnt(4)
    buffer_load_dwordx4 v[148:151], v1, s[12:15], s7 offen offset:0 nt
    s_xor_b32 s7, s49, 0xc6000
    v_mfma_f32_16x16x32_bf16 v[12:15], v[16:19], v[128:131], v[12:15]
    v_and_b32_dpp v24, v76, v6 row_newbcast:4 row_mask:0xf bank_mask:0xf
    v_and_b32_dpp v25, v76, v7 row_newbcast:4 row_mask:0xf bank_mask:0xf
    v_and_b32_dpp v26, v76, v8 row_newbcast:4 row_mask:0xf bank_mask:0xf
    v_and_b32_dpp v27, v76, v9 row_newbcast:4 row_mask:0xf bank_mask:0xf
    s_waitcnt vmcnt(4)
    buffer_load_dwordx4 v[152:155], v1, s[12:15], s7 offen offset:0 nt
    s_xor_b32 s7, s49, 0xc7000
    v_mfma_f32_16x16x32_bf16 v[12:15], v[20:23], v[132:135], v[12:15]
    v_and_b32_dpp v16, v76, v6 row_newbcast:12 row_mask:0xf bank_mask:0xf
    v_and_b32_dpp v17, v76, v7 row_newbcast:12 row_mask:0xf bank_mask:0xf
    v_and_b32_dpp v18, v76, v8 row_newbcast:12 row_mask:0xf bank_mask:0xf
    v_and_b32_dpp v19, v76, v9 row_newbcast:12 row_mask:0xf bank_mask:0xf
    s_waitcnt vmcnt(4)
    buffer_load_dwordx4 v[156:159], v1, s[12:15], s7 offen offset:0 nt
    s_xor_b32 s7, s49, 0xc8000
    v_mfma_f32_16x16x32_bf16 v[12:15], v[24:27], v[136:139], v[12:15]
    v_and_b32_dpp v20, v76, v6 row_newbcast:2 row_mask:0xf bank_mask:0xf
    v_and_b32_dpp v21, v76, v7 row_newbcast:2 row_mask:0xf bank_mask:0xf
    v_and_b32_dpp v22, v76, v8 row_newbcast:2 row_mask:0xf bank_mask:0xf
    v_and_b32_dpp v23, v76, v9 row_newbcast:2 row_mask:0xf bank_mask:0xf
    s_waitcnt vmcnt(4)
    buffer_load_dwordx4 v[160:163], v1, s[12:15], s7 offen offset:0 nt
    s_xor_b32 s7, s49, 0xc9000
    v_mfma_f32_16x16x32_bf16 v[12:15], v[16:19], v[140:143], v[12:15]
    v_and_b32_dpp v24, v76, v6 row_newbcast:10 row_mask:0xf bank_mask:0xf
    v_and_b32_dpp v25, v76, v7 row_newbcast:10 row_mask:0xf bank_mask:0xf
    v_and_b32_dpp v26, v76, v8 row_newbcast:10 row_mask:0xf bank_mask:0xf
    v_and_b32_dpp v27, v76, v9 row_newbcast:10 row_mask:0xf bank_mask:0xf
    s_waitcnt vmcnt(4)
    buffer_load_dwordx4 v[164:167], v1, s[12:15], s7 offen offset:0 nt
    s_xor_b32 s7, s49, 0xca000
    v_mfma_f32_16x16x32_bf16 v[12:15], v[20:23], v[144:147], v[12:15]
    v_and_b32_dpp v16, v76, v6 row_newbcast:6 row_mask:0xf bank_mask:0xf
    v_and_b32_dpp v17, v76, v7 row_newbcast:6 row_mask:0xf bank_mask:0xf
    v_and_b32_dpp v18, v76, v8 row_newbcast:6 row_mask:0xf bank_mask:0xf
    v_and_b32_dpp v19, v76, v9 row_newbcast:6 row_mask:0xf bank_mask:0xf
    s_waitcnt vmcnt(4)
    buffer_load_dwordx4 v[168:171], v1, s[12:15], s7 offen offset:0 nt
    s_xor_b32 s7, s49, 0xcb000
    v_mfma_f32_16x16x32_bf16 v[12:15], v[24:27], v[148:151], v[12:15]
    v_and_b32_dpp v20, v76, v6 row_newbcast:14 row_mask:0xf bank_mask:0xf
    v_and_b32_dpp v21, v76, v7 row_newbcast:14 row_mask:0xf bank_mask:0xf
    v_and_b32_dpp v22, v76, v8 row_newbcast:14 row_mask:0xf bank_mask:0xf
    v_and_b32_dpp v23, v76, v9 row_newbcast:14 row_mask:0xf bank_mask:0xf
    s_waitcnt vmcnt(4)
    buffer_load_dwordx4 v[172:175], v1, s[12:15], s7 offen offset:0 nt
    s_xor_b32 s7, s49, 0xcc000
    v_mfma_f32_16x16x32_bf16 v[12:15], v[16:19], v[152:155], v[12:15]
    v_and_b32_dpp v24, v76, v6 row_newbcast:1 row_mask:0xf bank_mask:0xf
    v_and_b32_dpp v25, v76, v7 row_newbcast:1 row_mask:0xf bank_mask:0xf
    v_and_b32_dpp v26, v76, v8 row_newbcast:1 row_mask:0xf bank_mask:0xf
    v_and_b32_dpp v27, v76, v9 row_newbcast:1 row_mask:0xf bank_mask:0xf
    s_waitcnt vmcnt(4)
    buffer_load_dwordx4 v[176:179], v1, s[12:15], s7 offen offset:0 nt
    s_xor_b32 s7, s49, 0xcd000
    v_mfma_f32_16x16x32_bf16 v[12:15], v[20:23], v[156:159], v[12:15]
    v_and_b32_dpp v16, v76, v6 row_newbcast:9 row_mask:0xf bank_mask:0xf
    v_and_b32_dpp v17, v76, v7 row_newbcast:9 row_mask:0xf bank_mask:0xf
    v_and_b32_dpp v18, v76, v8 row_newbcast:9 row_mask:0xf bank_mask:0xf
    v_and_b32_dpp v19, v76, v9 row_newbcast:9 row_mask:0xf bank_mask:0xf
    s_waitcnt vmcnt(4)
    buffer_load_dwordx4 v[180:183], v1, s[12:15], s7 offen offset:0 nt
    s_xor_b32 s7, s49, 0xce000
    v_mfma_f32_16x16x32_bf16 v[12:15], v[24:27], v[160:163], v[12:15]
    v_and_b32_dpp v20, v76, v6 row_newbcast:5 row_mask:0xf bank_mask:0xf
    v_and_b32_dpp v21, v76, v7 row_newbcast:5 row_mask:0xf bank_mask:0xf
    v_and_b32_dpp v22, v76, v8 row_newbcast:5 row_mask:0xf bank_mask:0xf
    v_and_b32_dpp v23, v76, v9 row_newbcast:5 row_mask:0xf bank_mask:0xf
    s_waitcnt vmcnt(4)
    buffer_load_dwordx4 v[184:187], v1, s[12:15], s7 offen offset:0 nt
    s_xor_b32 s7, s49, 0xcf000
    v_mfma_f32_16x16x32_bf16 v[12:15], v[16:19], v[164:167], v[12:15]
    v_and_b32_dpp v24, v76, v6 row_newbcast:13 row_mask:0xf bank_mask:0xf
    v_and_b32_dpp v25, v76, v7 row_newbcast:13 row_mask:0xf bank_mask:0xf
    v_and_b32_dpp v26, v76, v8 row_newbcast:13 row_mask:0xf bank_mask:0xf
    v_and_b32_dpp v27, v76, v9 row_newbcast:13 row_mask:0xf bank_mask:0xf
    s_waitcnt vmcnt(4)
    buffer_load_dwordx4 v[188:191], v1, s[12:15], s7 offen offset:0 nt
    s_xor_b32 s7, s49, 0xd0000
    v_mfma_f32_16x16x32_bf16 v[12:15], v[20:23], v[168:171], v[12:15]
    v_and_b32_dpp v16, v76, v6 row_newbcast:3 row_mask:0xf bank_mask:0xf
    v_and_b32_dpp v17, v76, v7 row_newbcast:3 row_mask:0xf bank_mask:0xf
    v_and_b32_dpp v18, v76, v8 row_newbcast:3 row_mask:0xf bank_mask:0xf
    v_and_b32_dpp v19, v76, v9 row_newbcast:3 row_mask:0xf bank_mask:0xf
    s_waitcnt vmcnt(4)
    buffer_load_dwordx4 v[192:195], v1, s[12:15], s7 offen offset:0 nt
    s_xor_b32 s7, s49, 0xd1000
    v_mfma_f32_16x16x32_bf16 v[12:15], v[24:27], v[172:175], v[12:15]
    v_and_b32_dpp v20, v76, v6 row_newbcast:11 row_mask:0xf bank_mask:0xf
    v_and_b32_dpp v21, v76, v7 row_newbcast:11 row_mask:0xf bank_mask:0xf
    v_and_b32_dpp v22, v76, v8 row_newbcast:11 row_mask:0xf bank_mask:0xf
    v_and_b32_dpp v23, v76, v9 row_newbcast:11 row_mask:0xf bank_mask:0xf
    s_waitcnt vmcnt(4)
    buffer_load_dwordx4 v[196:199], v1, s[12:15], s7 offen offset:0 nt
    s_xor_b32 s7, s49, 0xd2000
    v_mfma_f32_16x16x32_bf16 v[12:15], v[16:19], v[176:179], v[12:15]
    v_and_b32_dpp v24, v76, v6 row_newbcast:7 row_mask:0xf bank_mask:0xf
    v_and_b32_dpp v25, v76, v7 row_newbcast:7 row_mask:0xf bank_mask:0xf
    v_and_b32_dpp v26, v76, v8 row_newbcast:7 row_mask:0xf bank_mask:0xf
    v_and_b32_dpp v27, v76, v9 row_newbcast:7 row_mask:0xf bank_mask:0xf
    s_waitcnt vmcnt(4)
    buffer_load_dwordx4 v[200:203], v1, s[12:15], s7 offen offset:0 nt
    s_xor_b32 s7, s49, 0xd3000
    v_mfma_f32_16x16x32_bf16 v[12:15], v[20:23], v[180:183], v[12:15]
    v_and_b32_dpp v16, v76, v6 row_newbcast:15 row_mask:0xf bank_mask:0xf
    v_and_b32_dpp v17, v76, v7 row_newbcast:15 row_mask:0xf bank_mask:0xf
    v_and_b32_dpp v18, v76, v8 row_newbcast:15 row_mask:0xf bank_mask:0xf
    v_and_b32_dpp v19, v76, v9 row_newbcast:15 row_mask:0xf bank_mask:0xf
    s_waitcnt vmcnt(4)
    buffer_load_dwordx4 v[204:207], v1, s[12:15], s7 offen offset:0 nt
    s_xor_b32 s7, s49, 0xd4000
    v_mfma_f32_16x16x32_bf16 v[12:15], v[24:27], v[184:187], v[12:15]
    v_and_b32_dpp v20, v77, v6 row_newbcast:0 row_mask:0xf bank_mask:0xf
    v_and_b32_dpp v21, v77, v7 row_newbcast:0 row_mask:0xf bank_mask:0xf
    v_and_b32_dpp v22, v77, v8 row_newbcast:0 row_mask:0xf bank_mask:0xf
    v_and_b32_dpp v23, v77, v9 row_newbcast:0 row_mask:0xf bank_mask:0xf
    s_waitcnt vmcnt(4)
    buffer_load_dwordx4 v[208:211], v1, s[12:15], s7 offen offset:0 nt
    s_xor_b32 s7, s49, 0xd5000
    v_mfma_f32_16x16x32_bf16 v[12:15], v[16:19], v[188:191], v[12:15]
    v_and_b32_dpp v24, v77, v6 row_newbcast:8 row_mask:0xf bank_mask:0xf
    v_and_b32_dpp v25, v77, v7 row_newbcast:8 row_mask:0xf bank_mask:0xf
    v_and_b32_dpp v26, v77, v8 row_newbcast:8 row_mask:0xf bank_mask:0xf
    v_and_b32_dpp v27, v77, v9 row_newbcast:8 row_mask:0xf bank_mask:0xf
    s_waitcnt vmcnt(4)
    buffer_load_dwordx4 v[212:215], v1, s[12:15], s7 offen offset:0 nt
    s_xor_b32 s7, s49, 0xd6000
    v_mfma_f32_16x16x32_bf16 v[12:15], v[20:23], v[192:195], v[12:15]
    v_and_b32_dpp v16, v77, v6 row_newbcast:4 row_mask:0xf bank_mask:0xf
    v_and_b32_dpp v17, v77, v7 row_newbcast:4 row_mask:0xf bank_mask:0xf
    v_and_b32_dpp v18, v77, v8 row_newbcast:4 row_mask:0xf bank_mask:0xf
    v_and_b32_dpp v19, v77, v9 row_newbcast:4 row_mask:0xf bank_mask:0xf
    s_waitcnt vmcnt(4)
    buffer_load_dwordx4 v[216:219], v1, s[12:15], s7 offen offset:0 nt
    s_xor_b32 s7, s49, 0xd7000
    v_mfma_f32_16x16x32_bf16 v[12:15], v[24:27], v[196:199], v[12:15]
    v_and_b32_dpp v20, v77, v6 row_newbcast:12 row_mask:0xf bank_mask:0xf
    v_and_b32_dpp v21, v77, v7 row_newbcast:12 row_mask:0xf bank_mask:0xf
    v_and_b32_dpp v22, v77, v8 row_newbcast:12 row_mask:0xf bank_mask:0xf
    v_and_b32_dpp v23, v77, v9 row_newbcast:12 row_mask:0xf bank_mask:0xf
    s_waitcnt vmcnt(4)
    buffer_load_dwordx4 v[220:223], v1, s[12:15], s7 offen offset:0 nt
    s_xor_b32 s7, s49, 0xd8000
    v_mfma_f32_16x16x32_bf16 v[12:15], v[16:19], v[200:203], v[12:15]
    v_and_b32_dpp v24, v77, v6 row_newbcast:2 row_mask:0xf bank_mask:0xf
    v_and_b32_dpp v25, v77, v7 row_newbcast:2 row_mask:0xf bank_mask:0xf
    v_and_b32_dpp v26, v77, v8 row_newbcast:2 row_mask:0xf bank_mask:0xf
    v_and_b32_dpp v27, v77, v9 row_newbcast:2 row_mask:0xf bank_mask:0xf
    s_waitcnt vmcnt(4)
    buffer_load_dwordx4 v[224:227], v1, s[12:15], s7 offen offset:0 nt
    s_xor_b32 s7, s49, 0xd9000
    v_mfma_f32_16x16x32_bf16 v[12:15], v[20:23], v[204:207], v[12:15]
    v_and_b32_dpp v16, v77, v6 row_newbcast:10 row_mask:0xf bank_mask:0xf
    v_and_b32_dpp v17, v77, v7 row_newbcast:10 row_mask:0xf bank_mask:0xf
    v_and_b32_dpp v18, v77, v8 row_newbcast:10 row_mask:0xf bank_mask:0xf
    v_and_b32_dpp v19, v77, v9 row_newbcast:10 row_mask:0xf bank_mask:0xf
    s_waitcnt vmcnt(4)
    buffer_load_dwordx4 v[228:231], v1, s[12:15], s7 offen offset:0 nt
    s_xor_b32 s7, s49, 0xda000
    v_mfma_f32_16x16x32_bf16 v[12:15], v[24:27], v[208:211], v[12:15]
    v_and_b32_dpp v20, v77, v6 row_newbcast:6 row_mask:0xf bank_mask:0xf
    v_and_b32_dpp v21, v77, v7 row_newbcast:6 row_mask:0xf bank_mask:0xf
    v_and_b32_dpp v22, v77, v8 row_newbcast:6 row_mask:0xf bank_mask:0xf
    v_and_b32_dpp v23, v77, v9 row_newbcast:6 row_mask:0xf bank_mask:0xf
    s_waitcnt vmcnt(4)
    buffer_load_dwordx4 v[232:235], v1, s[12:15], s7 offen offset:0 nt
    s_xor_b32 s7, s49, 0xdb000
    v_mfma_f32_16x16x32_bf16 v[12:15], v[16:19], v[212:215], v[12:15]
    v_and_b32_dpp v24, v77, v6 row_newbcast:14 row_mask:0xf bank_mask:0xf
    v_and_b32_dpp v25, v77, v7 row_newbcast:14 row_mask:0xf bank_mask:0xf
    v_and_b32_dpp v26, v77, v8 row_newbcast:14 row_mask:0xf bank_mask:0xf
    v_and_b32_dpp v27, v77, v9 row_newbcast:14 row_mask:0xf bank_mask:0xf
    s_waitcnt vmcnt(4)
    buffer_load_dwordx4 v[236:239], v1, s[12:15], s7 offen offset:0 nt
    s_xor_b32 s7, s49, 0xdc000
    v_mfma_f32_16x16x32_bf16 v[12:15], v[20:23], v[216:219], v[12:15]
    v_and_b32_dpp v16, v77, v6 row_newbcast:1 row_mask:0xf bank_mask:0xf
    v_and_b32_dpp v17, v77, v7 row_newbcast:1 row_mask:0xf bank_mask:0xf
    v_and_b32_dpp v18, v77, v8 row_newbcast:1 row_mask:0xf bank_mask:0xf
    v_and_b32_dpp v19, v77, v9 row_newbcast:1 row_mask:0xf bank_mask:0xf
    s_waitcnt vmcnt(4)
    buffer_load_dwordx4 v[240:243], v1, s[12:15], s7 offen offset:0 nt
    s_xor_b32 s7, s49, 0xdd000
    v_mfma_f32_16x16x32_bf16 v[12:15], v[24:27], v[220:223], v[12:15]
    v_and_b32_dpp v20, v77, v6 row_newbcast:9 row_mask:0xf bank_mask:0xf
    v_and_b32_dpp v21, v77, v7 row_newbcast:9 row_mask:0xf bank_mask:0xf
    v_and_b32_dpp v22, v77, v8 row_newbcast:9 row_mask:0xf bank_mask:0xf
    v_and_b32_dpp v23, v77, v9 row_newbcast:9 row_mask:0xf bank_mask:0xf
    s_waitcnt vmcnt(4)
    buffer_load_dwordx4 v[244:247], v1, s[12:15], s7 offen offset:0 nt
    s_xor_b32 s7, s49, 0xde000
    v_mfma_f32_16x16x32_bf16 v[12:15], v[16:19], v[224:227], v[12:15]
    v_and_b32_dpp v24, v77, v6 row_newbcast:5 row_mask:0xf bank_mask:0xf
    v_and_b32_dpp v25, v77, v7 row_newbcast:5 row_mask:0xf bank_mask:0xf
    v_and_b32_dpp v26, v77, v8 row_newbcast:5 row_mask:0xf bank_mask:0xf
    v_and_b32_dpp v27, v77, v9 row_newbcast:5 row_mask:0xf bank_mask:0xf
    s_waitcnt vmcnt(4)
    buffer_load_dwordx4 v[248:251], v1, s[12:15], s7 offen offset:0 nt
    s_xor_b32 s7, s49, 0xdf000
    v_mfma_f32_16x16x32_bf16 v[12:15], v[20:23], v[228:231], v[12:15]
    v_and_b32_dpp v16, v77, v6 row_newbcast:13 row_mask:0xf bank_mask:0xf
    v_and_b32_dpp v17, v77, v7 row_newbcast:13 row_mask:0xf bank_mask:0xf
    v_and_b32_dpp v18, v77, v8 row_newbcast:13 row_mask:0xf bank_mask:0xf
    v_and_b32_dpp v19, v77, v9 row_newbcast:13 row_mask:0xf bank_mask:0xf
    s_waitcnt vmcnt(4)
    buffer_load_dwordx4 v[252:255], v1, s[12:15], s7 offen offset:0 nt
    s_xor_b32 s7, s49, 0xe0000
    v_mfma_f32_16x16x32_bf16 v[12:15], v[24:27], v[232:235], v[12:15]
    v_and_b32_dpp v20, v77, v6 row_newbcast:3 row_mask:0xf bank_mask:0xf
    v_and_b32_dpp v21, v77, v7 row_newbcast:3 row_mask:0xf bank_mask:0xf
    v_and_b32_dpp v22, v77, v8 row_newbcast:3 row_mask:0xf bank_mask:0xf
    v_and_b32_dpp v23, v77, v9 row_newbcast:3 row_mask:0xf bank_mask:0xf
    s_waitcnt vmcnt(4)
    buffer_load_dwordx4 v[96:99], v1, s[12:15], s7 offen offset:0 nt
    s_xor_b32 s7, s49, 0xe1000
    v_mfma_f32_16x16x32_bf16 v[12:15], v[16:19], v[236:239], v[12:15]
    v_and_b32_dpp v24, v77, v6 row_newbcast:11 row_mask:0xf bank_mask:0xf
    v_and_b32_dpp v25, v77, v7 row_newbcast:11 row_mask:0xf bank_mask:0xf
    v_and_b32_dpp v26, v77, v8 row_newbcast:11 row_mask:0xf bank_mask:0xf
    v_and_b32_dpp v27, v77, v9 row_newbcast:11 row_mask:0xf bank_mask:0xf
    s_waitcnt vmcnt(4)
    buffer_load_dwordx4 v[100:103], v1, s[12:15], s7 offen offset:0 nt
    s_xor_b32 s7, s49, 0xe2000
    v_mfma_f32_16x16x32_bf16 v[12:15], v[20:23], v[240:243], v[12:15]
    v_and_b32_dpp v16, v77, v6 row_newbcast:7 row_mask:0xf bank_mask:0xf
    v_and_b32_dpp v17, v77, v7 row_newbcast:7 row_mask:0xf bank_mask:0xf
    v_and_b32_dpp v18, v77, v8 row_newbcast:7 row_mask:0xf bank_mask:0xf
    v_and_b32_dpp v19, v77, v9 row_newbcast:7 row_mask:0xf bank_mask:0xf
    s_waitcnt vmcnt(4)
    buffer_load_dwordx4 v[104:107], v1, s[12:15], s7 offen offset:0 nt
    s_xor_b32 s7, s49, 0xe3000
    v_mfma_f32_16x16x32_bf16 v[12:15], v[24:27], v[244:247], v[12:15]
    v_and_b32_dpp v20, v77, v6 row_newbcast:15 row_mask:0xf bank_mask:0xf
    v_and_b32_dpp v21, v77, v7 row_newbcast:15 row_mask:0xf bank_mask:0xf
    v_and_b32_dpp v22, v77, v8 row_newbcast:15 row_mask:0xf bank_mask:0xf
    v_and_b32_dpp v23, v77, v9 row_newbcast:15 row_mask:0xf bank_mask:0xf
    s_waitcnt vmcnt(4)
    buffer_load_dwordx4 v[108:111], v1, s[12:15], s7 offen offset:0 nt
    s_xor_b32 s7, s49, 0xe4000
    v_mfma_f32_16x16x32_bf16 v[12:15], v[16:19], v[248:251], v[12:15]
    v_and_b32_dpp v24, v78, v6 row_newbcast:0 row_mask:0xf bank_mask:0xf
    v_and_b32_dpp v25, v78, v7 row_newbcast:0 row_mask:0xf bank_mask:0xf
    v_and_b32_dpp v26, v78, v8 row_newbcast:0 row_mask:0xf bank_mask:0xf
    v_and_b32_dpp v27, v78, v9 row_newbcast:0 row_mask:0xf bank_mask:0xf
    s_waitcnt vmcnt(4)
    buffer_load_dwordx4 v[112:115], v1, s[12:15], s7 offen offset:0 nt
    s_xor_b32 s7, s49, 0xe5000
    v_mfma_f32_16x16x32_bf16 v[12:15], v[20:23], v[252:255], v[12:15]
    v_and_b32_dpp v16, v78, v6 row_newbcast:8 row_mask:0xf bank_mask:0xf
    v_and_b32_dpp v17, v78, v7 row_newbcast:8 row_mask:0xf bank_mask:0xf
    v_and_b32_dpp v18, v78, v8 row_newbcast:8 row_mask:0xf bank_mask:0xf
    v_and_b32_dpp v19, v78, v9 row_newbcast:8 row_mask:0xf bank_mask:0xf
    s_waitcnt vmcnt(4)
    buffer_load_dwordx4 v[116:119], v1, s[12:15], s7 offen offset:0 nt
    s_xor_b32 s7, s49, 0xe6000
    v_mfma_f32_16x16x32_bf16 v[12:15], v[24:27], v[96:99], v[12:15]
    v_and_b32_dpp v20, v78, v6 row_newbcast:4 row_mask:0xf bank_mask:0xf
    v_and_b32_dpp v21, v78, v7 row_newbcast:4 row_mask:0xf bank_mask:0xf
    v_and_b32_dpp v22, v78, v8 row_newbcast:4 row_mask:0xf bank_mask:0xf
    v_and_b32_dpp v23, v78, v9 row_newbcast:4 row_mask:0xf bank_mask:0xf
    s_waitcnt vmcnt(4)
    buffer_load_dwordx4 v[120:123], v1, s[12:15], s7 offen offset:0 nt
    s_xor_b32 s7, s49, 0xe7000
    v_mfma_f32_16x16x32_bf16 v[12:15], v[16:19], v[100:103], v[12:15]
    v_and_b32_dpp v24, v78, v6 row_newbcast:12 row_mask:0xf bank_mask:0xf
    v_and_b32_dpp v25, v78, v7 row_newbcast:12 row_mask:0xf bank_mask:0xf
    v_and_b32_dpp v26, v78, v8 row_newbcast:12 row_mask:0xf bank_mask:0xf
    v_and_b32_dpp v27, v78, v9 row_newbcast:12 row_mask:0xf bank_mask:0xf
    s_waitcnt vmcnt(4)
    buffer_load_dwordx4 v[124:127], v1, s[12:15], s7 offen offset:0 nt
    s_xor_b32 s7, s49, 0xe8000
    v_mfma_f32_16x16x32_bf16 v[12:15], v[20:23], v[104:107], v[12:15]
    v_and_b32_dpp v16, v78, v6 row_newbcast:2 row_mask:0xf bank_mask:0xf
    v_and_b32_dpp v17, v78, v7 row_newbcast:2 row_mask:0xf bank_mask:0xf
    v_and_b32_dpp v18, v78, v8 row_newbcast:2 row_mask:0xf bank_mask:0xf
    v_and_b32_dpp v19, v78, v9 row_newbcast:2 row_mask:0xf bank_mask:0xf
    buffer_load_dwordx4 v[128:131], v1, s[12:15], s7 offen offset:0 nt
    s_xor_b32 s7, s49, 0xe9000
    buffer_load_dwordx4 v[132:135], v1, s[12:15], s7 offen offset:0 nt
    s_xor_b32 s7, s49, 0xea000
    buffer_load_dwordx4 v[136:139], v1, s[12:15], s7 offen offset:0 nt
    s_xor_b32 s7, s49, 0xeb000
    buffer_load_dwordx4 v[140:143], v1, s[12:15], s7 offen offset:0 nt
    s_xor_b32 s7, s49, 0xec000
    buffer_load_dwordx4 v[144:147], v1, s[12:15], s7 offen offset:0 nt
    s_xor_b32 s7, s49, 0xed000
    buffer_load_dwordx4 v[148:151], v1, s[12:15], s7 offen offset:0 nt
    s_xor_b32 s7, s49, 0xee000
    buffer_load_dwordx4 v[152:155], v1, s[12:15], s7 offen offset:0 nt
    s_xor_b32 s7, s49, 0xef000
    buffer_load_dwordx4 v[156:159], v1, s[12:15], s7 offen offset:0 nt
    s_xor_b32 s7, s49, 0xf0000
    buffer_load_dwordx4 v[160:163], v1, s[12:15], s7 offen offset:0 nt
    s_xor_b32 s7, s49, 0xf1000
    buffer_load_dwordx4 v[164:167], v1, s[12:15], s7 offen offset:0 nt
    s_xor_b32 s7, s49, 0xf2000
    buffer_load_dwordx4 v[168:171], v1, s[12:15], s7 offen offset:0 nt
    s_xor_b32 s7, s49, 0xf3000
    buffer_load_dwordx4 v[172:175], v1, s[12:15], s7 offen offset:0 nt
    s_xor_b32 s7, s49, 0xf4000
    buffer_load_dwordx4 v[176:179], v1, s[12:15], s7 offen offset:0 nt
    s_xor_b32 s7, s49, 0xf5000
    buffer_load_dwordx4 v[180:183], v1, s[12:15], s7 offen offset:0 nt
    s_xor_b32 s7, s49, 0xf6000
    buffer_load_dwordx4 v[184:187], v1, s[12:15], s7 offen offset:0 nt
    s_xor_b32 s7, s49, 0xf7000
    buffer_load_dwordx4 v[188:191], v1, s[12:15], s7 offen offset:0 nt
    s_xor_b32 s7, s49, 0xf8000
    buffer_load_dwordx4 v[192:195], v1, s[12:15], s7 offen offset:0 nt
    s_xor_b32 s7, s49, 0xf9000
    buffer_load_dwordx4 v[196:199], v1, s[12:15], s7 offen offset:0 nt
    s_xor_b32 s7, s49, 0xfa000
    buffer_load_dwordx4 v[200:203], v1, s[12:15], s7 offen offset:0 nt
    s_xor_b32 s7, s49, 0xfb000
    s_waitcnt vmcnt(23)
    buffer_load_dwordx4 v[204:207], v1, s[12:15], s7 offen offset:0 nt
    s_xor_b32 s7, s49, 0xfc000
    v_mfma_f32_16x16x32_bf16 v[12:15], v[24:27], v[108:111], v[12:15]
    v_and_b32_dpp v20, v78, v6 row_newbcast:10 row_mask:0xf bank_mask:0xf
    v_and_b32_dpp v21, v78, v7 row_newbcast:10 row_mask:0xf bank_mask:0xf
    v_and_b32_dpp v22, v78, v8 row_newbcast:10 row_mask:0xf bank_mask:0xf
    v_and_b32_dpp v23, v78, v9 row_newbcast:10 row_mask:0xf bank_mask:0xf
    s_waitcnt vmcnt(23)
    buffer_load_dwordx4 v[208:211], v1, s[12:15], s7 offen offset:0 nt
    s_xor_b32 s7, s49, 0xfd000
    v_mfma_f32_16x16x32_bf16 v[12:15], v[16:19], v[112:115], v[12:15]
    v_and_b32_dpp v24, v78, v6 row_newbcast:6 row_mask:0xf bank_mask:0xf
    v_and_b32_dpp v25, v78, v7 row_newbcast:6 row_mask:0xf bank_mask:0xf
    v_and_b32_dpp v26, v78, v8 row_newbcast:6 row_mask:0xf bank_mask:0xf
    v_and_b32_dpp v27, v78, v9 row_newbcast:6 row_mask:0xf bank_mask:0xf
    s_waitcnt vmcnt(23)
    buffer_load_dwordx4 v[212:215], v1, s[12:15], s7 offen offset:0 nt
    s_xor_b32 s7, s49, 0xfe000
    v_mfma_f32_16x16x32_bf16 v[12:15], v[20:23], v[116:119], v[12:15]
    v_and_b32_dpp v16, v78, v6 row_newbcast:14 row_mask:0xf bank_mask:0xf
    v_and_b32_dpp v17, v78, v7 row_newbcast:14 row_mask:0xf bank_mask:0xf
    v_and_b32_dpp v18, v78, v8 row_newbcast:14 row_mask:0xf bank_mask:0xf
    v_and_b32_dpp v19, v78, v9 row_newbcast:14 row_mask:0xf bank_mask:0xf
    s_waitcnt vmcnt(23)
    buffer_load_dwordx4 v[216:219], v1, s[12:15], s7 offen offset:0 nt
    s_xor_b32 s7, s49, 0xff000
    v_mfma_f32_16x16x32_bf16 v[12:15], v[24:27], v[120:123], v[12:15]
    v_and_b32_dpp v20, v78, v6 row_newbcast:1 row_mask:0xf bank_mask:0xf
    v_and_b32_dpp v21, v78, v7 row_newbcast:1 row_mask:0xf bank_mask:0xf
    v_and_b32_dpp v22, v78, v8 row_newbcast:1 row_mask:0xf bank_mask:0xf
    v_and_b32_dpp v23, v78, v9 row_newbcast:1 row_mask:0xf bank_mask:0xf
    s_waitcnt vmcnt(23)
    buffer_load_dwordx4 v[220:223], v1, s[12:15], s7 offen offset:0 nt
    v_mfma_f32_16x16x32_bf16 v[12:15], v[16:19], v[124:127], v[12:15]
    v_and_b32_dpp v24, v78, v6 row_newbcast:9 row_mask:0xf bank_mask:0xf
    v_and_b32_dpp v25, v78, v7 row_newbcast:9 row_mask:0xf bank_mask:0xf
    v_and_b32_dpp v26, v78, v8 row_newbcast:9 row_mask:0xf bank_mask:0xf
    v_and_b32_dpp v27, v78, v9 row_newbcast:9 row_mask:0xf bank_mask:0xf
    s_waitcnt vmcnt(23)
    v_mfma_f32_16x16x32_bf16 v[12:15], v[20:23], v[128:131], v[12:15]
    v_and_b32_dpp v16, v78, v6 row_newbcast:5 row_mask:0xf bank_mask:0xf
    v_and_b32_dpp v17, v78, v7 row_newbcast:5 row_mask:0xf bank_mask:0xf
    v_and_b32_dpp v18, v78, v8 row_newbcast:5 row_mask:0xf bank_mask:0xf
    v_and_b32_dpp v19, v78, v9 row_newbcast:5 row_mask:0xf bank_mask:0xf
    s_waitcnt vmcnt(22)
    v_mfma_f32_16x16x32_bf16 v[12:15], v[24:27], v[132:135], v[12:15]
    v_and_b32_dpp v20, v78, v6 row_newbcast:13 row_mask:0xf bank_mask:0xf
    v_and_b32_dpp v21, v78, v7 row_newbcast:13 row_mask:0xf bank_mask:0xf
    v_and_b32_dpp v22, v78, v8 row_newbcast:13 row_mask:0xf bank_mask:0xf
    v_and_b32_dpp v23, v78, v9 row_newbcast:13 row_mask:0xf bank_mask:0xf
    s_waitcnt vmcnt(21)
    v_mfma_f32_16x16x32_bf16 v[12:15], v[16:19], v[136:139], v[12:15]
    v_and_b32_dpp v24, v78, v6 row_newbcast:3 row_mask:0xf bank_mask:0xf
    v_and_b32_dpp v25, v78, v7 row_newbcast:3 row_mask:0xf bank_mask:0xf
    v_and_b32_dpp v26, v78, v8 row_newbcast:3 row_mask:0xf bank_mask:0xf
    v_and_b32_dpp v27, v78, v9 row_newbcast:3 row_mask:0xf bank_mask:0xf
    s_waitcnt vmcnt(20)
    v_mfma_f32_16x16x32_bf16 v[12:15], v[20:23], v[140:143], v[12:15]
    v_and_b32_dpp v16, v78, v6 row_newbcast:11 row_mask:0xf bank_mask:0xf
    v_and_b32_dpp v17, v78, v7 row_newbcast:11 row_mask:0xf bank_mask:0xf
    v_and_b32_dpp v18, v78, v8 row_newbcast:11 row_mask:0xf bank_mask:0xf
    v_and_b32_dpp v19, v78, v9 row_newbcast:11 row_mask:0xf bank_mask:0xf
    s_waitcnt vmcnt(19)
    v_mfma_f32_16x16x32_bf16 v[12:15], v[24:27], v[144:147], v[12:15]
    v_and_b32_dpp v20, v78, v6 row_newbcast:7 row_mask:0xf bank_mask:0xf
    v_and_b32_dpp v21, v78, v7 row_newbcast:7 row_mask:0xf bank_mask:0xf
    v_and_b32_dpp v22, v78, v8 row_newbcast:7 row_mask:0xf bank_mask:0xf
    v_and_b32_dpp v23, v78, v9 row_newbcast:7 row_mask:0xf bank_mask:0xf
    s_waitcnt vmcnt(18)
    v_mfma_f32_16x16x32_bf16 v[12:15], v[16:19], v[148:151], v[12:15]
    v_and_b32_dpp v24, v78, v6 row_newbcast:15 row_mask:0xf bank_mask:0xf
    v_and_b32_dpp v25, v78, v7 row_newbcast:15 row_mask:0xf bank_mask:0xf
    v_and_b32_dpp v26, v78, v8 row_newbcast:15 row_mask:0xf bank_mask:0xf
    v_and_b32_dpp v27, v78, v9 row_newbcast:15 row_mask:0xf bank_mask:0xf
    s_waitcnt vmcnt(17)
    v_mfma_f32_16x16x32_bf16 v[12:15], v[20:23], v[152:155], v[12:15]
    v_and_b32_dpp v16, v79, v6 row_newbcast:0 row_mask:0xf bank_mask:0xf
    v_and_b32_dpp v17, v79, v7 row_newbcast:0 row_mask:0xf bank_mask:0xf
    v_and_b32_dpp v18, v79, v8 row_newbcast:0 row_mask:0xf bank_mask:0xf
    v_and_b32_dpp v19, v79, v9 row_newbcast:0 row_mask:0xf bank_mask:0xf
    s_waitcnt vmcnt(16)
    v_mfma_f32_16x16x32_bf16 v[12:15], v[24:27], v[156:159], v[12:15]
    v_and_b32_dpp v20, v79, v6 row_newbcast:8 row_mask:0xf bank_mask:0xf
    v_and_b32_dpp v21, v79, v7 row_newbcast:8 row_mask:0xf bank_mask:0xf
    v_and_b32_dpp v22, v79, v8 row_newbcast:8 row_mask:0xf bank_mask:0xf
    v_and_b32_dpp v23, v79, v9 row_newbcast:8 row_mask:0xf bank_mask:0xf
    s_waitcnt vmcnt(15)
    v_mfma_f32_16x16x32_bf16 v[12:15], v[16:19], v[160:163], v[12:15]
    v_and_b32_dpp v24, v79, v6 row_newbcast:4 row_mask:0xf bank_mask:0xf
    v_and_b32_dpp v25, v79, v7 row_newbcast:4 row_mask:0xf bank_mask:0xf
    v_and_b32_dpp v26, v79, v8 row_newbcast:4 row_mask:0xf bank_mask:0xf
    v_and_b32_dpp v27, v79, v9 row_newbcast:4 row_mask:0xf bank_mask:0xf
    s_waitcnt vmcnt(14)
    v_mfma_f32_16x16x32_bf16 v[12:15], v[20:23], v[164:167], v[12:15]
    v_and_b32_dpp v16, v79, v6 row_newbcast:12 row_mask:0xf bank_mask:0xf
    v_and_b32_dpp v17, v79, v7 row_newbcast:12 row_mask:0xf bank_mask:0xf
    v_and_b32_dpp v18, v79, v8 row_newbcast:12 row_mask:0xf bank_mask:0xf
    v_and_b32_dpp v19, v79, v9 row_newbcast:12 row_mask:0xf bank_mask:0xf
    s_waitcnt vmcnt(13)
    v_mfma_f32_16x16x32_bf16 v[12:15], v[24:27], v[168:171], v[12:15]
    v_and_b32_dpp v20, v79, v6 row_newbcast:2 row_mask:0xf bank_mask:0xf
    v_and_b32_dpp v21, v79, v7 row_newbcast:2 row_mask:0xf bank_mask:0xf
    v_and_b32_dpp v22, v79, v8 row_newbcast:2 row_mask:0xf bank_mask:0xf
    v_and_b32_dpp v23, v79, v9 row_newbcast:2 row_mask:0xf bank_mask:0xf
    s_waitcnt vmcnt(12)
    v_mfma_f32_16x16x32_bf16 v[12:15], v[16:19], v[172:175], v[12:15]
    v_and_b32_dpp v24, v79, v6 row_newbcast:10 row_mask:0xf bank_mask:0xf
    v_and_b32_dpp v25, v79, v7 row_newbcast:10 row_mask:0xf bank_mask:0xf
    v_and_b32_dpp v26, v79, v8 row_newbcast:10 row_mask:0xf bank_mask:0xf
    v_and_b32_dpp v27, v79, v9 row_newbcast:10 row_mask:0xf bank_mask:0xf
    s_waitcnt vmcnt(11)
    v_mfma_f32_16x16x32_bf16 v[12:15], v[20:23], v[176:179], v[12:15]
    v_and_b32_dpp v16, v79, v6 row_newbcast:6 row_mask:0xf bank_mask:0xf
    v_and_b32_dpp v17, v79, v7 row_newbcast:6 row_mask:0xf bank_mask:0xf
    v_and_b32_dpp v18, v79, v8 row_newbcast:6 row_mask:0xf bank_mask:0xf
    v_and_b32_dpp v19, v79, v9 row_newbcast:6 row_mask:0xf bank_mask:0xf
    s_waitcnt vmcnt(10)
    v_mfma_f32_16x16x32_bf16 v[12:15], v[24:27], v[180:183], v[12:15]
    v_and_b32_dpp v20, v79, v6 row_newbcast:14 row_mask:0xf bank_mask:0xf
    v_and_b32_dpp v21, v79, v7 row_newbcast:14 row_mask:0xf bank_mask:0xf
    v_and_b32_dpp v22, v79, v8 row_newbcast:14 row_mask:0xf bank_mask:0xf
    v_and_b32_dpp v23, v79, v9 row_newbcast:14 row_mask:0xf bank_mask:0xf
    s_waitcnt vmcnt(9)
    v_mfma_f32_16x16x32_bf16 v[12:15], v[16:19], v[184:187], v[12:15]
    v_and_b32_dpp v24, v79, v6 row_newbcast:1 row_mask:0xf bank_mask:0xf
    v_and_b32_dpp v25, v79, v7 row_newbcast:1 row_mask:0xf bank_mask:0xf
    v_and_b32_dpp v26, v79, v8 row_newbcast:1 row_mask:0xf bank_mask:0xf
    v_and_b32_dpp v27, v79, v9 row_newbcast:1 row_mask:0xf bank_mask:0xf
    s_waitcnt vmcnt(8)
    v_mfma_f32_16x16x32_bf16 v[12:15], v[20:23], v[188:191], v[12:15]
    v_and_b32_dpp v16, v79, v6 row_newbcast:9 row_mask:0xf bank_mask:0xf
    v_and_b32_dpp v17, v79, v7 row_newbcast:9 row_mask:0xf bank_mask:0xf
    v_and_b32_dpp v18, v79, v8 row_newbcast:9 row_mask:0xf bank_mask:0xf
    v_and_b32_dpp v19, v79, v9 row_newbcast:9 row_mask:0xf bank_mask:0xf
    s_waitcnt vmcnt(7)
    v_mfma_f32_16x16x32_bf16 v[12:15], v[24:27], v[192:195], v[12:15]
    v_and_b32_dpp v20, v79, v6 row_newbcast:5 row_mask:0xf bank_mask:0xf
    v_and_b32_dpp v21, v79, v7 row_newbcast:5 row_mask:0xf bank_mask:0xf
    v_and_b32_dpp v22, v79, v8 row_newbcast:5 row_mask:0xf bank_mask:0xf
    v_and_b32_dpp v23, v79, v9 row_newbcast:5 row_mask:0xf bank_mask:0xf
    s_waitcnt vmcnt(6)
    v_mfma_f32_16x16x32_bf16 v[12:15], v[16:19], v[196:199], v[12:15]
    v_and_b32_dpp v24, v79, v6 row_newbcast:13 row_mask:0xf bank_mask:0xf
    v_and_b32_dpp v25, v79, v7 row_newbcast:13 row_mask:0xf bank_mask:0xf
    v_and_b32_dpp v26, v79, v8 row_newbcast:13 row_mask:0xf bank_mask:0xf
    v_and_b32_dpp v27, v79, v9 row_newbcast:13 row_mask:0xf bank_mask:0xf
    s_waitcnt vmcnt(5)
    v_mfma_f32_16x16x32_bf16 v[12:15], v[20:23], v[200:203], v[12:15]
    v_and_b32_dpp v16, v79, v6 row_newbcast:3 row_mask:0xf bank_mask:0xf
    v_and_b32_dpp v17, v79, v7 row_newbcast:3 row_mask:0xf bank_mask:0xf
    v_and_b32_dpp v18, v79, v8 row_newbcast:3 row_mask:0xf bank_mask:0xf
    v_and_b32_dpp v19, v79, v9 row_newbcast:3 row_mask:0xf bank_mask:0xf
    s_waitcnt vmcnt(4)
    v_mfma_f32_16x16x32_bf16 v[12:15], v[24:27], v[204:207], v[12:15]
    v_and_b32_dpp v20, v79, v6 row_newbcast:11 row_mask:0xf bank_mask:0xf
    v_and_b32_dpp v21, v79, v7 row_newbcast:11 row_mask:0xf bank_mask:0xf
    v_and_b32_dpp v22, v79, v8 row_newbcast:11 row_mask:0xf bank_mask:0xf
    v_and_b32_dpp v23, v79, v9 row_newbcast:11 row_mask:0xf bank_mask:0xf
    s_waitcnt vmcnt(3)
    v_mfma_f32_16x16x32_bf16 v[12:15], v[16:19], v[208:211], v[12:15]
    v_and_b32_dpp v24, v79, v6 row_newbcast:7 row_mask:0xf bank_mask:0xf
    v_and_b32_dpp v25, v79, v7 row_newbcast:7 row_mask:0xf bank_mask:0xf
    v_and_b32_dpp v26, v79, v8 row_newbcast:7 row_mask:0xf bank_mask:0xf
    v_and_b32_dpp v27, v79, v9 row_newbcast:7 row_mask:0xf bank_mask:0xf
    s_waitcnt vmcnt(2)
    v_mfma_f32_16x16x32_bf16 v[12:15], v[20:23], v[212:215], v[12:15]
    v_and_b32_dpp v16, v79, v6 row_newbcast:15 row_mask:0xf bank_mask:0xf
    v_and_b32_dpp v17, v79, v7 row_newbcast:15 row_mask:0xf bank_mask:0xf
    v_and_b32_dpp v18, v79, v8 row_newbcast:15 row_mask:0xf bank_mask:0xf
    v_and_b32_dpp v19, v79, v9 row_newbcast:15 row_mask:0xf bank_mask:0xf
    s_waitcnt vmcnt(1)
    v_mfma_f32_16x16x32_bf16 v[12:15], v[24:27], v[216:219], v[12:15]
    s_waitcnt vmcnt(0)
    v_mfma_f32_16x16x32_bf16 v[12:15], v[16:19], v[220:223], v[12:15]
    s_mov_b32 exec_hi, 0
    s_nop 6
    ds_write_b128 v5, v[12:15] offset:4608
    s_waitcnt lgkmcnt(0)
    s_barrier
    s_endpgm
L_helper:
    s_load_dwordx16 s[16:31], s[0:1], 0
    s_load_dwordx8 s[32:39], s[0:1], 64
    s_load_dwordx4 s[40:43], s[0:1], 96
    s_and_b32 s3, s2, 31
    s_lshr_b32 s4, s2, 5
    v_and_b32 v3, 15, v2
    v_lshrrev_b32 v4, 4, v2
    v_and_b32 v5, 1, v3
    v_lshlrev_b32 v5, 4, v5
    v_mov_b32 v11, 0xffff
    v_lshlrev_b32 v11, v5, v11
    v_lshrrev_b32 v5, 1, v3
    v_cmp_eq_u32 s[56:57], 0, v5
    v_cmp_eq_u32 s[58:59], 1, v5
    v_cmp_eq_u32 s[60:61], 2, v5
    v_cmp_eq_u32 s[62:63], 3, v5
    v_cndmask_b32 v6, 0, v11, s[56:57]
    v_cndmask_b32 v7, 0, v11, s[58:59]
    v_cndmask_b32 v8, 0, v11, s[60:61]
    v_cndmask_b32 v9, 0, v11, s[62:63]
    s_mov_b32 s92, 0xffff0000
    s_mov_b32 s93, 0x3fb8aa3b
    s_sub_u32 s5, s5, 4
    s_lshl_b32 s7, s5, 7
    v_add_u32 v5, s7, v4
    v_lshlrev_b32 v30, 13, v5
    v_lshl_add_u32 v30, v3, 4, v30
    v_lshl_add_u32 v31, v3, 2, v5
    v_lshlrev_b32 v31, 1, v31
    s_waitcnt lgkmcnt(0)
    s_lshl_b32 s7, s4, 10
    s_add_u32 s12, s16, s7
    s_addc_u32 s13, s17, 0
    s_and_b32 s13, s13, 0xffff
    s_mov_b32 s14, 1024
    s_mov_b32 s15, 0x00020000
    s_lshl_b32 s7, s3, 8
    s_sub_u32 s94, 4194304, s7
    s_add_u32 s8, s22, s7
    s_addc_u32 s9, s23, 0
    s_and_b32 s9, s9, 0xffff
    s_mov_b32 s10, s94
    s_mov_b32 s11, 0x00020000
    buffer_load_ushort v33, v31, s[12:15], 0 offen
    buffer_load_ushort v34, v31, s[12:15], 0 offen offset:128
    buffer_load_dwordx4 v[96:99], v30, s[8:11], 0 offen
    s_mov_b32 s7, 32768
    buffer_load_dwordx4 v[100:103], v30, s[8:11], s7 offen
    s_mov_b32 s7, 65536
    buffer_load_dwordx4 v[104:107], v30, s[8:11], s7 offen
    s_waitcnt vmcnt(3)
    v_lshl_or_b32 v28, v33, 16, v33
    v_lshl_or_b32 v29, v34, 16, v34
    s_nop 0
    v_and_b32_dpp v16, v28, v6 row_newbcast:0 row_mask:0xf bank_mask:0xf
    v_and_b32_dpp v17, v28, v7 row_newbcast:0 row_mask:0xf bank_mask:0xf
    v_and_b32_dpp v18, v28, v8 row_newbcast:0 row_mask:0xf bank_mask:0xf
    v_and_b32_dpp v19, v28, v9 row_newbcast:0 row_mask:0xf bank_mask:0xf
    v_and_b32_dpp v20, v28, v6 row_newbcast:1 row_mask:0xf bank_mask:0xf
    v_and_b32_dpp v21, v28, v7 row_newbcast:1 row_mask:0xf bank_mask:0xf
    v_and_b32_dpp v22, v28, v8 row_newbcast:1 row_mask:0xf bank_mask:0xf
    v_and_b32_dpp v23, v28, v9 row_newbcast:1 row_mask:0xf bank_mask:0xf
    s_waitcnt vmcnt(2)
    s_mov_b32 s7, 98304
    buffer_load_dwordx4 v[108:111], v30, s[8:11], s7 offen
    v_mfma_f32_16x16x32_bf16 v[36:39], v[16:19], v[96:99], 0
    v_and_b32_dpp v24, v28, v6 row_newbcast:2 row_mask:0xf bank_mask:0xf
    v_and_b32_dpp v25, v28, v7 row_newbcast:2 row_mask:0xf bank_mask:0xf
    v_and_b32_dpp v26, v28, v8 row_newbcast:2 row_mask:0xf bank_mask:0xf
    v_and_b32_dpp v27, v28, v9 row_newbcast:2 row_mask:0xf bank_mask:0xf
    s_waitcnt vmcnt(2)
    s_mov_b32 s7, 131072
    buffer_load_dwordx4 v[112:115], v30, s[8:11], s7 offen
    v_mfma_f32_16x16x32_bf16 v[36:39], v[20:23], v[100:103], v[36:39]
    v_and_b32_dpp v16, v28, v6 row_newbcast:3 row_mask:0xf bank_mask:0xf
    v_and_b32_dpp v17, v28, v7 row_newbcast:3 row_mask:0xf bank_mask:0xf
    v_and_b32_dpp v18, v28, v8 row_newbcast:3 row_mask:0xf bank_mask:0xf
    v_and_b32_dpp v19, v28, v9 row_newbcast:3 row_mask:0xf bank_mask:0xf
    s_waitcnt vmcnt(2)
    s_mov_b32 s7, 163840
    buffer_load_dwordx4 v[116:119], v30, s[8:11], s7 offen
    v_mfma_f32_16x16x32_bf16 v[36:39], v[24:27], v[104:107], v[36:39]
    v_and_b32_dpp v20, v28, v6 row_newbcast:4 row_mask:0xf bank_mask:0xf
    v_and_b32_dpp v21, v28, v7 row_newbcast:4 row_mask:0xf bank_mask:0xf
    v_and_b32_dpp v22, v28, v8 row_newbcast:4 row_mask:0xf bank_mask:0xf
    v_and_b32_dpp v23, v28, v9 row_newbcast:4 row_mask:0xf bank_mask:0xf
    s_waitcnt vmcnt(2)
    s_mov_b32 s7, 196608
    buffer_load_dwordx4 v[120:123], v30, s[8:11], s7 offen
    v_mfma_f32_16x16x32_bf16 v[36:39], v[16:19], v[108:111], v[36:39]
    v_and_b32_dpp v24, v28, v6 row_newbcast:5 row_mask:0xf bank_mask:0xf
    v_and_b32_dpp v25, v28, v7 row_newbcast:5 row_mask:0xf bank_mask:0xf
    v_and_b32_dpp v26, v28, v8 row_newbcast:5 row_mask:0xf bank_mask:0xf
    v_and_b32_dpp v27, v28, v9 row_newbcast:5 row_mask:0xf bank_mask:0xf
    s_waitcnt vmcnt(2)
    s_mov_b32 s7, 229376
    buffer_load_dwordx4 v[124:127], v30, s[8:11], s7 offen
    v_mfma_f32_16x16x32_bf16 v[36:39], v[20:23], v[112:115], v[36:39]
    v_and_b32_dpp v16, v28, v6 row_newbcast:6 row_mask:0xf bank_mask:0xf
    v_and_b32_dpp v17, v28, v7 row_newbcast:6 row_mask:0xf bank_mask:0xf
    v_and_b32_dpp v18, v28, v8 row_newbcast:6 row_mask:0xf bank_mask:0xf
    v_and_b32_dpp v19, v28, v9 row_newbcast:6 row_mask:0xf bank_mask:0xf
    s_waitcnt vmcnt(2)
    s_mov_b32 s7, 262144
    buffer_load_dwordx4 v[128:131], v30, s[8:11], s7 offen
    v_mfma_f32_16x16x32_bf16 v[36:39], v[24:27], v[116:119], v[36:39]
    v_and_b32_dpp v20, v28, v6 row_newbcast:7 row_mask:0xf bank_mask:0xf
    v_and_b32_dpp v21, v28, v7 row_newbcast:7 row_mask:0xf bank_mask:0xf
    v_and_b32_dpp v22, v28, v8 row_newbcast:7 row_mask:0xf bank_mask:0xf
    v_and_b32_dpp v23, v28, v9 row_newbcast:7 row_mask:0xf bank_mask:0xf
    s_waitcnt vmcnt(2)
    s_mov_b32 s7, 294912
    buffer_load_dwordx4 v[132:135], v30, s[8:11], s7 offen
    v_mfma_f32_16x16x32_bf16 v[36:39], v[16:19], v[120:123], v[36:39]
    v_and_b32_dpp v24, v28, v6 row_newbcast:8 row_mask:0xf bank_mask:0xf
    v_and_b32_dpp v25, v28, v7 row_newbcast:8 row_mask:0xf bank_mask:0xf
    v_and_b32_dpp v26, v28, v8 row_newbcast:8 row_mask:0xf bank_mask:0xf
    v_and_b32_dpp v27, v28, v9 row_newbcast:8 row_mask:0xf bank_mask:0xf
    s_waitcnt vmcnt(2)
    s_mov_b32 s7, 327680
    buffer_load_dwordx4 v[136:139], v30, s[8:11], s7 offen
    v_mfma_f32_16x16x32_bf16 v[36:39], v[20:23], v[124:127], v[36:39]
    v_and_b32_dpp v16, v28, v6 row_newbcast:9 row_mask:0xf bank_mask:0xf
    v_and_b32_dpp v17, v28, v7 row_newbcast:9 row_mask:0xf bank_mask:0xf
    v_and_b32_dpp v18, v28, v8 row_newbcast:9 row_mask:0xf bank_mask:0xf
    v_and_b32_dpp v19, v28, v9 row_newbcast:9 row_mask:0xf bank_mask:0xf
    s_waitcnt vmcnt(2)
    s_mov_b32 s7, 360448
    buffer_load_dwordx4 v[140:143], v30, s[8:11], s7 offen
    v_mfma_f32_16x16x32_bf16 v[36:39], v[24:27], v[128:131], v[36:39]
    v_and_b32_dpp v20, v28, v6 row_newbcast:10 row_mask:0xf bank_mask:0xf
    v_and_b32_dpp v21, v28, v7 row_newbcast:10 row_mask:0xf bank_mask:0xf
    v_and_b32_dpp v22, v28, v8 row_newbcast:10 row_mask:0xf bank_mask:0xf
    v_and_b32_dpp v23, v28, v9 row_newbcast:10 row_mask:0xf bank_mask:0xf
    s_waitcnt vmcnt(2)
    s_mov_b32 s7, 393216
    buffer_load_dwordx4 v[144:147], v30, s[8:11], s7 offen
    v_mfma_f32_16x16x32_bf16 v[36:39], v[16:19], v[132:135], v[36:39]
    v_and_b32_dpp v24, v28, v6 row_newbcast:11 row_mask:0xf bank_mask:0xf
    v_and_b32_dpp v25, v28, v7 row_newbcast:11 row_mask:0xf bank_mask:0xf
    v_and_b32_dpp v26, v28, v8 row_newbcast:11 row_mask:0xf bank_mask:0xf
    v_and_b32_dpp v27, v28, v9 row_newbcast:11 row_mask:0xf bank_mask:0xf
    s_waitcnt vmcnt(2)
    s_mov_b32 s7, 425984
    buffer_load_dwordx4 v[148:151], v30, s[8:11], s7 offen
    v_mfma_f32_16x16x32_bf16 v[36:39], v[20:23], v[136:139], v[36:39]
    v_and_b32_dpp v16, v28, v6 row_newbcast:12 row_mask:0xf bank_mask:0xf
    v_and_b32_dpp v17, v28, v7 row_newbcast:12 row_mask:0xf bank_mask:0xf
    v_and_b32_dpp v18, v28, v8 row_newbcast:12 row_mask:0xf bank_mask:0xf
    v_and_b32_dpp v19, v28, v9 row_newbcast:12 row_mask:0xf bank_mask:0xf
    s_waitcnt vmcnt(2)
    s_mov_b32 s7, 458752
    buffer_load_dwordx4 v[152:155], v30, s[8:11], s7 offen
    v_mfma_f32_16x16x32_bf16 v[36:39], v[24:27], v[140:143], v[36:39]
    v_and_b32_dpp v20, v28, v6 row_newbcast:13 row_mask:0xf bank_mask:0xf
    v_and_b32_dpp v21, v28, v7 row_newbcast:13 row_mask:0xf bank_mask:0xf
    v_and_b32_dpp v22, v28, v8 row_newbcast:13 row_mask:0xf bank_mask:0xf
    v_and_b32_dpp v23, v28, v9 row_newbcast:13 row_mask:0xf bank_mask:0xf
    s_waitcnt vmcnt(2)
    s_mov_b32 s7, 491520
    buffer_load_dwordx4 v[156:159], v30, s[8:11], s7 offen
    v_mfma_f32_16x16x32_bf16 v[36:39], v[16:19], v[144:147], v[36:39]
    v_and_b32_dpp v24, v28, v6 row_newbcast:14 row_mask:0xf bank_mask:0xf
    v_and_b32_dpp v25, v28, v7 row_newbcast:14 row_mask:0xf bank_mask:0xf
    v_and_b32_dpp v26, v28, v8 row_newbcast:14 row_mask:0xf bank_mask:0xf
    v_and_b32_dpp v27, v28, v9 row_newbcast:14 row_mask:0xf bank_mask:0xf
    s_waitcnt vmcnt(2)
    s_mov_b32 s7, 524288
    buffer_load_dwordx4 v[160:163], v30, s[8:11], s7 offen
    v_mfma_f32_16x16x32_bf16 v[36:39], v[20:23], v[148:151], v[36:39]
    v_and_b32_dpp v16, v28, v6 row_newbcast:15 row_mask:0xf bank_mask:0xf
    v_and_b32_dpp v17, v28, v7 row_newbcast:15 row_mask:0xf bank_mask:0xf
    v_and_b32_dpp v18, v28, v8 row_newbcast:15 row_mask:0xf bank_mask:0xf
    v_and_b32_dpp v19, v28, v9 row_newbcast:15 row_mask:0xf bank_mask:0xf
    s_waitcnt vmcnt(2)
    s_mov_b32 s7, 557056
    buffer_load_dwordx4 v[164:167], v30, s[8:11], s7 offen
    v_mfma_f32_16x16x32_bf16 v[36:39], v[24:27], v[152:155], v[36:39]
    v_and_b32_dpp v20, v29, v6 row_newbcast:0 row_mask:0xf bank_mask:0xf
    v_and_b32_dpp v21, v29, v7 row_newbcast:0 row_mask:0xf bank_mask:0xf
    v_and_b32_dpp v22, v29, v8 row_newbcast:0 row_mask:0xf bank_mask:0xf
    v_and_b32_dpp v23, v29, v9 row_newbcast:0 row_mask:0xf bank_mask:0xf
    s_waitcnt vmcnt(2)
    s_mov_b32 s7, 589824
    buffer_load_dwordx4 v[168:171], v30, s[8:11], s7 offen
    v_mfma_f32_16x16x32_bf16 v[36:39], v[16:19], v[156:159], v[36:39]
    v_and_b32_dpp v24, v29, v6 row_newbcast:1 row_mask:0xf bank_mask:0xf
    v_and_b32_dpp v25, v29, v7 row_newbcast:1 row_mask:0xf bank_mask:0xf
    v_and_b32_dpp v26, v29, v8 row_newbcast:1 row_mask:0xf bank_mask:0xf
    v_and_b32_dpp v27, v29, v9 row_newbcast:1 row_mask:0xf bank_mask:0xf
    s_waitcnt vmcnt(2)
    s_mov_b32 s7, 622592
    buffer_load_dwordx4 v[172:175], v30, s[8:11], s7 offen
    v_mfma_f32_16x16x32_bf16 v[36:39], v[20:23], v[160:163], v[36:39]
    v_and_b32_dpp v16, v29, v6 row_newbcast:2 row_mask:0xf bank_mask:0xf
    v_and_b32_dpp v17, v29, v7 row_newbcast:2 row_mask:0xf bank_mask:0xf
    v_and_b32_dpp v18, v29, v8 row_newbcast:2 row_mask:0xf bank_mask:0xf
    v_and_b32_dpp v19, v29, v9 row_newbcast:2 row_mask:0xf bank_mask:0xf
    s_waitcnt vmcnt(2)
    s_mov_b32 s7, 655360
    buffer_load_dwordx4 v[176:179], v30, s[8:11], s7 offen
    v_mfma_f32_16x16x32_bf16 v[36:39], v[24:27], v[164:167], v[36:39]
    v_and_b32_dpp v20, v29, v6 row_newbcast:3 row_mask:0xf bank_mask:0xf
    v_and_b32_dpp v21, v29, v7 row_newbcast:3 row_mask:0xf bank_mask:0xf
    v_and_b32_dpp v22, v29, v8 row_newbcast:3 row_mask:0xf bank_mask:0xf
    v_and_b32_dpp v23, v29, v9 row_newbcast:3 row_mask:0xf bank_mask:0xf
    s_waitcnt vmcnt(2)
    s_mov_b32 s7, 688128
    buffer_load_dwordx4 v[180:183], v30, s[8:11], s7 offen
    v_mfma_f32_16x16x32_bf16 v[36:39], v[16:19], v[168:171], v[36:39]
    v_and_b32_dpp v24, v29, v6 row_newbcast:4 row_mask:0xf bank_mask:0xf
    v_and_b32_dpp v25, v29, v7 row_newbcast:4 row_mask:0xf bank_mask:0xf
    v_and_b32_dpp v26, v29, v8 row_newbcast:4 row_mask:0xf bank_mask:0xf
    v_and_b32_dpp v27, v29, v9 row_newbcast:4 row_mask:0xf bank_mask:0xf
    s_waitcnt vmcnt(2)
    s_mov_b32 s7, 720896
    buffer_load_dwordx4 v[184:187], v30, s[8:11], s7 offen
    v_mfma_f32_16x16x32_bf16 v[36:39], v[20:23], v[172:175], v[36:39]
    v_and_b32_dpp v16, v29, v6 row_newbcast:5 row_mask:0xf bank_mask:0xf
    v_and_b32_dpp v17, v29, v7 row_newbcast:5 row_mask:0xf bank_mask:0xf
    v_and_b32_dpp v18, v29, v8 row_newbcast:5 row_mask:0xf bank_mask:0xf
    v_and_b32_dpp v19, v29, v9 row_newbcast:5 row_mask:0xf bank_mask:0xf
    s_waitcnt vmcnt(2)
    s_mov_b32 s7, 753664
    buffer_load_dwordx4 v[188:191], v30, s[8:11], s7 offen
    v_mfma_f32_16x16x32_bf16 v[36:39], v[24:27], v[176:179], v[36:39]
    v_and_b32_dpp v20, v29, v6 row_newbcast:6 row_mask:0xf bank_mask:0xf
    v_and_b32_dpp v21, v29, v7 row_newbcast:6 row_mask:0xf bank_mask:0xf
    v_and_b32_dpp v22, v29, v8 row_newbcast:6 row_mask:0xf bank_mask:0xf
    v_and_b32_dpp v23, v29, v9 row_newbcast:6 row_mask:0xf bank_mask:0xf
    s_waitcnt vmcnt(2)
    s_mov_b32 s7, 786432
    buffer_load_dwordx4 v[192:195], v30, s[8:11], s7 offen
    v_mfma_f32_16x16x32_bf16 v[36:39], v[16:19], v[180:183], v[36:39]
    v_and_b32_dpp v24, v29, v6 row_newbcast:7 row_mask:0xf bank_mask:0xf
    v_and_b32_dpp v25, v29, v7 row_newbcast:7 row_mask:0xf bank_mask:0xf
    v_and_b32_dpp v26, v29, v8 row_newbcast:7 row_mask:0xf bank_mask:0xf
    v_and_b32_dpp v27, v29, v9 row_newbcast:7 row_mask:0xf bank_mask:0xf
    s_waitcnt vmcnt(2)
    s_mov_b32 s7, 819200
    buffer_load_dwordx4 v[196:199], v30, s[8:11], s7 offen
    v_mfma_f32_16x16x32_bf16 v[36:39], v[20:23], v[184:187], v[36:39]
    v_and_b32_dpp v16, v29, v6 row_newbcast:8 row_mask:0xf bank_mask:0xf
    v_and_b32_dpp v17, v29, v7 row_newbcast:8 row_mask:0xf bank_mask:0xf
    v_and_b32_dpp v18, v29, v8 row_newbcast:8 row_mask:0xf bank_mask:0xf
    v_and_b32_dpp v19, v29, v9 row_newbcast:8 row_mask:0xf bank_mask:0xf
    s_waitcnt vmcnt(2)
    s_mov_b32 s7, 851968
    buffer_load_dwordx4 v[200:203], v30, s[8:11], s7 offen
    v_mfma_f32_16x16x32_bf16 v[36:39], v[24:27], v[188:191], v[36:39]
    v_and_b32_dpp v20, v29, v6 row_newbcast:9 row_mask:0xf bank_mask:0xf
    v_and_b32_dpp v21, v29, v7 row_newbcast:9 row_mask:0xf bank_mask:0xf
    v_and_b32_dpp v22, v29, v8 row_newbcast:9 row_mask:0xf bank_mask:0xf
    v_and_b32_dpp v23, v29, v9 row_newbcast:9 row_mask:0xf bank_mask:0xf
    s_waitcnt vmcnt(2)
    s_mov_b32 s7, 884736
    buffer_load_dwordx4 v[204:207], v30, s[8:11], s7 offen
    v_mfma_f32_16x16x32_bf16 v[36:39], v[16:19], v[192:195], v[36:39]
    v_and_b32_dpp v24, v29, v6 row_newbcast:10 row_mask:0xf bank_mask:0xf
    v_and_b32_dpp v25, v29, v7 row_newbcast:10 row_mask:0xf bank_mask:0xf
    v_and_b32_dpp v26, v29, v8 row_newbcast:10 row_mask:0xf bank_mask:0xf
    v_and_b32_dpp v27, v29, v9 row_newbcast:10 row_mask:0xf bank_mask:0xf
    s_waitcnt vmcnt(2)
    s_mov_b32 s7, 917504
    buffer_load_dwordx4 v[208:211], v30, s[8:11], s7 offen
    v_mfma_f32_16x16x32_bf16 v[36:39], v[20:23], v[196:199], v[36:39]
    v_and_b32_dpp v16, v29, v6 row_newbcast:11 row_mask:0xf bank_mask:0xf
    v_and_b32_dpp v17, v29, v7 row_newbcast:11 row_mask:0xf bank_mask:0xf
    v_and_b32_dpp v18, v29, v8 row_newbcast:11 row_mask:0xf bank_mask:0xf
    v_and_b32_dpp v19, v29, v9 row_newbcast:11 row_mask:0xf bank_mask:0xf
    s_waitcnt vmcnt(2)
    s_mov_b32 s7, 950272
    buffer_load_dwordx4 v[212:215], v30, s[8:11], s7 offen
    v_mfma_f32_16x16x32_bf16 v[36:39], v[24:27], v[200:203], v[36:39]
    v_and_b32_dpp v20, v29, v6 row_newbcast:12 row_mask:0xf bank_mask:0xf
    v_and_b32_dpp v21, v29, v7 row_newbcast:12 row_mask:0xf bank_mask:0xf
    v_and_b32_dpp v22, v29, v8 row_newbcast:12 row_mask:0xf bank_mask:0xf
    v_and_b32_dpp v23, v29, v9 row_newbcast:12 row_mask:0xf bank_mask:0xf
    s_waitcnt vmcnt(2)
    s_mov_b32 s7, 983040
    buffer_load_dwordx4 v[216:219], v30, s[8:11], s7 offen
    v_mfma_f32_16x16x32_bf16 v[36:39], v[16:19], v[204:207], v[36:39]
    v_and_b32_dpp v24, v29, v6 row_newbcast:13 row_mask:0xf bank_mask:0xf
    v_and_b32_dpp v25, v29, v7 row_newbcast:13 row_mask:0xf bank_mask:0xf
    v_and_b32_dpp v26, v29, v8 row_newbcast:13 row_mask:0xf bank_mask:0xf
    v_and_b32_dpp v27, v29, v9 row_newbcast:13 row_mask:0xf bank_mask:0xf
    s_waitcnt vmcnt(2)
    s_mov_b32 s7, 1015808
    buffer_load_dwordx4 v[220:223], v30, s[8:11], s7 offen
    v_mfma_f32_16x16x32_bf16 v[36:39], v[20:23], v[208:211], v[36:39]
    v_and_b32_dpp v16, v29, v6 row_newbcast:14 row_mask:0xf bank_mask:0xf
    v_and_b32_dpp v17, v29, v7 row_newbcast:14 row_mask:0xf bank_mask:0xf
    v_and_b32_dpp v18, v29, v8 row_newbcast:14 row_mask:0xf bank_mask:0xf
    v_and_b32_dpp v19, v29, v9 row_newbcast:14 row_mask:0xf bank_mask:0xf
    s_waitcnt vmcnt(2)
    v_mfma_f32_16x16x32_bf16 v[36:39], v[24:27], v[212:215], v[36:39]
    v_and_b32_dpp v20, v29, v6 row_newbcast:15 row_mask:0xf bank_mask:0xf
    v_and_b32_dpp v21, v29, v7 row_newbcast:15 row_mask:0xf bank_mask:0xf
    v_and_b32_dpp v22, v29, v8 row_newbcast:15 row_mask:0xf bank_mask:0xf
    v_and_b32_dpp v23, v29, v9 row_newbcast:15 row_mask:0xf bank_mask:0xf
    s_waitcnt vmcnt(1)
    v_mfma_f32_16x16x32_bf16 v[36:39], v[16:19], v[216:219], v[36:39]
    s_waitcnt vmcnt(0)
    v_mfma_f32_16x16x32_bf16 v[36:39], v[20:23], v[220:223], v[36:39]
    v_lshlrev_b32 v35, 5, v3
    v_lshl_add_u32 v35, v4, 4, v35
    s_lshl_b32 s7, s5, 9
    v_add_u32 v35, s7, v35
    s_mov_b32 exec_hi, 0
    s_nop 2
    ds_write_b128 v35, v[36:39] offset:0
    s_mov_b64 exec, -1
    s_waitcnt lgkmcnt(0)
    s_barrier
    s_mov_b32 s44, s42
    s_and_b32 s45, s43, 0xffff
    s_mov_b32 s46, 2097152
    s_mov_b32 s47, 0x00020000
    s_min_u32 s7, s3, 27
    s_lshl_b32 s7, s7, 16
    s_add_u32 s56, s34, s7
    s_addc_u32 s57, s35, 0
    s_and_b32 s57, s57, 0xffff
    s_mov_b32 s58, 65536
    s_mov_b32 s59, 0x00020000
    s_lshl_b32 s7, s3, 17
    s_add_u32 s60, s24, s7
    s_addc_u32 s61, s25, 0
    s_and_b32 s61, s61, 0xffff
    s_mov_b32 s62, 131072
    s_mov_b32 s63, 0x00020000
    s_mov_b32 s64, s38
    s_and_b32 s65, s39, 0xffff
    s_mov_b32 s66, 8192
    s_mov_b32 s67, 0x00020000
    s_mov_b32 s68, s36
    s_and_b32 s69, s37, 0xffff
    s_mov_b32 s70, 1024
    s_mov_b32 s71, 0x00020000
    s_mov_b32 s72, s28
    s_and_b32 s73, s29, 0xffff
    s_mov_b32 s74, 1024
    s_mov_b32 s75, 0x00020000
    s_mov_b32 s76, s40
    s_and_b32 s77, s41, 0xffff
    s_mov_b32 s78, 256
    s_mov_b32 s79, 0x00020000
    s_or_b32 s7, s2, s5
    s_cmp_lg_u32 s7, 0
    s_cbranch_scc1 L_notag
    s_memrealtime s[94:95]
    s_waitcnt lgkmcnt(0)
    s_brev_b32 s7, s94
    s_xor_b32 s95, s95, s7
    s_or_b32 s95, s95, 1
    s_or_b32 s94, s94, 1
    v_mov_b32 v12, s94
    v_mov_b32 v13, s95
    v_mov_b32 v33, 0
    s_mov_b64 exec, 1
    buffer_store_dwordx2 v[12:13], v33, s[76:79], 0 offen sc1
    s_mov_b64 exec, -1
    s_waitcnt vmcnt(0)
L_notag:
    s_nop 1
    v_lshlrev_b32 v31, 10, v4
    v_lshl_add_u32 v31, v3, 4, v31
    s_lshl_b32 s7, s5, 8
    v_add_u32 v31, s7, v31
    s_cmp_ge_u32 s3, 28
    s_cbranch_scc1 L_noffn1
    s_movk_i32 s7, 3584
    v_mul_lo_u32 v30, v5, s7
    v_and_b32 v33, 7, v3
    v_lshl_add_u32 v30, v33, 4, v30
    s_lshl_b32 s7, s3, 7
    v_add_u32 v30, s7, v30
    v_cmp_gt_u32 vcc, 8, v3
    v_mov_b32 v10, s32
    v_mov_b32 v11, s30
    v_cndmask_b32 v10, v10, v11, vcc
    v_mov_b32 v33, s33
    v_mov_b32 v11, s31
    v_cndmask_b32 v11, v33, v11, vcc
    v_add_co_u32 v10, vcc, v10, v30
    s_nop 1
    v_addc_co_u32 v11, vcc, 0, v11, vcc
    s_movk_i32 s7, 14336
    global_load_dwordx4 v[96:99], v[10:11], off
    v_add_co_u32 v10, vcc, s7, v10
    s_nop 1
    v_addc_co_u32 v11, vcc, 0, v11, vcc
    global_load_dwordx4 v[100:103], v[10:11], off
    v_add_co_u32 v10, vcc, s7, v10
    s_nop 1
    v_addc_co_u32 v11, vcc, 0, v11, vcc
    s_waitcnt vmcnt(1)
    global_load_dwordx4 v[104:107], v[10:11], off
    v_add_co_u32 v10, vcc, s7, v10
    s_nop 1
    v_addc_co_u32 v11, vcc, 0, v11, vcc
    s_waitcnt vmcnt(1)
    global_load_dwordx4 v[108:111], v[10:11], off
    v_add_co_u32 v10, vcc, s7, v10
    s_nop 1
    v_addc_co_u32 v11, vcc, 0, v11, vcc
    s_waitcnt vmcnt(1)
    global_load_dwordx4 v[112:115], v[10:11], off
    v_add_co_u32 v10, vcc, s7, v10
    s_nop 1
    v_addc_co_u32 v11, vcc, 0, v11, vcc
    s_waitcnt vmcnt(1)
    global_load_dwordx4 v[116:119], v[10:11], off
    v_add_co_u32 v10, vcc, s7, v10
    s_nop 1
    v_addc_co_u32 v11, vcc, 0, v11, vcc
    s_waitcnt vmcnt(1)
    global_load_dwordx4 v[120:123], v[10:11], off
    v_add_co_u32 v10, vcc, s7, v10
    s_nop 1
    v_addc_co_u32 v11, vcc, 0, v11, vcc
    s_waitcnt vmcnt(1)
    global_load_dwordx4 v[124:127], v[10:11], off
    v_add_co_u32 v10, vcc, s7, v10
    s_nop 1
    v_addc_co_u32 v11, vcc, 0, v11, vcc
    s_waitcnt vmcnt(1)
    global_load_dwordx4 v[128:131], v[10:11], off
    v_add_co_u32 v10, vcc, s7, v10
    s_nop 1
    v_addc_co_u32 v11, vcc, 0, v11, vcc
    s_waitcnt vmcnt(1)
    global_load_dwordx4 v[132:135], v[10:11], off
    v_add_co_u32 v10, vcc, s7, v10
    s_nop 1
    v_addc_co_u32 v11, vcc, 0, v11, vcc
    s_waitcnt vmcnt(1)
    global_load_dwordx4 v[136:139], v[10:11], off
    v_add_co_u32 v10, vcc, s7, v10
    s_nop 1
    v_addc_co_u32 v11, vcc, 0, v11, vcc
    s_waitcnt vmcnt(1)
    global_load_dwordx4 v[140:143], v[10:11], off
    v_add_co_u32 v10, vcc, s7, v10
    s_nop 1
    v_addc_co_u32 v11, vcc, 0, v11, vcc
    s_waitcnt vmcnt(1)
    global_load_dwordx4 v[144:147], v[10:11], off
    v_add_co_u32 v10, vcc, s7, v10
    s_nop 1
    v_addc_co_u32 v11, vcc, 0, v11, vcc
    s_waitcnt vmcnt(1)
    global_load_dwordx4 v[148:151], v[10:11], off
    v_add_co_u32 v10, vcc, s7, v10
    s_nop 1
    v_addc_co_u32 v11, vcc, 0, v11, vcc
    s_waitcnt vmcnt(1)
    global_load_dwordx4 v[152:155], v[10:11], off
    v_add_co_u32 v10, vcc, s7, v10
    s_nop 1
    v_addc_co_u32 v11, vcc, 0, v11, vcc
    s_waitcnt vmcnt(1)
    global_load_dwordx4 v[156:159], v[10:11], off
    v_add_co_u32 v10, vcc, s7, v10
    s_nop 1
    v_addc_co_u32 v11, vcc, 0, v11, vcc
    s_waitcnt vmcnt(1)
    global_load_dwordx4 v[160:163], v[10:11], off
    v_add_co_u32 v10, vcc, s7, v10
    s_nop 1
    v_addc_co_u32 v11, vcc, 0, v11, vcc
    s_waitcnt vmcnt(1)
    global_load_dwordx4 v[164:167], v[10:11], off
    v_add_co_u32 v10, vcc, s7, v10
    s_nop 1
    v_addc_co_u32 v11, vcc, 0, v11, vcc
    s_waitcnt vmcnt(1)
    global_load_dwordx4 v[168:171], v[10:11], off
    v_add_co_u32 v10, vcc, s7, v10
    s_nop 1
    v_addc_co_u32 v11, vcc, 0, v11, vcc
    s_waitcnt vmcnt(1)
    global_load_dwordx4 v[172:175], v[10:11], off
    v_add_co_u32 v10, vcc, s7, v10
    s_nop 1
    v_addc_co_u32 v11, vcc, 0, v11, vcc
    s_waitcnt vmcnt(1)
    global_load_dwordx4 v[176:179], v[10:11], off
    v_add_co_u32 v10, vcc, s7, v10
    s_nop 1
    v_addc_co_u32 v11, vcc, 0, v11, vcc
    s_waitcnt vmcnt(1)
    global_load_dwordx4 v[180:183], v[10:11], off
    v_add_co_u32 v10, vcc, s7, v10
    s_nop 1
    v_addc_co_u32 v11, vcc, 0, v11, vcc
    s_waitcnt vmcnt(1)
    global_load_dwordx4 v[184:187], v[10:11], off
    v_add_co_u32 v10, vcc, s7, v10
    s_nop 1
    v_addc_co_u32 v11, vcc, 0, v11, vcc
    s_waitcnt vmcnt(1)
    global_load_dwordx4 v[188:191], v[10:11], off
    v_add_co_u32 v10, vcc, s7, v10
    s_nop 1
    v_addc_co_u32 v11, vcc, 0, v11, vcc
    s_waitcnt vmcnt(1)
    global_load_dwordx4 v[192:195], v[10:11], off
    v_add_co_u32 v10, vcc, s7, v10
    s_nop 1
    v_addc_co_u32 v11, vcc, 0, v11, vcc
    s_waitcnt vmcnt(1)
    global_load_dwordx4 v[196:199], v[10:11], off
    v_add_co_u32 v10, vcc, s7, v10
    s_nop 1
    v_addc_co_u32 v11, vcc, 0, v11, vcc
    s_waitcnt vmcnt(1)
    global_load_dwordx4 v[200:203], v[10:11], off
    v_add_co_u32 v10, vcc, s7, v10
    s_nop 1
    v_addc_co_u32 v11, vcc, 0, v11, vcc
    s_waitcnt vmcnt(1)
    global_load_dwordx4 v[204:207], v[10:11], off
    v_add_co_u32 v10, vcc, s7, v10
    s_nop 1
    v_addc_co_u32 v11, vcc, 0, v11, vcc
    s_waitcnt vmcnt(1)
    global_load_dwordx4 v[208:211], v[10:11], off
    v_add_co_u32 v10, vcc, s7, v10
    s_nop 1
    v_addc_co_u32 v11, vcc, 0, v11, vcc
    s_waitcnt vmcnt(1)
    global_load_dwordx4 v[212:215], v[10:11], off
    v_add_co_u32 v10, vcc, s7, v10
    s_nop 1
    v_addc_co_u32 v11, vcc, 0, v11, vcc
    s_waitcnt vmcnt(1)
    global_load_dwordx4 v[216:219], v[10:11], off
    v_add_co_u32 v10, vcc, s7, v10
    s_nop 1
    v_addc_co_u32 v11, vcc, 0, v11, vcc
    s_waitcnt vmcnt(1)
    global_load_dwordx4 v[220:223], v[10:11], off
    s_waitcnt vmcnt(1)
    buffer_load_dwordx4 v[40:43], v31, s[56:59], 0 offen
    s_mov_b32 s7, 4096
    s_waitcnt vmcnt(1)
    buffer_load_dwordx4 v[44:47], v31, s[56:59], s7 offen
    s_waitcnt vmcnt(2)
    v_and_b32_dpp v16, v28, v6 row_newbcast:0 row_mask:0xf bank_mask:0xf
    v_and_b32_dpp v17, v28, v7 row_newbcast:0 row_mask:0xf bank_mask:0xf
    v_and_b32_dpp v18, v28, v8 row_newbcast:0 row_mask:0xf bank_mask:0xf
    v_and_b32_dpp v19, v28, v9 row_newbcast:0 row_mask:0xf bank_mask:0xf
    v_and_b32_dpp v20, v28, v6 row_newbcast:1 row_mask:0xf bank_mask:0xf
    v_and_b32_dpp v21, v28, v7 row_newbcast:1 row_mask:0xf bank_mask:0xf
    v_and_b32_dpp v22, v28, v8 row_newbcast:1 row_mask:0xf bank_mask:0xf
    v_and_b32_dpp v23, v28, v9 row_newbcast:1 row_mask:0xf bank_mask:0xf
    v_mfma_f32_16x16x32_bf16 v[36:39], v[16:19], v[96:99], 0
    v_and_b32_dpp v24, v28, v6 row_newbcast:2 row_mask:0xf bank_mask:0xf
    v_and_b32_dpp v25, v28, v7 row_newbcast:2 row_mask:0xf bank_mask:0xf
    v_and_b32_dpp v26, v28, v8 row_newbcast:2 row_mask:0xf bank_mask:0xf
    v_and_b32_dpp v27, v28, v9 row_newbcast:2 row_mask:0xf bank_mask:0xf
    v_mfma_f32_16x16x32_bf16 v[36:39], v[20:23], v[100:103], v[36:39]
    v_and_b32_dpp v16, v28, v6 row_newbcast:3 row_mask:0xf bank_mask:0xf
    v_and_b32_dpp v17, v28, v7 row_newbcast:3 row_mask:0xf bank_mask:0xf
    v_and_b32_dpp v18, v28, v8 row_newbcast:3 row_mask:0xf bank_mask:0xf
    v_and_b32_dpp v19, v28, v9 row_newbcast:3 row_mask:0xf bank_mask:0xf
    v_mfma_f32_16x16x32_bf16 v[36:39], v[24:27], v[104:107], v[36:39]
    v_and_b32_dpp v20, v28, v6 row_newbcast:4 row_mask:0xf bank_mask:0xf
    v_and_b32_dpp v21, v28, v7 row_newbcast:4 row_mask:0xf bank_mask:0xf
    v_and_b32_dpp v22, v28, v8 row_newbcast:4 row_mask:0xf bank_mask:0xf
    v_and_b32_dpp v23, v28, v9 row_newbcast:4 row_mask:0xf bank_mask:0xf
    v_mfma_f32_16x16x32_bf16 v[36:39], v[16:19], v[108:111], v[36:39]
    v_and_b32_dpp v24, v28, v6 row_newbcast:5 row_mask:0xf bank_mask:0xf
    v_and_b32_dpp v25, v28, v7 row_newbcast:5 row_mask:0xf bank_mask:0xf
    v_and_b32_dpp v26, v28, v8 row_newbcast:5 row_mask:0xf bank_mask:0xf
    v_and_b32_dpp v27, v28, v9 row_newbcast:5 row_mask:0xf bank_mask:0xf
    v_mfma_f32_16x16x32_bf16 v[36:39], v[20:23], v[112:115], v[36:39]
    v_and_b32_dpp v16, v28, v6 row_newbcast:6 row_mask:0xf bank_mask:0xf
    v_and_b32_dpp v17, v28, v7 row_newbcast:6 row_mask:0xf bank_mask:0xf
    v_and_b32_dpp v18, v28, v8 row_newbcast:6 row_mask:0xf bank_mask:0xf
    v_and_b32_dpp v19, v28, v9 row_newbcast:6 row_mask:0xf bank_mask:0xf
    v_mfma_f32_16x16x32_bf16 v[36:39], v[24:27], v[116:119], v[36:39]
    v_and_b32_dpp v20, v28, v6 row_newbcast:7 row_mask:0xf bank_mask:0xf
    v_and_b32_dpp v21, v28, v7 row_newbcast:7 row_mask:0xf bank_mask:0xf
    v_and_b32_dpp v22, v28, v8 row_newbcast:7 row_mask:0xf bank_mask:0xf
    v_and_b32_dpp v23, v28, v9 row_newbcast:7 row_mask:0xf bank_mask:0xf
    v_mfma_f32_16x16x32_bf16 v[36:39], v[16:19], v[120:123], v[36:39]
    v_and_b32_dpp v24, v28, v6 row_newbcast:8 row_mask:0xf bank_mask:0xf
    v_and_b32_dpp v25, v28, v7 row_newbcast:8 row_mask:0xf bank_mask:0xf
    v_and_b32_dpp v26, v28, v8 row_newbcast:8 row_mask:0xf bank_mask:0xf
    v_and_b32_dpp v27, v28, v9 row_newbcast:8 row_mask:0xf bank_mask:0xf
    v_mfma_f32_16x16x32_bf16 v[36:39], v[20:23], v[124:127], v[36:39]
    v_and_b32_dpp v16, v28, v6 row_newbcast:9 row_mask:0xf bank_mask:0xf
    v_and_b32_dpp v17, v28, v7 row_newbcast:9 row_mask:0xf bank_mask:0xf
    v_and_b32_dpp v18, v28, v8 row_newbcast:9 row_mask:0xf bank_mask:0xf
    v_and_b32_dpp v19, v28, v9 row_newbcast:9 row_mask:0xf bank_mask:0xf
    v_mfma_f32_16x16x32_bf16 v[36:39], v[24:27], v[128:131], v[36:39]
    v_and_b32_dpp v20, v28, v6 row_newbcast:10 row_mask:0xf bank_mask:0xf
    v_and_b32_dpp v21, v28, v7 row_newbcast:10 row_mask:0xf bank_mask:0xf
    v_and_b32_dpp v22, v28, v8 row_newbcast:10 row_mask:0xf bank_mask:0xf
    v_and_b32_dpp v23, v28, v9 row_newbcast:10 row_mask:0xf bank_mask:0xf
    v_mfma_f32_16x16x32_bf16 v[36:39], v[16:19], v[132:135], v[36:39]
    v_and_b32_dpp v24, v28, v6 row_newbcast:11 row_mask:0xf bank_mask:0xf
    v_and_b32_dpp v25, v28, v7 row_newbcast:11 row_mask:0xf bank_mask:0xf
    v_and_b32_dpp v26, v28, v8 row_newbcast:11 row_mask:0xf bank_mask:0xf
    v_and_b32_dpp v27, v28, v9 row_newbcast:11 row_mask:0xf bank_mask:0xf
    v_mfma_f32_16x16x32_bf16 v[36:39], v[20:23], v[136:139], v[36:39]
    v_and_b32_dpp v16, v28, v6 row_newbcast:12 row_mask:0xf bank_mask:0xf
    v_and_b32_dpp v17, v28, v7 row_newbcast:12 row_mask:0xf bank_mask:0xf
    v_and_b32_dpp v18, v28, v8 row_newbcast:12 row_mask:0xf bank_mask:0xf
    v_and_b32_dpp v19, v28, v9 row_newbcast:12 row_mask:0xf bank_mask:0xf
    v_mfma_f32_16x16x32_bf16 v[36:39], v[24:27], v[140:143], v[36:39]
    v_and_b32_dpp v20, v28, v6 row_newbcast:13 row_mask:0xf bank_mask:0xf
    v_and_b32_dpp v21, v28, v7 row_newbcast:13 row_mask:0xf bank_mask:0xf
    v_and_b32_dpp v22, v28, v8 row_newbcast:13 row_mask:0xf bank_mask:0xf
    v_and_b32_dpp v23, v28, v9 row_newbcast:13 row_mask:0xf bank_mask:0xf
    v_mfma_f32_16x16x32_bf16 v[36:39], v[16:19], v[144:147], v[36:39]
    v_and_b32_dpp v24, v28, v6 row_newbcast:14 row_mask:0xf bank_mask:0xf
    v_and_b32_dpp v25, v28, v7 row_newbcast:14 row_mask:0xf bank_mask:0xf
    v_and_b32_dpp v26, v28, v8 row_newbcast:14 row_mask:0xf bank_mask:0xf
    v_and_b32_dpp v27, v28, v9 row_newbcast:14 row_mask:0xf bank_mask:0xf
    v_mfma_f32_16x16x32_bf16 v[36:39], v[20:23], v[148:151], v[36:39]
    v_and_b32_dpp v16, v28, v6 row_newbcast:15 row_mask:0xf bank_mask:0xf
    v_and_b32_dpp v17, v28, v7 row_newbcast:15 row_mask:0xf bank_mask:0xf
    v_and_b32_dpp v18, v28, v8 row_newbcast:15 row_mask:0xf bank_mask:0xf
    v_and_b32_dpp v19, v28, v9 row_newbcast:15 row_mask:0xf bank_mask:0xf
    v_mfma_f32_16x16x32_bf16 v[36:39], v[24:27], v[152:155], v[36:39]
    v_and_b32_dpp v20, v29, v6 row_newbcast:0 row_mask:0xf bank_mask:0xf
    v_and_b32_dpp v21, v29, v7 row_newbcast:0 row_mask:0xf bank_mask:0xf
    v_and_b32_dpp v22, v29, v8 row_newbcast:0 row_mask:0xf bank_mask:0xf
    v_and_b32_dpp v23, v29, v9 row_newbcast:0 row_mask:0xf bank_mask:0xf
    v_mfma_f32_16x16x32_bf16 v[36:39], v[16:19], v[156:159], v[36:39]
    v_and_b32_dpp v24, v29, v6 row_newbcast:1 row_mask:0xf bank_mask:0xf
    v_and_b32_dpp v25, v29, v7 row_newbcast:1 row_mask:0xf bank_mask:0xf
    v_and_b32_dpp v26, v29, v8 row_newbcast:1 row_mask:0xf bank_mask:0xf
    v_and_b32_dpp v27, v29, v9 row_newbcast:1 row_mask:0xf bank_mask:0xf
    v_mfma_f32_16x16x32_bf16 v[36:39], v[20:23], v[160:163], v[36:39]
    v_and_b32_dpp v16, v29, v6 row_newbcast:2 row_mask:0xf bank_mask:0xf
    v_and_b32_dpp v17, v29, v7 row_newbcast:2 row_mask:0xf bank_mask:0xf
    v_and_b32_dpp v18, v29, v8 row_newbcast:2 row_mask:0xf bank_mask:0xf
    v_and_b32_dpp v19, v29, v9 row_newbcast:2 row_mask:0xf bank_mask:0xf
    v_mfma_f32_16x16x32_bf16 v[36:39], v[24:27], v[164:167], v[36:39]
    v_and_b32_dpp v20, v29, v6 row_newbcast:3 row_mask:0xf bank_mask:0xf
    v_and_b32_dpp v21, v29, v7 row_newbcast:3 row_mask:0xf bank_mask:0xf
    v_and_b32_dpp v22, v29, v8 row_newbcast:3 row_mask:0xf bank_mask:0xf
    v_and_b32_dpp v23, v29, v9 row_newbcast:3 row_mask:0xf bank_mask:0xf
    v_mfma_f32_16x16x32_bf16 v[36:39], v[16:19], v[168:171], v[36:39]
    v_and_b32_dpp v24, v29, v6 row_newbcast:4 row_mask:0xf bank_mask:0xf
    v_and_b32_dpp v25, v29, v7 row_newbcast:4 row_mask:0xf bank_mask:0xf
    v_and_b32_dpp v26, v29, v8 row_newbcast:4 row_mask:0xf bank_mask:0xf
    v_and_b32_dpp v27, v29, v9 row_newbcast:4 row_mask:0xf bank_mask:0xf
    v_mfma_f32_16x16x32_bf16 v[36:39], v[20:23], v[172:175], v[36:39]
    v_and_b32_dpp v16, v29, v6 row_newbcast:5 row_mask:0xf bank_mask:0xf
    v_and_b32_dpp v17, v29, v7 row_newbcast:5 row_mask:0xf bank_mask:0xf
    v_and_b32_dpp v18, v29, v8 row_newbcast:5 row_mask:0xf bank_mask:0xf
    v_and_b32_dpp v19, v29, v9 row_newbcast:5 row_mask:0xf bank_mask:0xf
    v_mfma_f32_16x16x32_bf16 v[36:39], v[24:27], v[176:179], v[36:39]
    v_and_b32_dpp v20, v29, v6 row_newbcast:6 row_mask:0xf bank_mask:0xf
    v_and_b32_dpp v21, v29, v7 row_newbcast:6 row_mask:0xf bank_mask:0xf
    v_and_b32_dpp v22, v29, v8 row_newbcast:6 row_mask:0xf bank_mask:0xf
    v_and_b32_dpp v23, v29, v9 row_newbcast:6 row_mask:0xf bank_mask:0xf
    v_mfma_f32_16x16x32_bf16 v[36:39], v[16:19], v[180:183], v[36:39]
    v_and_b32_dpp v24, v29, v6 row_newbcast:7 row_mask:0xf bank_mask:0xf
    v_and_b32_dpp v25, v29, v7 row_newbcast:7 row_mask:0xf bank_mask:0xf
    v_and_b32_dpp v26, v29, v8 row_newbcast:7 row_mask:0xf bank_mask:0xf
    v_and_b32_dpp v27, v29, v9 row_newbcast:7 row_mask:0xf bank_mask:0xf
    v_mfma_f32_16x16x32_bf16 v[36:39], v[20:23], v[184:187], v[36:39]
    v_and_b32_dpp v16, v29, v6 row_newbcast:8 row_mask:0xf bank_mask:0xf
    v_and_b32_dpp v17, v29, v7 row_newbcast:8 row_mask:0xf bank_mask:0xf
    v_and_b32_dpp v18, v29, v8 row_newbcast:8 row_mask:0xf bank_mask:0xf
    v_and_b32_dpp v19, v29, v9 row_newbcast:8 row_mask:0xf bank_mask:0xf
    v_mfma_f32_16x16x32_bf16 v[36:39], v[24:27], v[188:191], v[36:39]
    v_and_b32_dpp v20, v29, v6 row_newbcast:9 row_mask:0xf bank_mask:0xf
    v_and_b32_dpp v21, v29, v7 row_newbcast:9 row_mask:0xf bank_mask:0xf
    v_and_b32_dpp v22, v29, v8 row_newbcast:9 row_mask:0xf bank_mask:0xf
    v_and_b32_dpp v23, v29, v9 row_newbcast:9 row_mask:0xf bank_mask:0xf
    v_mfma_f32_16x16x32_bf16 v[36:39], v[16:19], v[192:195], v[36:39]
    v_and_b32_dpp v24, v29, v6 row_newbcast:10 row_mask:0xf bank_mask:0xf
    v_and_b32_dpp v25, v29, v7 row_newbcast:10 row_mask:0xf bank_mask:0xf
    v_and_b32_dpp v26, v29, v8 row_newbcast:10 row_mask:0xf bank_mask:0xf
    v_and_b32_dpp v27, v29, v9 row_newbcast:10 row_mask:0xf bank_mask:0xf
    v_mfma_f32_16x16x32_bf16 v[36:39], v[20:23], v[196:199], v[36:39]
    v_and_b32_dpp v16, v29, v6 row_newbcast:11 row_mask:0xf bank_mask:0xf
    v_and_b32_dpp v17, v29, v7 row_newbcast:11 row_mask:0xf bank_mask:0xf
    v_and_b32_dpp v18, v29, v8 row_newbcast:11 row_mask:0xf bank_mask:0xf
    v_and_b32_dpp v19, v29, v9 row_newbcast:11 row_mask:0xf bank_mask:0xf
    v_mfma_f32_16x16x32_bf16 v[36:39], v[24:27], v[200:203], v[36:39]
    v_and_b32_dpp v20, v29, v6 row_newbcast:12 row_mask:0xf bank_mask:0xf
    v_and_b32_dpp v21, v29, v7 row_newbcast:12 row_mask:0xf bank_mask:0xf
    v_and_b32_dpp v22, v29, v8 row_newbcast:12 row_mask:0xf bank_mask:0xf
    v_and_b32_dpp v23, v29, v9 row_newbcast:12 row_mask:0xf bank_mask:0xf
    v_mfma_f32_16x16x32_bf16 v[36:39], v[16:19], v[204:207], v[36:39]
    v_and_b32_dpp v24, v29, v6 row_newbcast:13 row_mask:0xf bank_mask:0xf
    v_and_b32_dpp v25, v29, v7 row_newbcast:13 row_mask:0xf bank_mask:0xf
    v_and_b32_dpp v26, v29, v8 row_newbcast:13 row_mask:0xf bank_mask:0xf
    v_and_b32_dpp v27, v29, v9 row_newbcast:13 row_mask:0xf bank_mask:0xf
    v_mfma_f32_16x16x32_bf16 v[36:39], v[20:23], v[208:211], v[36:39]
    v_and_b32_dpp v16, v29, v6 row_newbcast:14 row_mask:0xf bank_mask:0xf
    v_and_b32_dpp v17, v29, v7 row_newbcast:14 row_mask:0xf bank_mask:0xf
    v_and_b32_dpp v18, v29, v8 row_newbcast:14 row_mask:0xf bank_mask:0xf
    v_and_b32_dpp v19, v29, v9 row_newbcast:14 row_mask:0xf bank_mask:0xf
    v_mfma_f32_16x16x32_bf16 v[36:39], v[24:27], v[212:215], v[36:39]
    v_and_b32_dpp v20, v29, v6 row_newbcast:15 row_mask:0xf bank_mask:0xf
    v_and_b32_dpp v21, v29, v7 row_newbcast:15 row_mask:0xf bank_mask:0xf
    v_and_b32_dpp v22, v29, v8 row_newbcast:15 row_mask:0xf bank_mask:0xf
    v_and_b32_dpp v23, v29, v9 row_newbcast:15 row_mask:0xf bank_mask:0xf
    v_mfma_f32_16x16x32_bf16 v[36:39], v[16:19], v[216:219], v[36:39]
    s_nop 0
    v_mfma_f32_16x16x32_bf16 v[36:39], v[20:23], v[220:223], v[36:39]
    s_mov_b32 exec_hi, 0
    s_nop 6
    ds_write_b128 v35, v[36:39] offset:2048
    s_mov_b64 exec, -1
    s_mov_b32 s7, 8192
    s_waitcnt vmcnt(1)
    buffer_load_dwordx4 v[48:51], v31, s[56:59], s7 offen
    s_mov_b32 s7, 12288
    s_waitcnt vmcnt(1)
    buffer_load_dwordx4 v[52:55], v31, s[56:59], s7 offen
    s_mov_b32 s7, 16384
    s_waitcnt vmcnt(1)
    buffer_load_dwordx4 v[56:59], v31, s[56:59], s7 offen
    s_mov_b32 s7, 20480
    s_waitcnt vmcnt(1)
    buffer_load_dwordx4 v[60:63], v31, s[56:59], s7 offen
    s_mov_b32 s7, 24576
    s_waitcnt vmcnt(1)
    buffer_load_dwordx4 v[64:67], v31, s[56:59], s7 offen
    s_mov_b32 s7, 28672
    s_waitcnt vmcnt(1)
    buffer_load_dwordx4 v[68:71], v31, s[56:59], s7 offen
    s_mov_b32 s7, 32768
    s_waitcnt vmcnt(1)
    buffer_load_dwordx4 v[72:75], v31, s[56:59], s7 offen
    s_mov_b32 s7, 36864
    s_waitcnt vmcnt(1)
    buffer_load_dwordx4 v[76:79], v31, s[56:59], s7 offen
    s_mov_b32 s7, 40960
    s_waitcnt vmcnt(1)
    buffer_load_dwordx4 v[80:83], v31, s[56:59], s7 offen
    s_mov_b32 s7, 45056
    s_waitcnt vmcnt(1)
    buffer_load_dwordx4 v[84:87], v31, s[56:59], s7 offen
    s_mov_b32 s7, 49152
    s_waitcnt vmcnt(1)
    buffer_load_dwordx4 v[88:91], v31, s[56:59], s7 offen
    s_mov_b32 s7, 53248
    s_waitcnt vmcnt(1)
    buffer_load_dwordx4 v[92:95], v31, s[56:59], s7 offen
    s_mov_b32 s7, 57344
    s_waitcnt vmcnt(1)
    buffer_load_dwordx4 v[248:251], v31, s[56:59], s7 offen
    s_mov_b32 s7, 61440
    s_waitcnt vmcnt(1)
    buffer_load_dwordx4 v[252:255], v31, s[56:59], s7 offen
    s_waitcnt vmcnt(0)
L_noffn1:
    s_nop 1
    v_lshlrev_b32 v33, 4, v2
    buffer_load_dwordx4 v[224:227], v33, s[12:15], 0 offen
    buffer_load_dwordx4 v[228:231], v33, s[68:71], 0 offen
    s_waitcnt vmcnt(1)
    buffer_load_dwordx4 v[232:235], v33, s[72:75], 0 offen
    v_and_b32 v33, 3, v2
    s_lshl_b32 s7, s3, 4
    s_lshl_b32 s94, s5, 2
    s_add_u32 s7, s7, s94
    v_add_u32 v33, s7, v33
    v_lshlrev_b32 v236, 1, v33
    s_waitcnt vmcnt(1)
    buffer_load_ushort v237, v236, s[12:15], 0 offen
    s_waitcnt vmcnt(0)
    v_lshlrev_b32 v240, 16, v224
    v_and_b32 v241, s92, v224
    v_lshlrev_b32 v242, 16, v228
    v_and_b32 v243, s92, v228
    v_mul_f32 v240, v240, v242
    v_mul_f32 v241, v241, v243
    v_cvt_pk_bf16_f32 v240, v240, v241
    v_and_b32 v241, s92, v240
    v_lshlrev_b32 v240, 16, v240
    v_add_f32 v238, v240, v241
    v_lshlrev_b32 v240, 16, v225
    v_and_b32 v241, s92, v225
    v_lshlrev_b32 v242, 16, v229
    v_and_b32 v243, s92, v229
    v_mul_f32 v240, v240, v242
    v_mul_f32 v241, v241, v243
    v_cvt_pk_bf16_f32 v240, v240, v241
    v_and_b32 v241, s92, v240
    v_lshlrev_b32 v240, 16, v240
    v_add_f32 v238, v238, v240
    v_add_f32 v238, v238, v241
    v_lshlrev_b32 v240, 16, v226
    v_and_b32 v241, s92, v226
    v_lshlrev_b32 v242, 16, v230
    v_and_b32 v243, s92, v230
    v_mul_f32 v240, v240, v242
    v_mul_f32 v241, v241, v243
    v_cvt_pk_bf16_f32 v240, v240, v241
    v_and_b32 v241, s92, v240
    v_lshlrev_b32 v240, 16, v240
    v_add_f32 v238, v238, v240
    v_add_f32 v238, v238, v241
    v_lshlrev_b32 v240, 16, v227
    v_and_b32 v241, s92, v227
    v_lshlrev_b32 v242, 16, v231
    v_and_b32 v243, s92, v231
    v_mul_f32 v240, v240, v242
    v_mul_f32 v241, v241, v243
    v_cvt_pk_bf16_f32 v240, v240, v241
    v_and_b32 v241, s92, v240
    v_lshlrev_b32 v240, 16, v240
    v_add_f32 v238, v238, v240
    v_add_f32 v238, v238, v241
    v_dot2_f32_bf16 v239, v224, v232, 0
    v_dot2_f32_bf16 v239, v225, v233, v239
    v_dot2_f32_bf16 v239, v226, v234, v239
    v_dot2_f32_bf16 v239, v227, v235, v239
    v_add_f32_dpp v238, v238, v238 row_ror:8 row_mask:0xf bank_mask:0xf
    s_nop 1
    v_add_f32_dpp v238, v238, v238 row_ror:4 row_mask:0xf bank_mask:0xf
    s_nop 1
    v_add_f32_dpp v238, v238, v238 row_ror:2 row_mask:0xf bank_mask:0xf
    s_nop 1
    v_add_f32_dpp v238, v238, v238 row_ror:1 row_mask:0xf bank_mask:0xf
    v_mov_b32 v240, v238
    s_nop 1
    v_permlane16_swap_b32 v238, v240
    v_add_f32 v238, v238, v240
    v_mov_b32 v240, v238
    s_nop 1
    v_permlane32_swap_b32 v238, v240
    v_add_f32 v238, v238, v240
    v_add_f32_dpp v239, v239, v239 row_ror:8 row_mask:0xf bank_mask:0xf
    s_nop 1
    v_add_f32_dpp v239, v239, v239 row_ror:4 row_mask:0xf bank_mask:0xf
    s_nop 1
    v_add_f32_dpp v239, v239, v239 row_ror:2 row_mask:0xf bank_mask:0xf
    s_nop 1
    v_add_f32_dpp v239, v239, v239 row_ror:1 row_mask:0xf bank_mask:0xf
    v_mov_b32 v240, v239
    s_nop 1
    v_permlane16_swap_b32 v239, v240
    v_add_f32 v239, v239, v240
    v_mov_b32 v240, v239
    s_nop 1
    v_permlane32_swap_b32 v239, v240
    v_add_f32 v239, v239, v240
    v_cvt_pk_bf16_f32 v238, v238, v238
    v_and_b32 v238, s92, v238
    v_mul_f32 v238, 0xbfb8aa3b, v238
    v_exp_f32 v238, v238
    s_nop 0
    v_add_f32 v238, 1.0, v238
    v_rcp_f32 v238, v238
    s_nop 0
    v_cvt_pk_bf16_f32 v238, v238, v238
    v_and_b32 v238, s92, v238
    v_cvt_pk_bf16_f32 v239, v239, v239
    v_and_b32 v239, s92, v239
    v_mul_f32 v239, 0xbfb8aa3b, v239
    v_exp_f32 v239, v239
    s_nop 0
    v_add_f32 v239, 1.0, v239
    v_rcp_f32 v239, v239
    s_nop 0
    v_cvt_pk_bf16_f32 v239, v239, v239
    v_and_b32 v239, s92, v239
    v_lshlrev_b32 v237, 16, v237
    v_sub_f32 v243, 1.0, v238
    v_cvt_pk_bf16_f32 v235, v243, v243
    v_and_b32 v235, s92, v235
    s_lshl_b32 s7, s4, 10
    v_add_u32 v236, s7, v236
    s_cmp_lg_u32 s5, 0
    s_cbranch_scc1 L_tag_done
    v_mov_b32 v33, 0
    s_mov_b32 s95, 1048576
    s_mov_b64 exec, 1
L_tag_poll:
    buffer_load_dwordx2 v[12:13], v33, s[76:79], 0 offen sc1
    s_waitcnt vmcnt(0)
    v_min_u32 v34, v12, v13
    v_cmp_eq_u32 vcc, 0, v34
    s_sub_u32 s95, s95, 1
    s_cmp_eq_u32 s95, 0
    s_cbranch_scc1 L_tag_got
    s_cbranch_vccz L_tag_got
    s_sleep 8
    s_branch L_tag_poll
L_tag_got:
    ds_write_b64 v33, v[12:13] offset:4160
    s_mov_b64 exec, -1
L_tag_done:
    s_nop 1
    s_waitcnt lgkmcnt(0)
    s_barrier
    v_mov_b32 v33, 0
    ds_read_b64 v[232:233], v33 offset:4160
    v_mov_b32 v36, 0
    v_mov_b32 v37, 0
    v_mov_b32 v38, 0
    v_mov_b32 v39, 0
    s_cmp_ge_u32 s3, 28
    s_cbranch_scc1 L_ffn2
    v_lshl_add_u32 v33, v3, 2, v4
    v_lshlrev_b32 v33, 2, v33
    v_add_u32 v34, 2048, v33
    ds_read2_b32 v[240:241], v34 offset0:0 offset1:64
    ds_read2_b32 v[242:243], v34 offset0:128 offset1:192
    v_add_u32 v34, 1024, v34
    ds_read2_b32 v[244:245], v34 offset0:0 offset1:64
    ds_read2_b32 v[246:247], v34 offset0:128 offset1:192
    s_waitcnt lgkmcnt(0)
    v_add_f32 v240, v240, v242
    v_add_f32 v244, v244, v246
    v_add_f32 v241, v241, v243
    v_add_f32 v245, v245, v247
    v_add_f32 v240, v240, v244
    v_add_f32 v241, v241, v245
    v_cvt_pk_bf16_f32 v240, v240, v240
    v_and_b32 v240, s92, v240
    v_cvt_pk_bf16_f32 v241, v241, v241
    v_and_b32 v241, s92, v241
    v_mul_f32 v242, 0xbfb8aa3b, v240
    v_exp_f32 v242, v242
    s_nop 0
    v_add_f32 v242, 1.0, v242
    v_rcp_f32 v242, v242
    s_nop 0
    v_mul_f32 v242, v240, v242
    v_cvt_pk_bf16_f32 v242, v242, v242
    v_and_b32 v242, s92, v242
    v_mul_f32 v242, v242, v241
    v_cvt_pk_bf16_f32 v242, v242, v242
    s_nop 1
    v_and_b32_dpp v16, v242, v6 row_newbcast:0 row_mask:0xf bank_mask:0xf
    v_and_b32_dpp v17, v242, v7 row_newbcast:0 row_mask:0xf bank_mask:0xf
    v_and_b32_dpp v18, v242, v8 row_newbcast:0 row_mask:0xf bank_mask:0xf
    v_and_b32_dpp v19, v242, v9 row_newbcast:0 row_mask:0xf bank_mask:0xf
    v_and_b32_dpp v20, v242, v6 row_newbcast:1 row_mask:0xf bank_mask:0xf
    v_and_b32_dpp v21, v242, v7 row_newbcast:1 row_mask:0xf bank_mask:0xf
    v_and_b32_dpp v22, v242, v8 row_newbcast:1 row_mask:0xf bank_mask:0xf
    v_and_b32_dpp v23, v242, v9 row_newbcast:1 row_mask:0xf bank_mask:0xf
    v_mfma_f32_16x16x32_bf16 v[36:39], v[40:43], v[16:19], 0
    v_and_b32_dpp v24, v242, v6 row_newbcast:2 row_mask:0xf bank_mask:0xf
    v_and_b32_dpp v25, v242, v7 row_newbcast:2 row_mask:0xf bank_mask:0xf
    v_and_b32_dpp v26, v242, v8 row_newbcast:2 row_mask:0xf bank_mask:0xf
    v_and_b32_dpp v27, v242, v9 row_newbcast:2 row_mask:0xf bank_mask:0xf
    v_mfma_f32_16x16x32_bf16 v[36:39], v[44:47], v[20:23], v[36:39]
    v_and_b32_dpp v16, v242, v6 row_newbcast:3 row_mask:0xf bank_mask:0xf
    v_and_b32_dpp v17, v242, v7 row_newbcast:3 row_mask:0xf bank_mask:0xf
    v_and_b32_dpp v18, v242, v8 row_newbcast:3 row_mask:0xf bank_mask:0xf
    v_and_b32_dpp v19, v242, v9 row_newbcast:3 row_mask:0xf bank_mask:0xf
    v_mfma_f32_16x16x32_bf16 v[36:39], v[48:51], v[24:27], v[36:39]
    v_and_b32_dpp v20, v242, v6 row_newbcast:4 row_mask:0xf bank_mask:0xf
    v_and_b32_dpp v21, v242, v7 row_newbcast:4 row_mask:0xf bank_mask:0xf
    v_and_b32_dpp v22, v242, v8 row_newbcast:4 row_mask:0xf bank_mask:0xf
    v_and_b32_dpp v23, v242, v9 row_newbcast:4 row_mask:0xf bank_mask:0xf
    v_mfma_f32_16x16x32_bf16 v[36:39], v[52:55], v[16:19], v[36:39]
    v_and_b32_dpp v24, v242, v6 row_newbcast:5 row_mask:0xf bank_mask:0xf
    v_and_b32_dpp v25, v242, v7 row_newbcast:5 row_mask:0xf bank_mask:0xf
    v_and_b32_dpp v26, v242, v8 row_newbcast:5 row_mask:0xf bank_mask:0xf
    v_and_b32_dpp v27, v242, v9 row_newbcast:5 row_mask:0xf bank_mask:0xf
    v_mfma_f32_16x16x32_bf16 v[36:39], v[56:59], v[20:23], v[36:39]
    v_and_b32_dpp v16, v242, v6 row_newbcast:6 row_mask:0xf bank_mask:0xf
    v_and_b32_dpp v17, v242, v7 row_newbcast:6 row_mask:0xf bank_mask:0xf
    v_and_b32_dpp v18, v242, v8 row_newbcast:6 row_mask:0xf bank_mask:0xf
    v_and_b32_dpp v19, v242, v9 row_newbcast:6 row_mask:0xf bank_mask:0xf
    v_mfma_f32_16x16x32_bf16 v[36:39], v[60:63], v[24:27], v[36:39]
    v_and_b32_dpp v20, v242, v6 row_newbcast:7 row_mask:0xf bank_mask:0xf
    v_and_b32_dpp v21, v242, v7 row_newbcast:7 row_mask:0xf bank_mask:0xf
    v_and_b32_dpp v22, v242, v8 row_newbcast:7 row_mask:0xf bank_mask:0xf
    v_and_b32_dpp v23, v242, v9 row_newbcast:7 row_mask:0xf bank_mask:0xf
    v_mfma_f32_16x16x32_bf16 v[36:39], v[64:67], v[16:19], v[36:39]
    v_and_b32_dpp v24, v242, v6 row_newbcast:8 row_mask:0xf bank_mask:0xf
    v_and_b32_dpp v25, v242, v7 row_newbcast:8 row_mask:0xf bank_mask:0xf
    v_and_b32_dpp v26, v242, v8 row_newbcast:8 row_mask:0xf bank_mask:0xf
    v_and_b32_dpp v27, v242, v9 row_newbcast:8 row_mask:0xf bank_mask:0xf
    v_mfma_f32_16x16x32_bf16 v[36:39], v[68:71], v[20:23], v[36:39]
    v_and_b32_dpp v16, v242, v6 row_newbcast:9 row_mask:0xf bank_mask:0xf
    v_and_b32_dpp v17, v242, v7 row_newbcast:9 row_mask:0xf bank_mask:0xf
    v_and_b32_dpp v18, v242, v8 row_newbcast:9 row_mask:0xf bank_mask:0xf
    v_and_b32_dpp v19, v242, v9 row_newbcast:9 row_mask:0xf bank_mask:0xf
    v_mfma_f32_16x16x32_bf16 v[36:39], v[72:75], v[24:27], v[36:39]
    v_and_b32_dpp v20, v242, v6 row_newbcast:10 row_mask:0xf bank_mask:0xf
    v_and_b32_dpp v21, v242, v7 row_newbcast:10 row_mask:0xf bank_mask:0xf
    v_and_b32_dpp v22, v242, v8 row_newbcast:10 row_mask:0xf bank_mask:0xf
    v_and_b32_dpp v23, v242, v9 row_newbcast:10 row_mask:0xf bank_mask:0xf
    v_mfma_f32_16x16x32_bf16 v[36:39], v[76:79], v[16:19], v[36:39]
    v_and_b32_dpp v24, v242, v6 row_newbcast:11 row_mask:0xf bank_mask:0xf
    v_and_b32_dpp v25, v242, v7 row_newbcast:11 row_mask:0xf bank_mask:0xf
    v_and_b32_dpp v26, v242, v8 row_newbcast:11 row_mask:0xf bank_mask:0xf
    v_and_b32_dpp v27, v242, v9 row_newbcast:11 row_mask:0xf bank_mask:0xf
    v_mfma_f32_16x16x32_bf16 v[36:39], v[80:83], v[20:23], v[36:39]
    v_and_b32_dpp v16, v242, v6 row_newbcast:12 row_mask:0xf bank_mask:0xf
    v_and_b32_dpp v17, v242, v7 row_newbcast:12 row_mask:0xf bank_mask:0xf
    v_and_b32_dpp v18, v242, v8 row_newbcast:12 row_mask:0xf bank_mask:0xf
    v_and_b32_dpp v19, v242, v9 row_newbcast:12 row_mask:0xf bank_mask:0xf
    v_mfma_f32_16x16x32_bf16 v[36:39], v[84:87], v[24:27], v[36:39]
    v_and_b32_dpp v20, v242, v6 row_newbcast:13 row_mask:0xf bank_mask:0xf
    v_and_b32_dpp v21, v242, v7 row_newbcast:13 row_mask:0xf bank_mask:0xf
    v_and_b32_dpp v22, v242, v8 row_newbcast:13 row_mask:0xf bank_mask:0xf
    v_and_b32_dpp v23, v242, v9 row_newbcast:13 row_mask:0xf bank_mask:0xf
    v_mfma_f32_16x16x32_bf16 v[36:39], v[88:91], v[16:19], v[36:39]
    v_and_b32_dpp v24, v242, v6 row_newbcast:14 row_mask:0xf bank_mask:0xf
    v_and_b32_dpp v25, v242, v7 row_newbcast:14 row_mask:0xf bank_mask:0xf
    v_and_b32_dpp v26, v242, v8 row_newbcast:14 row_mask:0xf bank_mask:0xf
    v_and_b32_dpp v27, v242, v9 row_newbcast:14 row_mask:0xf bank_mask:0xf
    v_mfma_f32_16x16x32_bf16 v[36:39], v[92:95], v[20:23], v[36:39]
    v_and_b32_dpp v16, v242, v6 row_newbcast:15 row_mask:0xf bank_mask:0xf
    v_and_b32_dpp v17, v242, v7 row_newbcast:15 row_mask:0xf bank_mask:0xf
    v_and_b32_dpp v18, v242, v8 row_newbcast:15 row_mask:0xf bank_mask:0xf
    v_and_b32_dpp v19, v242, v9 row_newbcast:15 row_mask:0xf bank_mask:0xf
    v_mfma_f32_16x16x32_bf16 v[36:39], v[248:251], v[24:27], v[36:39]
    s_nop 0
    v_mfma_f32_16x16x32_bf16 v[36:39], v[252:255], v[16:19], v[36:39]
L_ffn2:
    s_nop 7
    s_waitcnt lgkmcnt(0)
    v_mov_b32 v225, v36
    s_nop 1
    v_mov_b32_dpp v225, v37 row_shr:8 row_mask:0xf bank_mask:0xc
    v_xor_b32 v227, v225, v233
    v_mov_b32 v229, v38
    s_nop 1
    v_mov_b32_dpp v229, v39 row_shr:8 row_mask:0xf bank_mask:0xc
    v_xor_b32 v231, v229, v233
    v_lshlrev_b32 v32, 4, v2
    s_lshl_b32 s7, s2, 13
    s_lshl_b32 s94, s5, 11
    s_add_u32 s7, s7, s94
    v_add_u32 v32, s7, v32
    v_lshlrev_b32 v31, 15, v4
    v_lshl_add_u32 v31, v3, 4, v31
    s_lshl_b32 s7, s5, 8
    v_add_u32 v31, s7, v31
    buffer_load_dwordx4 v[96:99], v31, s[60:63], 0 offen
    s_mov_b32 s7, 1024
    buffer_load_dwordx4 v[100:103], v31, s[60:63], s7 offen
    s_mov_b32 s7, 2048
    s_waitcnt vmcnt(1)
    buffer_load_dwordx4 v[104:107], v31, s[60:63], s7 offen
    s_mov_b32 s7, 3072
    s_waitcnt vmcnt(1)
    buffer_load_dwordx4 v[108:111], v31, s[60:63], s7 offen
    s_mov_b32 s7, 4096
    s_waitcnt vmcnt(1)
    buffer_load_dwordx4 v[112:115], v31, s[60:63], s7 offen
    s_mov_b32 s7, 5120
    s_waitcnt vmcnt(1)
    buffer_load_dwordx4 v[116:119], v31, s[60:63], s7 offen
    s_mov_b32 s7, 6144
    s_waitcnt vmcnt(1)
    buffer_load_dwordx4 v[120:123], v31, s[60:63], s7 offen
    s_mov_b32 s7, 7168
    s_waitcnt vmcnt(1)
    buffer_load_dwordx4 v[124:127], v31, s[60:63], s7 offen
    s_mov_b32 s7, 8192
    s_waitcnt vmcnt(1)
    buffer_load_dwordx4 v[128:131], v31, s[60:63], s7 offen
    s_mov_b32 s7, 9216
    s_waitcnt vmcnt(1)
    buffer_load_dwordx4 v[132:135], v31, s[60:63], s7 offen
    s_mov_b32 s7, 10240
    s_waitcnt vmcnt(1)
    buffer_load_dwordx4 v[136:139], v31, s[60:63], s7 offen
    s_mov_b32 s7, 11264
    s_waitcnt vmcnt(1)
    buffer_load_dwordx4 v[140:143], v31, s[60:63], s7 offen
    s_mov_b32 s7, 12288
    s_waitcnt vmcnt(1)
    buffer_load_dwordx4 v[144:147], v31, s[60:63], s7 offen
    s_mov_b32 s7, 13312
    s_waitcnt vmcnt(1)
    buffer_load_dwordx4 v[148:151], v31, s[60:63], s7 offen
    s_mov_b32 s7, 14336
    s_waitcnt vmcnt(1)
    buffer_load_dwordx4 v[152:155], v31, s[60:63], s7 offen
    s_mov_b32 s7, 15360
    s_waitcnt vmcnt(1)
    buffer_load_dwordx4 v[156:159], v31, s[60:63], s7 offen
    s_mov_b32 s7, 16384
    s_waitcnt vmcnt(1)
    buffer_load_dwordx4 v[160:163], v31, s[60:63], s7 offen
    s_mov_b32 s7, 17408
    s_waitcnt vmcnt(1)
    buffer_load_dwordx4 v[164:167], v31, s[60:63], s7 offen
    s_mov_b32 s7, 18432
    s_waitcnt vmcnt(1)
    buffer_load_dwordx4 v[168:171], v31, s[60:63], s7 offen
    s_mov_b32 s7, 19456
    s_waitcnt vmcnt(1)
    buffer_load_dwordx4 v[172:175], v31, s[60:63], s7 offen
    s_mov_b32 s7, 20480
    s_waitcnt vmcnt(1)
    buffer_load_dwordx4 v[176:179], v31, s[60:63], s7 offen
    s_mov_b32 s7, 21504
    s_waitcnt vmcnt(1)
    buffer_load_dwordx4 v[180:183], v31, s[60:63], s7 offen
    s_mov_b32 s7, 22528
    s_waitcnt vmcnt(1)
    buffer_load_dwordx4 v[184:187], v31, s[60:63], s7 offen
    s_mov_b32 s7, 23552
    s_waitcnt vmcnt(1)
    buffer_load_dwordx4 v[188:191], v31, s[60:63], s7 offen
    s_mov_b32 s7, 24576
    s_waitcnt vmcnt(1)
    buffer_load_dwordx4 v[192:195], v31, s[60:63], s7 offen
    s_mov_b32 s7, 25600
    s_waitcnt vmcnt(1)
    buffer_load_dwordx4 v[196:199], v31, s[60:63], s7 offen
    s_mov_b32 s7, 26624
    s_waitcnt vmcnt(1)
    buffer_load_dwordx4 v[200:203], v31, s[60:63], s7 offen
    s_mov_b32 s7, 27648
    s_waitcnt vmcnt(1)
    buffer_load_dwordx4 v[204:207], v31, s[60:63], s7 offen
    s_mov_b32 s7, 28672
    s_waitcnt vmcnt(1)
    buffer_load_dwordx4 v[208:211], v31, s[60:63], s7 offen
    s_mov_b32 s7, 29696
    s_waitcnt vmcnt(1)
    buffer_load_dwordx4 v[212:215], v31, s[60:63], s7 offen
    s_mov_b32 s7, 30720
    s_waitcnt vmcnt(1)
    buffer_load_dwordx4 v[216:219], v31, s[60:63], s7 offen
    s_mov_b32 s7, 31744
    s_waitcnt vmcnt(1)
    buffer_load_dwordx4 v[220:223], v31, s[60:63], s7 offen
    v_lshrrev_b32 v30, 2, v2
    v_lshlrev_b32 v30, 13, v30
    v_and_b32 v33, 3, v2
    v_lshl_add_u32 v30, v33, 4, v30
    s_lshl_b32 s7, s4, 18
    s_lshr_b32 s94, s3, 3
    s_lshl_b32 s94, s94, 11
    s_add_u32 s7, s7, s94
    s_and_b32 s94, s3, 1
    s_lshl_b32 s94, s94, 10
    s_add_u32 s7, s7, s94
    s_bfe_u32 s94, s3, 0x20001
    s_lshl_b32 s94, s94, 8
    s_add_u32 s7, s7, s94
    s_lshl_b32 s94, s5, 6
    s_add_u32 s7, s7, s94
    v_add_u32 v30, s7, v30
    s_mov_b32 s96, 0x20000
    v_lshlrev_b32 v33, 3, v2
    s_mov_b32 s95, 1048576
    s_waitcnt vmcnt(0)
    s_barrier
    ds_read_b64 v[244:245], v33 offset:4608
    ds_read_b64 v[246:247], v33 offset:5120
    ds_read_b64 v[248:249], v33 offset:5632
    ds_read_b64 v[250:251], v33 offset:6144
    s_waitcnt lgkmcnt(0)
    v_add_f32 v244, v244, v246
    v_add_f32 v248, v248, v250
    v_add_f32 v245, v245, v247
    v_add_f32 v249, v249, v251
    v_add_f32 v244, v244, v248
    v_add_f32 v245, v245, v249
    v_cvt_pk_bf16_f32 v28, v244, v244
    v_cvt_pk_bf16_f32 v29, v245, v245
    s_nop 0
    v_and_b32_dpp v16, v28, v6 row_newbcast:0 row_mask:0xf bank_mask:0xf
    v_and_b32_dpp v17, v28, v7 row_newbcast:0 row_mask:0xf bank_mask:0xf
    v_and_b32_dpp v18, v28, v8 row_newbcast:0 row_mask:0xf bank_mask:0xf
    v_and_b32_dpp v19, v28, v9 row_newbcast:0 row_mask:0xf bank_mask:0xf
    v_and_b32_dpp v20, v29, v6 row_newbcast:0 row_mask:0xf bank_mask:0xf
    v_and_b32_dpp v21, v29, v7 row_newbcast:0 row_mask:0xf bank_mask:0xf
    v_and_b32_dpp v22, v29, v8 row_newbcast:0 row_mask:0xf bank_mask:0xf
    v_and_b32_dpp v23, v29, v9 row_newbcast:0 row_mask:0xf bank_mask:0xf
    v_mfma_f32_16x16x32_bf16 v[36:39], v[96:99], v[16:19], 0
    v_and_b32_dpp v24, v28, v6 row_newbcast:1 row_mask:0xf bank_mask:0xf
    v_and_b32_dpp v25, v28, v7 row_newbcast:1 row_mask:0xf bank_mask:0xf
    v_and_b32_dpp v26, v28, v8 row_newbcast:1 row_mask:0xf bank_mask:0xf
    v_and_b32_dpp v27, v28, v9 row_newbcast:1 row_mask:0xf bank_mask:0xf
    v_mfma_f32_16x16x32_bf16 v[36:39], v[100:103], v[20:23], v[36:39]
    v_and_b32_dpp v16, v29, v6 row_newbcast:1 row_mask:0xf bank_mask:0xf
    v_and_b32_dpp v17, v29, v7 row_newbcast:1 row_mask:0xf bank_mask:0xf
    v_and_b32_dpp v18, v29, v8 row_newbcast:1 row_mask:0xf bank_mask:0xf
    v_and_b32_dpp v19, v29, v9 row_newbcast:1 row_mask:0xf bank_mask:0xf
    v_mfma_f32_16x16x32_bf16 v[36:39], v[104:107], v[24:27], v[36:39]
    v_and_b32_dpp v20, v28, v6 row_newbcast:2 row_mask:0xf bank_mask:0xf
    v_and_b32_dpp v21, v28, v7 row_newbcast:2 row_mask:0xf bank_mask:0xf
    v_and_b32_dpp v22, v28, v8 row_newbcast:2 row_mask:0xf bank_mask:0xf
    v_and_b32_dpp v23, v28, v9 row_newbcast:2 row_mask:0xf bank_mask:0xf
    v_mfma_f32_16x16x32_bf16 v[36:39], v[108:111], v[16:19], v[36:39]
    v_and_b32_dpp v24, v29, v6 row_newbcast:2 row_mask:0xf bank_mask:0xf
    v_and_b32_dpp v25, v29, v7 row_newbcast:2 row_mask:0xf bank_mask:0xf
    v_and_b32_dpp v26, v29, v8 row_newbcast:2 row_mask:0xf bank_mask:0xf
    v_and_b32_dpp v27, v29, v9 row_newbcast:2 row_mask:0xf bank_mask:0xf
    v_mfma_f32_16x16x32_bf16 v[36:39], v[112:115], v[20:23], v[36:39]
    v_and_b32_dpp v16, v28, v6 row_newbcast:3 row_mask:0xf bank_mask:0xf
    v_and_b32_dpp v17, v28, v7 row_newbcast:3 row_mask:0xf bank_mask:0xf
    v_and_b32_dpp v18, v28, v8 row_newbcast:3 row_mask:0xf bank_mask:0xf
    v_and_b32_dpp v19, v28, v9 row_newbcast:3 row_mask:0xf bank_mask:0xf
    v_mfma_f32_16x16x32_bf16 v[36:39], v[116:119], v[24:27], v[36:39]
    v_and_b32_dpp v20, v29, v6 row_newbcast:3 row_mask:0xf bank_mask:0xf
    v_and_b32_dpp v21, v29, v7 row_newbcast:3 row_mask:0xf bank_mask:0xf
    v_and_b32_dpp v22, v29, v8 row_newbcast:3 row_mask:0xf bank_mask:0xf
    v_and_b32_dpp v23, v29, v9 row_newbcast:3 row_mask:0xf bank_mask:0xf
    v_mfma_f32_16x16x32_bf16 v[36:39], v[120:123], v[16:19], v[36:39]
    v_and_b32_dpp v24, v28, v6 row_newbcast:4 row_mask:0xf bank_mask:0xf
    v_and_b32_dpp v25, v28, v7 row_newbcast:4 row_mask:0xf bank_mask:0xf
    v_and_b32_dpp v26, v28, v8 row_newbcast:4 row_mask:0xf bank_mask:0xf
    v_and_b32_dpp v27, v28, v9 row_newbcast:4 row_mask:0xf bank_mask:0xf
    v_mfma_f32_16x16x32_bf16 v[36:39], v[124:127], v[20:23], v[36:39]
    v_and_b32_dpp v16, v29, v6 row_newbcast:4 row_mask:0xf bank_mask:0xf
    v_and_b32_dpp v17, v29, v7 row_newbcast:4 row_mask:0xf bank_mask:0xf
    v_and_b32_dpp v18, v29, v8 row_newbcast:4 row_mask:0xf bank_mask:0xf
    v_and_b32_dpp v19, v29, v9 row_newbcast:4 row_mask:0xf bank_mask:0xf
    v_mfma_f32_16x16x32_bf16 v[36:39], v[128:131], v[24:27], v[36:39]
    v_and_b32_dpp v20, v28, v6 row_newbcast:5 row_mask:0xf bank_mask:0xf
    v_and_b32_dpp v21, v28, v7 row_newbcast:5 row_mask:0xf bank_mask:0xf
    v_and_b32_dpp v22, v28, v8 row_newbcast:5 row_mask:0xf bank_mask:0xf
    v_and_b32_dpp v23, v28, v9 row_newbcast:5 row_mask:0xf bank_mask:0xf
    v_mfma_f32_16x16x32_bf16 v[36:39], v[132:135], v[16:19], v[36:39]
    v_and_b32_dpp v24, v29, v6 row_newbcast:5 row_mask:0xf bank_mask:0xf
    v_and_b32_dpp v25, v29, v7 row_newbcast:5 row_mask:0xf bank_mask:0xf
    v_and_b32_dpp v26, v29, v8 row_newbcast:5 row_mask:0xf bank_mask:0xf
    v_and_b32_dpp v27, v29, v9 row_newbcast:5 row_mask:0xf bank_mask:0xf
    v_mfma_f32_16x16x32_bf16 v[36:39], v[136:139], v[20:23], v[36:39]
    v_and_b32_dpp v16, v28, v6 row_newbcast:6 row_mask:0xf bank_mask:0xf
    v_and_b32_dpp v17, v28, v7 row_newbcast:6 row_mask:0xf bank_mask:0xf
    v_and_b32_dpp v18, v28, v8 row_newbcast:6 row_mask:0xf bank_mask:0xf
    v_and_b32_dpp v19, v28, v9 row_newbcast:6 row_mask:0xf bank_mask:0xf
    v_mfma_f32_16x16x32_bf16 v[36:39], v[140:143], v[24:27], v[36:39]
    v_and_b32_dpp v20, v29, v6 row_newbcast:6 row_mask:0xf bank_mask:0xf
    v_and_b32_dpp v21, v29, v7 row_newbcast:6 row_mask:0xf bank_mask:0xf
    v_and_b32_dpp v22, v29, v8 row_newbcast:6 row_mask:0xf bank_mask:0xf
    v_and_b32_dpp v23, v29, v9 row_newbcast:6 row_mask:0xf bank_mask:0xf
    v_mfma_f32_16x16x32_bf16 v[36:39], v[144:147], v[16:19], v[36:39]
    v_and_b32_dpp v24, v28, v6 row_newbcast:7 row_mask:0xf bank_mask:0xf
    v_and_b32_dpp v25, v28, v7 row_newbcast:7 row_mask:0xf bank_mask:0xf
    v_and_b32_dpp v26, v28, v8 row_newbcast:7 row_mask:0xf bank_mask:0xf
    v_and_b32_dpp v27, v28, v9 row_newbcast:7 row_mask:0xf bank_mask:0xf
    v_mfma_f32_16x16x32_bf16 v[36:39], v[148:151], v[20:23], v[36:39]
    v_and_b32_dpp v16, v29, v6 row_newbcast:7 row_mask:0xf bank_mask:0xf
    v_and_b32_dpp v17, v29, v7 row_newbcast:7 row_mask:0xf bank_mask:0xf
    v_and_b32_dpp v18, v29, v8 row_newbcast:7 row_mask:0xf bank_mask:0xf
    v_and_b32_dpp v19, v29, v9 row_newbcast:7 row_mask:0xf bank_mask:0xf
    v_mfma_f32_16x16x32_bf16 v[36:39], v[152:155], v[24:27], v[36:39]
    v_and_b32_dpp v20, v28, v6 row_newbcast:8 row_mask:0xf bank_mask:0xf
    v_and_b32_dpp v21, v28, v7 row_newbcast:8 row_mask:0xf bank_mask:0xf
    v_and_b32_dpp v22, v28, v8 row_newbcast:8 row_mask:0xf bank_mask:0xf
    v_and_b32_dpp v23, v28, v9 row_newbcast:8 row_mask:0xf bank_mask:0xf
    v_mfma_f32_16x16x32_bf16 v[36:39], v[156:159], v[16:19], v[36:39]
    v_and_b32_dpp v24, v29, v6 row_newbcast:8 row_mask:0xf bank_mask:0xf
    v_and_b32_dpp v25, v29, v7 row_newbcast:8 row_mask:0xf bank_mask:0xf
    v_and_b32_dpp v26, v29, v8 row_newbcast:8 row_mask:0xf bank_mask:0xf
    v_and_b32_dpp v27, v29, v9 row_newbcast:8 row_mask:0xf bank_mask:0xf
    v_mfma_f32_16x16x32_bf16 v[36:39], v[160:163], v[20:23], v[36:39]
    v_and_b32_dpp v16, v28, v6 row_newbcast:9 row_mask:0xf bank_mask:0xf
    v_and_b32_dpp v17, v28, v7 row_newbcast:9 row_mask:0xf bank_mask:0xf
    v_and_b32_dpp v18, v28, v8 row_newbcast:9 row_mask:0xf bank_mask:0xf
    v_and_b32_dpp v19, v28, v9 row_newbcast:9 row_mask:0xf bank_mask:0xf
    v_mfma_f32_16x16x32_bf16 v[36:39], v[164:167], v[24:27], v[36:39]
    v_and_b32_dpp v20, v29, v6 row_newbcast:9 row_mask:0xf bank_mask:0xf
    v_and_b32_dpp v21, v29, v7 row_newbcast:9 row_mask:0xf bank_mask:0xf
    v_and_b32_dpp v22, v29, v8 row_newbcast:9 row_mask:0xf bank_mask:0xf
    v_and_b32_dpp v23, v29, v9 row_newbcast:9 row_mask:0xf bank_mask:0xf
    v_mfma_f32_16x16x32_bf16 v[36:39], v[168:171], v[16:19], v[36:39]
    v_and_b32_dpp v24, v28, v6 row_newbcast:10 row_mask:0xf bank_mask:0xf
    v_and_b32_dpp v25, v28, v7 row_newbcast:10 row_mask:0xf bank_mask:0xf
    v_and_b32_dpp v26, v28, v8 row_newbcast:10 row_mask:0xf bank_mask:0xf
    v_and_b32_dpp v27, v28, v9 row_newbcast:10 row_mask:0xf bank_mask:0xf
    v_mfma_f32_16x16x32_bf16 v[36:39], v[172:175], v[20:23], v[36:39]
    v_and_b32_dpp v16, v29, v6 row_newbcast:10 row_mask:0xf bank_mask:0xf
    v_and_b32_dpp v17, v29, v7 row_newbcast:10 row_mask:0xf bank_mask:0xf
    v_and_b32_dpp v18, v29, v8 row_newbcast:10 row_mask:0xf bank_mask:0xf
    v_and_b32_dpp v19, v29, v9 row_newbcast:10 row_mask:0xf bank_mask:0xf
    v_mfma_f32_16x16x32_bf16 v[36:39], v[176:179], v[24:27], v[36:39]
    v_and_b32_dpp v20, v28, v6 row_newbcast:11 row_mask:0xf bank_mask:0xf
    v_and_b32_dpp v21, v28, v7 row_newbcast:11 row_mask:0xf bank_mask:0xf
    v_and_b32_dpp v22, v28, v8 row_newbcast:11 row_mask:0xf bank_mask:0xf
    v_and_b32_dpp v23, v28, v9 row_newbcast:11 row_mask:0xf bank_mask:0xf
    v_mfma_f32_16x16x32_bf16 v[36:39], v[180:183], v[16:19], v[36:39]
    v_and_b32_dpp v24, v29, v6 row_newbcast:11 row_mask:0xf bank_mask:0xf
    v_and_b32_dpp v25, v29, v7 row_newbcast:11 row_mask:0xf bank_mask:0xf
    v_and_b32_dpp v26, v29, v8 row_newbcast:11 row_mask:0xf bank_mask:0xf
    v_and_b32_dpp v27, v29, v9 row_newbcast:11 row_mask:0xf bank_mask:0xf
    v_mfma_f32_16x16x32_bf16 v[36:39], v[184:187], v[20:23], v[36:39]
    v_and_b32_dpp v16, v28, v6 row_newbcast:12 row_mask:0xf bank_mask:0xf
    v_and_b32_dpp v17, v28, v7 row_newbcast:12 row_mask:0xf bank_mask:0xf
    v_and_b32_dpp v18, v28, v8 row_newbcast:12 row_mask:0xf bank_mask:0xf
    v_and_b32_dpp v19, v28, v9 row_newbcast:12 row_mask:0xf bank_mask:0xf
    v_mfma_f32_16x16x32_bf16 v[36:39], v[188:191], v[24:27], v[36:39]
    v_and_b32_dpp v20, v29, v6 row_newbcast:12 row_mask:0xf bank_mask:0xf
    v_and_b32_dpp v21, v29, v7 row_newbcast:12 row_mask:0xf bank_mask:0xf
    v_and_b32_dpp v22, v29, v8 row_newbcast:12 row_mask:0xf bank_mask:0xf
    v_and_b32_dpp v23, v29, v9 row_newbcast:12 row_mask:0xf bank_mask:0xf
    v_mfma_f32_16x16x32_bf16 v[36:39], v[192:195], v[16:19], v[36:39]
    v_and_b32_dpp v24, v28, v6 row_newbcast:13 row_mask:0xf bank_mask:0xf
    v_and_b32_dpp v25, v28, v7 row_newbcast:13 row_mask:0xf bank_mask:0xf
    v_and_b32_dpp v26, v28, v8 row_newbcast:13 row_mask:0xf bank_mask:0xf
    v_and_b32_dpp v27, v28, v9 row_newbcast:13 row_mask:0xf bank_mask:0xf
    v_mfma_f32_16x16x32_bf16 v[36:39], v[196:199], v[20:23], v[36:39]
    v_and_b32_dpp v16, v29, v6 row_newbcast:13 row_mask:0xf bank_mask:0xf
    v_and_b32_dpp v17, v29, v7 row_newbcast:13 row_mask:0xf bank_mask:0xf
    v_and_b32_dpp v18, v29, v8 row_newbcast:13 row_mask:0xf bank_mask:0xf
    v_and_b32_dpp v19, v29, v9 row_newbcast:13 row_mask:0xf bank_mask:0xf
    v_mfma_f32_16x16x32_bf16 v[36:39], v[200:203], v[24:27], v[36:39]
    v_and_b32_dpp v20, v28, v6 row_newbcast:14 row_mask:0xf bank_mask:0xf
    v_and_b32_dpp v21, v28, v7 row_newbcast:14 row_mask:0xf bank_mask:0xf
    v_and_b32_dpp v22, v28, v8 row_newbcast:14 row_mask:0xf bank_mask:0xf
    v_and_b32_dpp v23, v28, v9 row_newbcast:14 row_mask:0xf bank_mask:0xf
    v_mfma_f32_16x16x32_bf16 v[36:39], v[204:207], v[16:19], v[36:39]
    v_and_b32_dpp v24, v29, v6 row_newbcast:14 row_mask:0xf bank_mask:0xf
    v_and_b32_dpp v25, v29, v7 row_newbcast:14 row_mask:0xf bank_mask:0xf
    v_and_b32_dpp v26, v29, v8 row_newbcast:14 row_mask:0xf bank_mask:0xf
    v_and_b32_dpp v27, v29, v9 row_newbcast:14 row_mask:0xf bank_mask:0xf
    v_mfma_f32_16x16x32_bf16 v[36:39], v[208:211], v[20:23], v[36:39]
    v_and_b32_dpp v16, v28, v6 row_newbcast:15 row_mask:0xf bank_mask:0xf
    v_and_b32_dpp v17, v28, v7 row_newbcast:15 row_mask:0xf bank_mask:0xf
    v_and_b32_dpp v18, v28, v8 row_newbcast:15 row_mask:0xf bank_mask:0xf
    v_and_b32_dpp v19, v28, v9 row_newbcast:15 row_mask:0xf bank_mask:0xf
    v_mfma_f32_16x16x32_bf16 v[36:39], v[212:215], v[24:27], v[36:39]
    v_and_b32_dpp v20, v29, v6 row_newbcast:15 row_mask:0xf bank_mask:0xf
    v_and_b32_dpp v21, v29, v7 row_newbcast:15 row_mask:0xf bank_mask:0xf
    v_and_b32_dpp v22, v29, v8 row_newbcast:15 row_mask:0xf bank_mask:0xf
    v_and_b32_dpp v23, v29, v9 row_newbcast:15 row_mask:0xf bank_mask:0xf
    v_mfma_f32_16x16x32_bf16 v[36:39], v[216:219], v[16:19], v[36:39]
    s_nop 0
    v_mfma_f32_16x16x32_bf16 v[36:39], v[220:223], v[20:23], v[36:39]
    s_nop 7
    v_mov_b32 v224, v36
    v_mov_b32 v228, v38
    s_nop 0
    v_mov_b32_dpp v224, v37 row_shr:8 row_mask:0xf bank_mask:0xc
    v_mov_b32_dpp v228, v39 row_shr:8 row_mask:0xf bank_mask:0xc
    v_xor_b32 v226, v224, v232
    v_xor_b32 v230, v228, v232
    buffer_store_dwordx4 v[224:227], v32, s[44:47], 0 offen sc1
    buffer_store_dwordx4 v[228:231], v32, s[44:47], 0 offen offset:1024 sc1
    s_waitcnt vmcnt(0)
L_gather:
    buffer_load_dwordx4 v[40:43], v30, s[44:47], 0 offen sc1
    buffer_load_dwordx4 v[44:47], v30, s[44:47], s96 offen sc1
    s_sub_u32 s95, s95, 1
    s_waitcnt vmcnt(1)
    v_bitop3_b32 v48, v40, v42, v232 bitop3:0x96
    v_bitop3_b32 v49, v41, v43, v233 bitop3:0x96
    s_waitcnt vmcnt(0)
    v_bitop3_b32 v50, v44, v46, v232 bitop3:0x96
    v_bitop3_b32 v51, v45, v47, v233 bitop3:0x96
    v_or3_b32 v48, v48, v49, v50
    v_or_b32 v48, v48, v51
    v_cmp_ne_u32 vcc, 0, v48
    v_add_f32 v241, v40, v44
    v_add_f32 v240, v41, v45
    s_cmp_eq_u32 s95, 0
    s_cbranch_scc1 L_gather_done
    s_cbranch_vccz L_gather_done
    s_mov_b64 exec, vcc
    s_branch L_gather
L_gather_done:
    s_mov_b64 exec, -1
    v_permlane32_swap_b32 v241, v240
    v_add_f32 v241, v241, v240
    s_nop 1
    v_add_f32_dpp v241, v241, v241 row_ror:4 row_mask:0xf bank_mask:0xf
    s_nop 1
    v_add_f32_dpp v241, v241, v241 row_ror:8 row_mask:0xf bank_mask:0xf
    v_mov_b32 v240, v241
    s_nop 1
    v_permlane16_swap_b32 v241, v240
    v_add_f32 v241, v241, v240
    v_cvt_pk_bf16_f32 v241, v241, v241
    v_and_b32 v241, s92, v241
    v_mov_b32 v240, v241
    s_nop 1
    v_permlane32_swap_b32 v241, v240
    v_mul_f32 v240, v240, v239
    v_mul_f32 v241, v238, v241
    v_cvt_pk_bf16_f32 v240, v240, v240
    v_and_b32 v240, s92, v240
    v_cvt_pk_bf16_f32 v241, v241, v241
    v_and_b32 v241, s92, v241
    v_add_f32 v240, v237, v240
    v_cvt_pk_bf16_f32 v240, v240, v240
    v_and_b32 v240, s92, v240
    v_mul_f32 v240, v235, v240
    v_cvt_pk_bf16_f32 v240, v240, v240
    v_and_b32 v240, s92, v240
    v_add_f32 v241, v241, v240
    v_cvt_pk_bf16_f32 v241, v241, v241
    s_mov_b64 exec, 15
    buffer_store_short v241, v236, s[64:67], 0 offen
L_done:
    s_endpgm
.section .rodata,"a"
.p2align 6
.amdhsa_kernel gated_mix__mha_block_cached__moe_arch_mod__decode_kernel
  .amdhsa_next_free_vgpr 256
  .amdhsa_next_free_sgpr 102
  .amdhsa_accum_offset 256
  .amdhsa_group_segment_fixed_size 0
  .amdhsa_kernarg_size 112
  .amdhsa_user_sgpr_count 2
  .amdhsa_user_sgpr_kernarg_segment_ptr 1
  .amdhsa_system_sgpr_workgroup_id_x 1
  .amdhsa_float_denorm_mode_32 3
.end_amdhsa_kernel
```
